```python
import torch

def _softmax(x, axis=-1):
    return torch.softmax(x, dim=axis)
def _gelu(x):
    return torch.nn.functional.gelu(x, approximate="tanh")
def _silu(x):
    return torch.nn.functional.silu(x)
def _sigmoid(x):
    return torch.sigmoid(x)
def _layernorm(x, axis=-1, eps=1e-5):
    m = x.mean(dim=axis, keepdim=True)
    v = x.var(dim=axis, keepdim=True, unbiased=False)
    return (x - m) / torch.sqrt(v + eps)
def _scatter_add(tgt, idx, src, axis=0):
    return tgt.clone().index_add_(axis, idx, src)
def _segment_sum(src, seg, n):
    out = torch.zeros((n,) + src.shape[1:], dtype=src.dtype)
    return out.index_add_(0, seg, src)
def _pad(x, pw):
    flat = tuple(v for pair in reversed(pw) for v in pair)
    return torch.nn.functional.pad(x, flat)

kernel_name = 'sequential_preLN__softmax_full_mha__glu_gated_bilinear__prompt'

def setup_inputs():

    _w = (lambda a: (lambda t: t.to(torch.bfloat16) if t.is_floating_point() else t)(torch.as_tensor(a)))
    def _A_setup():
        B, S, D = 1, 2048, 1024
        return {
            "x": _w((lambda *s: torch.randn(*s, dtype=torch.bfloat16) * 0.05)(B, S, D)),
            "wqkv": _w((lambda *s: torch.randn(*s, dtype=torch.bfloat16) * 0.05)(D, 3 * D)),
            "wo": _w((lambda *s: torch.randn(*s, dtype=torch.bfloat16) * 0.05)(D, D)),
        }
    _A_in = _A_setup()

    def _B_setup():
        B, S, D, F = 1, 2048, 1024, 3584
        return {
            "x": _w((lambda *s: torch.randn(*s, dtype=torch.bfloat16) * 0.05)(B, S, D)),
            "w_gate": _w((lambda *s: torch.randn(*s, dtype=torch.bfloat16) * 0.8)(D, F) * (D ** -0.5)),
            "w_up": _w((lambda *s: torch.randn(*s, dtype=torch.bfloat16) * 0.8)(D, F) * (D ** -0.5)),
            "w_down": _w((lambda *s: torch.randn(*s, dtype=torch.bfloat16) * 0.8)(F, D) * (F ** -0.5)),
        }
    _B_in = _B_setup()

    return {
        "A_x": _A_in["x"],
        "A_wqkv": _A_in["wqkv"],
        "A_wo": _A_in["wo"],
        "B_x": _B_in["x"],
        "B_w_gate": _B_in["w_gate"],
        "B_w_up": _B_in["w_up"],
        "B_w_down": _B_in["w_down"],
    }

def reference(A_x, A_wqkv, A_wo, B_x, B_w_gate, B_w_up, B_w_down):
    def _A_ref(x, wqkv, wo):
        B, S, D = x.shape
        H = 32; Dh = D // H
        qkv = (lambda x, *d: x.permute(*d))((x @ wqkv).reshape(B, S, 3, H, Dh), 2, 0, 3, 1, 4)
        q, k, v = qkv[0], qkv[1], qkv[2]
        scale = Dh ** -0.5
        scores = torch.einsum("bhqd,bhkd->bhqk", q, k) * scale
        p = _softmax(scores, axis=-1)
        o = torch.einsum("bhqk,bhkd->bhqd", p, v)
        return (lambda x, *d: x.permute(*d))(o, 0, 2, 1, 3).reshape(B, S, D) @ wo

    def _B_ref(x, w_gate, w_up, w_down):
        g = torch.einsum("bsd,df->bsf", x, w_gate)
        u = torch.einsum("bsd,df->bsf", x, w_up)
        h = g * u
        return torch.einsum("bsf,fd->bsd", h, w_down)

    x = A_x
    h = x + _A_ref(_layernorm(x, axis=-1), A_wqkv, A_wo)
    h2 = h + _B_ref(_layernorm(h, axis=-1), B_w_gate, B_w_up, B_w_down)
    return h2
```

```asm
; @launch grid=(256,1,1) block=(256,1,1) lds=163840
.amdgcn_target "amdgcn-amd-amdhsa--gfx950"
.text
.p2align 8
L_text_begin:
.text
.globl sequential_preLN__softmax_full_mha__glu_gated_bilinear__prompt_kernel
.p2align 8
.type sequential_preLN__softmax_full_mha__glu_gated_bilinear__prompt_kernel,@function
sequential_preLN__softmax_full_mha__glu_gated_bilinear__prompt_kernel:
  s_cmp_ge_u32 s2, 256
  s_cbranch_scc1 L_sequential_preLN__softmax_full_mha__glu_gated_bilinear__prompt_kernel_end
  s_load_dwordx16 s[64:79], s[0:1], 0
  s_load_dwordx4 s[60:63], s[0:1], 64
  v_lshrrev_b32 v1, 6, v0
  s_nop 0
  v_readfirstlane_b32 s20, v1
  v_and_b32 v1, 63, v0
  s_and_b32 s30, s2, 7
  s_lshr_b32 s31, s2, 3
  s_and_b32 s21, s30, 1
  s_lshl_b32 s21, s21, 3
  s_and_b32 s32, s31, 7
  s_add_u32 s21, s21, s32
  s_lshr_b32 s22, s30, 1
  s_mul_i32 s22, s22, 4
  s_lshr_b32 s32, s31, 3
  s_add_u32 s22, s22, s32
  s_and_b32 s44, s20, 1
  s_lshr_b32 s45, s20, 1
  s_and_b32 s30, s22, 12
  s_add_u32 s31, s22, 1
  s_and_b32 s31, s31, 3
  s_add_u32 s31, s31, s30
  s_lshl_b32 s31, s31, 8
  s_add_u32 s32, s22, 2
  s_and_b32 s32, s32, 3
  s_add_u32 s32, s32, s30
  s_lshl_b32 s32, s32, 16
  s_or_b32 s46, s22, s31
  s_or_b32 s46, s46, s32
  v_lshrrev_b32 v28, 3, v1
  s_lshl_b32 s30, s20, 16
  s_lshl_b32 s31, s21, 18
  s_add_u32 s30, s30, s31
  v_lshl_add_u32 v29, v28, 11, s30
  v_lshrrev_b32 v28, 4, v1
  v_and_b32 v30, 7, v1
  v_xor_b32 v28, v28, v30
  v_lshl_add_u32 v2, v28, 4, v29
  v_xor_b32 v28, 4, v28
  v_lshl_add_u32 v3, v28, 4, v29
  v_add_u32 v3, 15360, v3
  v_add_u32 v4, 30720, v2
  v_add_u32 v5, 30720, v3
  v_bfe_u32 v28, v1, 4, 2
  v_bfe_u32 v29, v1, 1, 2
  v_xor_b32 v28, v28, v29
  v_and_b32 v29, 1, v1
  v_lshlrev_b32 v29, 4, v29
  v_lshl_add_u32 v27, v28, 5, v29
  s_mov_b32 s34, 6144
  v_bfe_u32 v28, v1, 3, 2
  v_lshrrev_b32 v29, 5, v1
  v_lshl_add_u32 v28, v29, 3, v28
  v_mul_lo_u32 v28, s34, v28
  v_add_u32 v27, v27, v28
  s_mul_i32 s35, s20, 6
  s_add_u32 s30, s35, 0
  s_and_b32 s32, s30, 24
  s_lshl_b32 s31, s32, 8
  s_lshr_b32 s32, s46, s32
  s_and_b32 s32, s32, 15
  s_lshl_b32 s32, s32, 7
  s_add_u32 s31, s31, s32
  s_and_b32 s32, s30, 4
  s_lshl_b32 s32, s32, 3
  s_and_b32 s33, s30, 1
  s_lshl_b32 s33, s33, 4
  s_add_u32 s32, s32, s33
  s_and_b32 s33, s30, 2
  s_lshl_b32 s33, s33, 1
  s_add_u32 s32, s32, s33
  s_mul_i32 s32, s32, 6144
  s_add_u32 s31, s31, s32
  s_sub_u32 s31, s31, 0
  v_add_u32 v6, s31, v27
  s_add_u32 s30, s35, 1
  s_and_b32 s32, s30, 24
  s_lshl_b32 s31, s32, 8
  s_lshr_b32 s32, s46, s32
  s_and_b32 s32, s32, 15
  s_lshl_b32 s32, s32, 7
  s_add_u32 s31, s31, s32
  s_and_b32 s32, s30, 4
  s_lshl_b32 s32, s32, 3
  s_and_b32 s33, s30, 1
  s_lshl_b32 s33, s33, 4
  s_add_u32 s32, s32, s33
  s_and_b32 s33, s30, 2
  s_lshl_b32 s33, s33, 1
  s_add_u32 s32, s32, s33
  s_mul_i32 s32, s32, 6144
  s_add_u32 s31, s31, s32
  s_sub_u32 s31, s31, 1024
  v_add_u32 v7, s31, v27
  s_add_u32 s30, s35, 2
  s_and_b32 s32, s30, 24
  s_lshl_b32 s31, s32, 8
  s_lshr_b32 s32, s46, s32
  s_and_b32 s32, s32, 15
  s_lshl_b32 s32, s32, 7
  s_add_u32 s31, s31, s32
  s_and_b32 s32, s30, 4
  s_lshl_b32 s32, s32, 3
  s_and_b32 s33, s30, 1
  s_lshl_b32 s33, s33, 4
  s_add_u32 s32, s32, s33
  s_and_b32 s33, s30, 2
  s_lshl_b32 s33, s33, 1
  s_add_u32 s32, s32, s33
  s_mul_i32 s32, s32, 6144
  s_add_u32 s31, s31, s32
  s_sub_u32 s31, s31, 2048
  v_add_u32 v8, s31, v27
  s_add_u32 s30, s35, 3
  s_and_b32 s32, s30, 24
  s_lshl_b32 s31, s32, 8
  s_lshr_b32 s32, s46, s32
  s_and_b32 s32, s32, 15
  s_lshl_b32 s32, s32, 7
  s_add_u32 s31, s31, s32
  s_and_b32 s32, s30, 4
  s_lshl_b32 s32, s32, 3
  s_and_b32 s33, s30, 1
  s_lshl_b32 s33, s33, 4
  s_add_u32 s32, s32, s33
  s_and_b32 s33, s30, 2
  s_lshl_b32 s33, s33, 1
  s_add_u32 s32, s32, s33
  s_mul_i32 s32, s32, 6144
  s_add_u32 s31, s31, s32
  s_sub_u32 s31, s31, 3072
  v_add_u32 v9, s31, v27
  s_add_u32 s30, s35, 4
  s_and_b32 s32, s30, 24
  s_lshl_b32 s31, s32, 8
  s_lshr_b32 s32, s46, s32
  s_and_b32 s32, s32, 15
  s_lshl_b32 s32, s32, 7
  s_add_u32 s31, s31, s32
  s_and_b32 s32, s30, 4
  s_lshl_b32 s32, s32, 3
  s_and_b32 s33, s30, 1
  s_lshl_b32 s33, s33, 4
  s_add_u32 s32, s32, s33
  s_and_b32 s33, s30, 2
  s_lshl_b32 s33, s33, 1
  s_add_u32 s32, s32, s33
  s_mul_i32 s32, s32, 6144
  s_add_u32 s31, s31, s32
  s_sub_u32 s31, s31, 0
  v_add_u32 v10, s31, v27
  s_add_u32 s30, s35, 5
  s_and_b32 s32, s30, 24
  s_lshl_b32 s31, s32, 8
  s_lshr_b32 s32, s46, s32
  s_and_b32 s32, s32, 15
  s_lshl_b32 s32, s32, 7
  s_add_u32 s31, s31, s32
  s_and_b32 s32, s30, 4
  s_lshl_b32 s32, s32, 3
  s_and_b32 s33, s30, 1
  s_lshl_b32 s33, s33, 4
  s_add_u32 s32, s32, s33
  s_and_b32 s33, s30, 2
  s_lshl_b32 s33, s33, 1
  s_add_u32 s32, s32, s33
  s_mul_i32 s32, s32, 6144
  s_add_u32 s31, s31, s32
  s_sub_u32 s31, s31, 1024
  v_add_u32 v11, s31, v27
  s_waitcnt lgkmcnt(0)
  s_mov_b32 s4, s66
  s_mov_b32 s5, s67
  s_mov_b32 s6, 6291456
  s_mov_b32 s7, 0x20000
  s_mov_b32 s8, s64
  s_mov_b32 s9, s65
  s_mov_b32 s10, 4194304
  s_mov_b32 s11, 0x20000
  s_mov_b32 s24, 0
  s_mov_b32 s25, 0
  s_mul_i32 s26, s20, 10240
  s_add_u32 s29, s26, 163840
  s_mov_b32 s27, 0
  s_mov_b32 s23, s26
  s_mov_b32 m0, s26
  s_nop 0
  buffer_load_dwordx4 v2, s[8:11], s25 offen lds
  buffer_load_dwordx4 v3, s[8:11], s25 offen offset:1024 lds
  buffer_load_dwordx4 v4, s[8:11], s25 offen offset:2048 lds
  buffer_load_dwordx4 v5, s[8:11], s25 offen offset:3072 lds
  s_add_u32 m0, s26, 4096
  s_nop 0
  buffer_load_dwordx4 v6, s[4:7], s24 offen lds
  buffer_load_dwordx4 v7, s[4:7], s24 offen offset:1024 lds
  buffer_load_dwordx4 v8, s[4:7], s24 offen offset:2048 lds
  buffer_load_dwordx4 v9, s[4:7], s24 offen offset:3072 lds
  s_add_u32 m0, s26, 8192
  s_nop 0
  buffer_load_dwordx4 v10, s[4:7], s24 offen lds
  buffer_load_dwordx4 v11, s[4:7], s24 offen offset:1024 lds
  s_add_u32 s24, s24, 393216
  s_add_u32 s25, s25, 128
  s_add_u32 s26, s26, 40960
  s_cmp_ge_u32 s26, s29
  s_cselect_b32 s26, s23, s26
  s_mov_b32 m0, s26
  s_nop 0
  buffer_load_dwordx4 v2, s[8:11], s25 offen lds
  buffer_load_dwordx4 v3, s[8:11], s25 offen offset:1024 lds
  buffer_load_dwordx4 v4, s[8:11], s25 offen offset:2048 lds
  buffer_load_dwordx4 v5, s[8:11], s25 offen offset:3072 lds
  s_add_u32 m0, s26, 4096
  s_nop 0
  buffer_load_dwordx4 v6, s[4:7], s24 offen lds
  buffer_load_dwordx4 v7, s[4:7], s24 offen offset:1024 lds
  buffer_load_dwordx4 v8, s[4:7], s24 offen offset:2048 lds
  buffer_load_dwordx4 v9, s[4:7], s24 offen offset:3072 lds
  s_add_u32 m0, s26, 8192
  s_nop 0
  buffer_load_dwordx4 v10, s[4:7], s24 offen lds
  buffer_load_dwordx4 v11, s[4:7], s24 offen offset:1024 lds
  s_add_u32 s24, s24, 393216
  s_add_u32 s25, s25, 128
  s_add_u32 s26, s26, 40960
  s_cmp_ge_u32 s26, s29
  s_cselect_b32 s26, s23, s26
  v_and_b32 v24, 15, v1
  v_lshrrev_b32 v25, 4, v1
  v_lshrrev_b32 v28, 5, v1
  v_and_b32 v29, 31, v1
  v_lshlrev_b32 v29, 4, v29
  v_lshl_add_u32 v26, v28, 11, v29
  s_lshl_b32 s30, s2, 14
  s_lshl_b32 s31, s20, 12
  s_add_u32 s30, s30, s31
  buffer_load_dwordx4 v[128:131], v26, s[8:11], s30 offen offset:0
  buffer_load_dwordx4 v[132:135], v26, s[8:11], s30 offen offset:512
  buffer_load_dwordx4 v[136:139], v26, s[8:11], s30 offen offset:1024
  buffer_load_dwordx4 v[140:143], v26, s[8:11], s30 offen offset:1536
  v_lshrrev_b32 v28, 3, v1
  v_mul_lo_u32 v28, s34, v28
  v_and_b32 v29, 7, v1
  v_lshl_add_u32 v26, v29, 4, v28
  s_mul_i32 s30, s21, 393216
  s_lshl_b32 s31, s20, 11
  s_add_u32 s30, s30, s31
  s_lshl_b32 s31, s20, 3
  s_lshr_b32 s31, s46, s31
  s_and_b32 s31, s31, 15
  s_lshl_b32 s31, s31, 7
  s_add_u32 s30, s30, s31
  s_mov_b32 s31, 49152
  s_mov_b64 s[16:17], s[4:5]
  s_mov_b32 s18, s6
  s_mov_b32 s19, 0x20000
  s_cmp_lg_u32 s20, 3
  s_cbranch_scc1 L_p1_cs
  v_and_b32 v28, 3, v1
  v_lshlrev_b32 v28, 11, v28
  v_lshrrev_b32 v29, 2, v1
  v_lshl_add_u32 v26, v29, 4, v28
  s_lshl_b32 s30, s2, 13
  s_movk_i32 s31, 256
  s_mov_b64 s[16:17], s[68:69]
  s_mov_b32 s18, 2097152
L_p1_cs:
  buffer_load_dwordx4 v[144:147], v26, s[16:19], s30 offen
  s_add_u32 s30, s30, s31
  buffer_load_dwordx4 v[148:151], v26, s[16:19], s30 offen
  s_add_u32 s30, s30, s31
  buffer_load_dwordx4 v[152:155], v26, s[16:19], s30 offen
  s_add_u32 s30, s30, s31
  buffer_load_dwordx4 v[156:159], v26, s[16:19], s30 offen
  s_add_u32 s30, s30, s31
  buffer_load_dwordx4 v[160:163], v26, s[16:19], s30 offen
  s_add_u32 s30, s30, s31
  buffer_load_dwordx4 v[164:167], v26, s[16:19], s30 offen
  s_add_u32 s30, s30, s31
  buffer_load_dwordx4 v[168:171], v26, s[16:19], s30 offen
  s_add_u32 s30, s30, s31
  buffer_load_dwordx4 v[172:175], v26, s[16:19], s30 offen
  s_getpc_b64 s[52:53]
L_pc_L_text_begin_278:
  s_add_u32 s52, s52, L_text_begin-L_pc_L_text_begin_278
  s_addc_u32 s53, s53, (L_text_begin-L_pc_L_text_begin_278)>>32
  s_mov_b32 s54, L_text_end-L_text_begin
  s_mov_b32 s55, 0x20000
  v_lshlrev_b32 v253, 7, v0
  buffer_load_dword v254, v253, s[52:55], 0 offen
  v_add_u32 v253, 32768, v253
  buffer_load_dword v254, v253, s[52:55], 0 offen
  s_add_u32 s58, s62, 42991616
  s_addc_u32 s59, s63, 0
  s_and_b32 s30, s2, 63
  s_lshl_b32 s30, s30, 8
  v_mov_b32 v30, s30
  v_mov_b32 v31, 0
  s_mov_b64 exec, 1
  global_store_dword v30, v31, s[58:59] sc1
  s_mov_b64 exec, -1
  v_bfe_u32 v28, v1, 2, 3
  v_lshlrev_b32 v29, 7, v28
  v_lshrrev_b32 v30, 5, v1
  v_lshl_add_u32 v29, v30, 10, v29
  v_and_b32 v30, 3, v1
  v_lshl_add_u32 v29, v30, 3, v29
  v_bfe_u32 v28, v1, 3, 2
  s_lshl_b32 s30, s45, 1
  v_xor_b32 v28, s30, v28
  v_lshl_add_u32 v12, v28, 5, v29
  v_xor_b32 v28, 1, v28
  v_lshl_add_u32 v13, v28, 5, v29
  s_mul_i32 s30, s44, 20480
  v_lshl_add_u32 v29, v24, 7, s30
  v_lshrrev_b32 v28, 1, v24
  v_xor_b32 v28, v28, v25
  v_lshl_add_u32 v14, v28, 4, v29
  v_xor_b32 v28, 4, v28
  v_lshl_add_u32 v15, v28, 4, v29
  v_mov_b32 v16, v12
  v_mov_b32 v17, v13
  v_mov_b32 v18, v14
  v_mov_b32 v19, v15
  v_mov_b32 v32, 0
  v_mov_b32 v33, 0
  v_mov_b32 v34, 0
  v_mov_b32 v35, 0
  v_mov_b32 v36, 0
  v_mov_b32 v37, 0
  v_mov_b32 v38, 0
  v_mov_b32 v39, 0
  v_mov_b32 v40, 0
  v_mov_b32 v41, 0
  v_mov_b32 v42, 0
  v_mov_b32 v43, 0
  v_mov_b32 v44, 0
  v_mov_b32 v45, 0
  v_mov_b32 v46, 0
  v_mov_b32 v47, 0
  v_mov_b32 v48, 0
  v_mov_b32 v49, 0
  v_mov_b32 v50, 0
  v_mov_b32 v51, 0
  v_mov_b32 v52, 0
  v_mov_b32 v53, 0
  v_mov_b32 v54, 0
  v_mov_b32 v55, 0
  v_mov_b32 v56, 0
  v_mov_b32 v57, 0
  v_mov_b32 v58, 0
  v_mov_b32 v59, 0
  v_mov_b32 v60, 0
  v_mov_b32 v61, 0
  v_mov_b32 v62, 0
  v_mov_b32 v63, 0
  v_mov_b32 v64, 0
  v_mov_b32 v65, 0
  v_mov_b32 v66, 0
  v_mov_b32 v67, 0
  v_mov_b32 v68, 0
  v_mov_b32 v69, 0
  v_mov_b32 v70, 0
  v_mov_b32 v71, 0
  v_mov_b32 v72, 0
  v_mov_b32 v73, 0
  v_mov_b32 v74, 0
  v_mov_b32 v75, 0
  v_mov_b32 v76, 0
  v_mov_b32 v77, 0
  v_mov_b32 v78, 0
  v_mov_b32 v79, 0
  v_mov_b32 v80, 0
  v_mov_b32 v81, 0
  v_mov_b32 v82, 0
  v_mov_b32 v83, 0
  v_mov_b32 v84, 0
  v_mov_b32 v85, 0
  v_mov_b32 v86, 0
  v_mov_b32 v87, 0
  v_mov_b32 v88, 0
  v_mov_b32 v89, 0
  v_mov_b32 v90, 0
  v_mov_b32 v91, 0
  v_mov_b32 v92, 0
  v_mov_b32 v93, 0
  v_mov_b32 v94, 0
  v_mov_b32 v95, 0
  v_mov_b32 v96, 0
  v_mov_b32 v97, 0
  v_mov_b32 v98, 0
  v_mov_b32 v99, 0
  v_mov_b32 v100, 0
  v_mov_b32 v101, 0
  v_mov_b32 v102, 0
  v_mov_b32 v103, 0
  v_mov_b32 v104, 0
  v_mov_b32 v105, 0
  v_mov_b32 v106, 0
  v_mov_b32 v107, 0
  v_mov_b32 v108, 0
  v_mov_b32 v109, 0
  v_mov_b32 v110, 0
  v_mov_b32 v111, 0
  v_mov_b32 v112, 0
  v_mov_b32 v113, 0
  v_mov_b32 v114, 0
  v_mov_b32 v115, 0
  v_mov_b32 v116, 0
  v_mov_b32 v117, 0
  v_mov_b32 v118, 0
  v_mov_b32 v119, 0
  v_mov_b32 v120, 0
  v_mov_b32 v121, 0
  v_mov_b32 v122, 0
  v_mov_b32 v123, 0
  v_mov_b32 v124, 0
  v_mov_b32 v125, 0
  v_mov_b32 v126, 0
  v_mov_b32 v127, 0
  s_add_u32 s12, s62, 41943040
  s_addc_u32 s13, s63, 0
  s_mov_b32 s14, 360448
  s_mov_b32 s15, 0x20000
  s_add_u32 s48, s62, 4194304
  s_addc_u32 s49, s63, 0
  s_mov_b32 s50, 12582912
  s_mov_b32 s51, 0x20000
  v_cmp_eq_u32 vcc, 0, v24
  v_mov_b32 v28, 0x3f80
  s_nop 0
  v_cndmask_b32 v176, 0, v28, vcc
  v_cmp_eq_u32 vcc, 1, v24
  v_mov_b32 v28, 1.0
  s_nop 0
  v_cndmask_b32 v176, v176, v28, vcc
  v_cmp_eq_u32 vcc, 2, v24
  v_mov_b32 v28, 0x3f80
  s_nop 0
  v_cndmask_b32 v177, 0, v28, vcc
  v_cmp_eq_u32 vcc, 3, v24
  v_mov_b32 v28, 1.0
  s_nop 0
  v_cndmask_b32 v177, v177, v28, vcc
  v_cmp_eq_u32 vcc, 4, v24
  v_mov_b32 v28, 0x3f80
  s_nop 0
  v_cndmask_b32 v178, 0, v28, vcc
  v_cmp_eq_u32 vcc, 5, v24
  v_mov_b32 v28, 1.0
  s_nop 0
  v_cndmask_b32 v178, v178, v28, vcc
  v_cmp_eq_u32 vcc, 6, v24
  v_mov_b32 v28, 0x3f80
  s_nop 0
  v_cndmask_b32 v179, 0, v28, vcc
  v_cmp_eq_u32 vcc, 7, v24
  v_mov_b32 v28, 1.0
  s_nop 0
  v_cndmask_b32 v179, v179, v28, vcc
  s_cmp_lg_u32 s20, 3
  s_cbranch_scc1 L_p1_sel
  v_mov_b32 v176, 0x3f803f80
  v_mov_b32 v177, 0x3f803f80
  v_mov_b32 v178, 0x3f803f80
  v_mov_b32 v179, 0x3f803f80
L_p1_sel:
  s_waitcnt vmcnt(11)
  v_lshlrev_b32 v184, 16, v128
  v_and_b32 v185, 0xffff0000, v128
  v_lshlrev_b32 v186, 16, v129
  v_and_b32 v187, 0xffff0000, v129
  v_lshlrev_b32 v188, 16, v130
  v_and_b32 v189, 0xffff0000, v130
  v_lshlrev_b32 v190, 16, v131
  v_and_b32 v191, 0xffff0000, v131
  v_lshlrev_b32 v192, 16, v132
  v_and_b32 v193, 0xffff0000, v132
  v_lshlrev_b32 v194, 16, v133
  v_and_b32 v195, 0xffff0000, v133
  v_lshlrev_b32 v196, 16, v134
  v_and_b32 v197, 0xffff0000, v134
  v_lshlrev_b32 v198, 16, v135
  v_and_b32 v199, 0xffff0000, v135
  v_lshlrev_b32 v200, 16, v136
  v_and_b32 v201, 0xffff0000, v136
  v_lshlrev_b32 v202, 16, v137
  v_and_b32 v203, 0xffff0000, v137
  v_lshlrev_b32 v204, 16, v138
  v_and_b32 v205, 0xffff0000, v138
  v_lshlrev_b32 v206, 16, v139
  v_and_b32 v207, 0xffff0000, v139
  v_lshlrev_b32 v208, 16, v140
  v_and_b32 v209, 0xffff0000, v140
  v_lshlrev_b32 v210, 16, v141
  v_and_b32 v211, 0xffff0000, v141
  v_lshlrev_b32 v212, 16, v142
  v_and_b32 v213, 0xffff0000, v142
  v_lshlrev_b32 v214, 16, v143
  v_and_b32 v215, 0xffff0000, v143
  v_pk_add_f32 v[28:29], v[184:185], v[186:187]
  v_pk_add_f32 v[28:29], v[28:29], v[188:189]
  v_pk_add_f32 v[28:29], v[28:29], v[190:191]
  v_pk_add_f32 v[28:29], v[28:29], v[192:193]
  v_pk_add_f32 v[28:29], v[28:29], v[194:195]
  v_pk_add_f32 v[28:29], v[28:29], v[196:197]
  v_pk_add_f32 v[28:29], v[28:29], v[198:199]
  v_pk_add_f32 v[28:29], v[28:29], v[200:201]
  v_pk_add_f32 v[28:29], v[28:29], v[202:203]
  v_pk_add_f32 v[28:29], v[28:29], v[204:205]
  v_pk_add_f32 v[28:29], v[28:29], v[206:207]
  v_pk_add_f32 v[28:29], v[28:29], v[208:209]
  v_pk_add_f32 v[28:29], v[28:29], v[210:211]
  v_pk_add_f32 v[28:29], v[28:29], v[212:213]
  v_pk_add_f32 v[28:29], v[28:29], v[214:215]
  v_add_f32 v28, v28, v29
  s_nop 1
  v_add_f32_dpp v28, v28, v28 row_ror:8 row_mask:0xf bank_mask:0xf
  s_nop 1
  v_add_f32_dpp v28, v28, v28 row_ror:4 row_mask:0xf bank_mask:0xf
  s_nop 1
  v_add_f32_dpp v28, v28, v28 row_ror:2 row_mask:0xf bank_mask:0xf
  s_nop 1
  v_add_f32_dpp v28, v28, v28 row_ror:1 row_mask:0xf bank_mask:0xf
  v_mov_b32 v29, v28
  s_nop 1
  v_permlane16_swap_b32 v29, v28
  v_add_f32 v28, v28, v29
  v_mul_f32 v30, 0x3a800000, v28
  v_pk_add_f32 v[184:185], v[184:185], v[30:31] op_sel_hi:[1,0] neg_lo:[0,1] neg_hi:[0,1]
  v_pk_add_f32 v[186:187], v[186:187], v[30:31] op_sel_hi:[1,0] neg_lo:[0,1] neg_hi:[0,1]
  v_pk_add_f32 v[188:189], v[188:189], v[30:31] op_sel_hi:[1,0] neg_lo:[0,1] neg_hi:[0,1]
  v_pk_add_f32 v[190:191], v[190:191], v[30:31] op_sel_hi:[1,0] neg_lo:[0,1] neg_hi:[0,1]
  v_pk_add_f32 v[192:193], v[192:193], v[30:31] op_sel_hi:[1,0] neg_lo:[0,1] neg_hi:[0,1]
  v_pk_add_f32 v[194:195], v[194:195], v[30:31] op_sel_hi:[1,0] neg_lo:[0,1] neg_hi:[0,1]
  v_pk_add_f32 v[196:197], v[196:197], v[30:31] op_sel_hi:[1,0] neg_lo:[0,1] neg_hi:[0,1]
  v_pk_add_f32 v[198:199], v[198:199], v[30:31] op_sel_hi:[1,0] neg_lo:[0,1] neg_hi:[0,1]
  v_pk_add_f32 v[200:201], v[200:201], v[30:31] op_sel_hi:[1,0] neg_lo:[0,1] neg_hi:[0,1]
  v_pk_add_f32 v[202:203], v[202:203], v[30:31] op_sel_hi:[1,0] neg_lo:[0,1] neg_hi:[0,1]
  v_pk_add_f32 v[204:205], v[204:205], v[30:31] op_sel_hi:[1,0] neg_lo:[0,1] neg_hi:[0,1]
  v_pk_add_f32 v[206:207], v[206:207], v[30:31] op_sel_hi:[1,0] neg_lo:[0,1] neg_hi:[0,1]
  v_pk_add_f32 v[208:209], v[208:209], v[30:31] op_sel_hi:[1,0] neg_lo:[0,1] neg_hi:[0,1]
  v_pk_add_f32 v[210:211], v[210:211], v[30:31] op_sel_hi:[1,0] neg_lo:[0,1] neg_hi:[0,1]
  v_pk_add_f32 v[212:213], v[212:213], v[30:31] op_sel_hi:[1,0] neg_lo:[0,1] neg_hi:[0,1]
  v_pk_add_f32 v[214:215], v[214:215], v[30:31] op_sel_hi:[1,0] neg_lo:[0,1] neg_hi:[0,1]
  v_pk_mul_f32 v[28:29], v[184:185], v[184:185]
  v_pk_fma_f32 v[28:29], v[186:187], v[186:187], v[28:29]
  v_pk_fma_f32 v[28:29], v[188:189], v[188:189], v[28:29]
  v_pk_fma_f32 v[28:29], v[190:191], v[190:191], v[28:29]
  v_pk_fma_f32 v[28:29], v[192:193], v[192:193], v[28:29]
  v_pk_fma_f32 v[28:29], v[194:195], v[194:195], v[28:29]
  v_pk_fma_f32 v[28:29], v[196:197], v[196:197], v[28:29]
  v_pk_fma_f32 v[28:29], v[198:199], v[198:199], v[28:29]
  v_pk_fma_f32 v[28:29], v[200:201], v[200:201], v[28:29]
  v_pk_fma_f32 v[28:29], v[202:203], v[202:203], v[28:29]
  v_pk_fma_f32 v[28:29], v[204:205], v[204:205], v[28:29]
  v_pk_fma_f32 v[28:29], v[206:207], v[206:207], v[28:29]
  v_pk_fma_f32 v[28:29], v[208:209], v[208:209], v[28:29]
  v_pk_fma_f32 v[28:29], v[210:211], v[210:211], v[28:29]
  v_pk_fma_f32 v[28:29], v[212:213], v[212:213], v[28:29]
  v_pk_fma_f32 v[28:29], v[214:215], v[214:215], v[28:29]
  v_add_f32 v28, v28, v29
  s_nop 1
  v_add_f32_dpp v28, v28, v28 row_ror:8 row_mask:0xf bank_mask:0xf
  s_nop 1
  v_add_f32_dpp v28, v28, v28 row_ror:4 row_mask:0xf bank_mask:0xf
  s_nop 1
  v_add_f32_dpp v28, v28, v28 row_ror:2 row_mask:0xf bank_mask:0xf
  s_nop 1
  v_add_f32_dpp v28, v28, v28 row_ror:1 row_mask:0xf bank_mask:0xf
  v_mov_b32 v29, v28
  s_nop 1
  v_permlane16_swap_b32 v29, v28
  v_add_f32 v28, v28, v29
  v_mov_b32 v29, 0x3727c5ac
  v_fmac_f32 v29, 0x3a800000, v28
  v_rsq_f32 v31, v29
  v_lshrrev_b32 v28, 5, v1
  v_lshlrev_b32 v28, 2, v28
  s_lshl_b32 s30, s2, 5
  s_lshl_b32 s31, s20, 3
  s_add_u32 s30, s30, s31
  s_add_u32 s31, s30, 24576
  s_mov_b32 exec_lo, 1
  s_mov_b32 exec_hi, 1
  buffer_store_dword v30, v28, s[12:15], s30 offen offset:0 sc1
  buffer_store_dword v31, v28, s[12:15], s31 offen sc1
  s_mov_b64 exec, -1
  s_waitcnt vmcnt(27)
  s_barrier
  ds_read_b128 a[0:3], v18 offset:0
  ds_read_b128 a[4:7], v18 offset:2048
  ds_read_b128 a[8:11], v18 offset:10240
  ds_read_b128 a[12:15], v18 offset:12288
  ds_read_b64_tr_b16 a[32:33], v16 offset:4096
  ds_read_b64_tr_b16 a[34:35], v16 offset:6144
  ds_read_b64_tr_b16 a[36:37], v17 offset:4096
  ds_read_b64_tr_b16 a[38:39], v17 offset:6144
  ds_read_b64_tr_b16 a[40:41], v16 offset:16384
  ds_read_b64_tr_b16 a[42:43], v16 offset:18432
  s_mov_b32 s28, 7
  s_waitcnt lgkmcnt(4)
.p2align 5
L_k1_loop:
  v_mfma_f32_16x16x32_bf16 v[32:35], a[32:35], a[0:3], v[32:35]
  s_add_u32 s27, s27, 40960
  ds_read_b64_tr_b16 a[44:45], v17 offset:16384
  v_mfma_f32_16x16x32_bf16 v[36:39], a[32:35], a[4:7], v[36:39]
  s_cmp_ge_u32 s27, 163840
  ds_read_b64_tr_b16 a[46:47], v17 offset:18432
  s_cselect_b32 s27, 0, s27
  v_mfma_f32_16x16x32_bf16 v[40:43], a[32:35], a[8:11], v[40:43]
  s_mov_b32 m0, s26
  ds_read_b128 a[16:19], v19 offset:0
  v_mfma_f32_16x16x32_bf16 v[44:47], a[32:35], a[12:15], v[44:47]
  s_waitcnt lgkmcnt(5)
  buffer_load_dwordx4 v2, s[8:11], s25 offen lds
  v_mfma_f32_16x16x32_bf16 v[60:63], a[36:39], a[12:15], v[60:63]
  ds_read_b64_tr_b16 a[32:33], v16 offset:28672
  v_mfma_f32_16x16x32_bf16 v[56:59], a[36:39], a[8:11], v[56:59]
  ds_read_b64_tr_b16 a[34:35], v16 offset:34816
  v_mfma_f32_16x16x32_bf16 v[52:55], a[36:39], a[4:7], v[52:55]
  ds_read_b128 a[20:23], v19 offset:2048
  v_mfma_f32_16x16x32_bf16 v[48:51], a[36:39], a[0:3], v[48:51]
  s_waitcnt lgkmcnt(6)
  buffer_load_dwordx4 v3, s[8:11], s25 offen offset:1024 lds
  v_mfma_f32_16x16x32_bf16 v[64:67], a[40:43], a[0:3], v[64:67]
  ds_read_b64_tr_b16 a[36:37], v17 offset:28672
  v_mfma_f32_16x16x32_bf16 v[68:71], a[40:43], a[4:7], v[68:71]
  ds_read_b64_tr_b16 a[38:39], v17 offset:34816
  buffer_load_dwordx4 v4, s[8:11], s25 offen offset:2048 lds
  v_mfma_f32_16x16x32_bf16 v[72:75], a[40:43], a[8:11], v[72:75]
  ds_read_b128 a[24:27], v19 offset:10240
  v_mfma_f32_16x16x32_bf16 v[76:79], a[40:43], a[12:15], v[76:79]
  s_waitcnt lgkmcnt(7)
  v_add_u32 v20, s27, v12
  v_mfma_f32_16x16x32_bf16 v[92:95], a[44:47], a[12:15], v[92:95]
  ds_read_b64_tr_b16 a[40:41], v16 offset:8192
  buffer_load_dwordx4 v5, s[8:11], s25 offen offset:3072 lds
  v_mfma_f32_16x16x32_bf16 v[88:91], a[44:47], a[8:11], v[88:91]
  ds_read_b64_tr_b16 a[42:43], v16 offset:14336
  v_add_u32 v21, s27, v13
  v_mfma_f32_16x16x32_bf16 v[84:87], a[44:47], a[4:7], v[84:87]
  s_add_u32 m0, s26, 4096
  ds_read_b128 a[28:31], v19 offset:12288
  v_mfma_f32_16x16x32_bf16 v[80:83], a[44:47], a[0:3], v[80:83]
  s_waitcnt lgkmcnt(7)
  buffer_load_dwordx4 v6, s[4:7], s24 offen lds
  v_mfma_f32_16x16x32_bf16 v[96:99], a[0:3], a[32:35], v[96:99]
  ds_read_b64_tr_b16 a[44:45], v17 offset:8192
  v_mfma_f32_16x16x32_bf16 v[100:103], a[4:7], a[32:35], v[100:103]
  ds_read_b64_tr_b16 a[46:47], v17 offset:14336
  v_mfma_f32_16x16x32_bf16 v[104:107], a[8:11], a[32:35], v[104:107]
  v_add_u32 v22, s27, v14
  v_mfma_f32_16x16x32_bf16 v[108:111], a[12:15], a[32:35], v[108:111]
  s_waitcnt lgkmcnt(6)
  buffer_load_dwordx4 v7, s[4:7], s24 offen offset:1024 lds
  v_mfma_f32_16x16x32_bf16 v[124:127], a[12:15], a[36:39], v[124:127]
  ds_read_b64_tr_b16 a[32:33], v16 offset:24576
  v_mfma_f32_16x16x32_bf16 v[120:123], a[8:11], a[36:39], v[120:123]
  ds_read_b64_tr_b16 a[34:35], v16 offset:26624
  v_mfma_f32_16x16x32_bf16 v[116:119], a[4:7], a[36:39], v[116:119]
  buffer_load_dwordx4 v8, s[4:7], s24 offen offset:2048 lds
  v_mfma_f32_16x16x32_bf16 v[112:115], a[0:3], a[36:39], v[112:115]
  s_waitcnt lgkmcnt(4)
  v_mfma_f32_16x16x32_bf16 v[32:35], a[40:43], a[16:19], v[32:35]
  ds_read_b64_tr_b16 a[36:37], v17 offset:24576
  v_mfma_f32_16x16x32_bf16 v[36:39], a[40:43], a[20:23], v[36:39]
  ds_read_b64_tr_b16 a[38:39], v17 offset:26624
  v_mfma_f32_16x16x32_bf16 v[40:43], a[40:43], a[24:27], v[40:43]
  buffer_load_dwordx4 v9, s[4:7], s24 offen offset:3072 lds
  v_mfma_f32_16x16x32_bf16 v[44:47], a[40:43], a[28:31], v[44:47]
  s_waitcnt lgkmcnt(4)
  v_add_u32 v23, s27, v15
  v_mfma_f32_16x16x32_bf16 v[60:63], a[44:47], a[28:31], v[60:63]
  ds_read_b64_tr_b16 a[40:41], v16 offset:36864
  v_mfma_f32_16x16x32_bf16 v[56:59], a[44:47], a[24:27], v[56:59]
  s_add_u32 m0, s26, 8192
  ds_read_b64_tr_b16 a[42:43], v16 offset:38912
  v_mfma_f32_16x16x32_bf16 v[52:55], a[44:47], a[20:23], v[52:55]
  buffer_load_dwordx4 v10, s[4:7], s24 offen lds
  v_mfma_f32_16x16x32_bf16 v[48:51], a[44:47], a[16:19], v[48:51]
  s_waitcnt vmcnt(9) lgkmcnt(4)
  s_barrier
  v_mfma_f32_16x16x32_bf16 v[64:67], a[32:35], a[16:19], v[64:67]
  ds_read_b64_tr_b16 a[44:45], v17 offset:36864
  ds_read_b128 a[0:3], v22 offset:0
  v_mfma_f32_16x16x32_bf16 v[68:71], a[32:35], a[20:23], v[68:71]
  ds_read_b64_tr_b16 a[46:47], v17 offset:38912
  v_mfma_f32_16x16x32_bf16 v[72:75], a[32:35], a[24:27], v[72:75]
  ds_read_b128 a[4:7], v22 offset:2048
  v_mfma_f32_16x16x32_bf16 v[76:79], a[32:35], a[28:31], v[76:79]
  s_waitcnt lgkmcnt(6)
  buffer_load_dwordx4 v11, s[4:7], s24 offen offset:1024 lds
  s_add_u32 s24, s24, 393216
  v_mfma_f32_16x16x32_bf16 v[92:95], a[36:39], a[28:31], v[92:95]
  s_add_u32 s25, s25, 128
  ds_read_b64_tr_b16 a[32:33], v20 offset:4096
  ds_read_b128 a[8:11], v22 offset:10240
  v_mfma_f32_16x16x32_bf16 v[88:91], a[36:39], a[24:27], v[88:91]
  s_add_u32 s26, s26, 40960
  ds_read_b64_tr_b16 a[34:35], v20 offset:6144
  v_mfma_f32_16x16x32_bf16 v[84:87], a[36:39], a[20:23], v[84:87]
  s_cmp_ge_u32 s26, s29
  ds_read_b128 a[12:15], v22 offset:12288
  s_cselect_b32 s26, s23, s26
  v_mfma_f32_16x16x32_bf16 v[80:83], a[36:39], a[16:19], v[80:83]
  s_waitcnt lgkmcnt(8)
  v_mfma_f32_16x16x32_bf16 v[96:99], a[16:19], a[40:43], v[96:99]
  ds_read_b64_tr_b16 a[36:37], v21 offset:4096
  v_mfma_f32_16x16x32_bf16 v[100:103], a[20:23], a[40:43], v[100:103]
  ds_read_b64_tr_b16 a[38:39], v21 offset:6144
  v_mfma_f32_16x16x32_bf16 v[104:107], a[24:27], a[40:43], v[104:107]
  v_mfma_f32_16x16x32_bf16 v[108:111], a[28:31], a[40:43], v[108:111]
  s_waitcnt lgkmcnt(7)
  v_mfma_f32_16x16x32_bf16 v[124:127], a[28:31], a[44:47], v[124:127]
  ds_read_b64_tr_b16 a[40:41], v20 offset:16384
  v_mfma_f32_16x16x32_bf16 v[120:123], a[24:27], a[44:47], v[120:123]
  ds_read_b64_tr_b16 a[42:43], v20 offset:18432
  v_mfma_f32_16x16x32_bf16 v[116:119], a[20:23], a[44:47], v[116:119]
  v_mfma_f32_16x16x32_bf16 v[112:115], a[16:19], a[44:47], v[112:115]
  s_waitcnt lgkmcnt(4)
  v_mfma_f32_16x16x32_bf16 v[32:35], a[32:35], a[0:3], v[32:35]
  s_add_u32 s27, s27, 40960
  ds_read_b64_tr_b16 a[44:45], v21 offset:16384
  s_sub_u32 s28, s28, 1
  v_mfma_f32_16x16x32_bf16 v[36:39], a[32:35], a[4:7], v[36:39]
  s_cmp_ge_u32 s27, 163840
  ds_read_b64_tr_b16 a[46:47], v21 offset:18432
  s_cselect_b32 s27, 0, s27
  v_mfma_f32_16x16x32_bf16 v[40:43], a[32:35], a[8:11], v[40:43]
  s_mov_b32 m0, s26
  ds_read_b128 a[16:19], v23 offset:0
  v_mfma_f32_16x16x32_bf16 v[44:47], a[32:35], a[12:15], v[44:47]
  s_waitcnt lgkmcnt(5)
  buffer_load_dwordx4 v2, s[8:11], s25 offen lds
  v_mfma_f32_16x16x32_bf16 v[60:63], a[36:39], a[12:15], v[60:63]
  ds_read_b64_tr_b16 a[32:33], v20 offset:28672
  v_mfma_f32_16x16x32_bf16 v[56:59], a[36:39], a[8:11], v[56:59]
  ds_read_b64_tr_b16 a[34:35], v20 offset:34816
  v_mfma_f32_16x16x32_bf16 v[52:55], a[36:39], a[4:7], v[52:55]
  ds_read_b128 a[20:23], v23 offset:2048
  v_mfma_f32_16x16x32_bf16 v[48:51], a[36:39], a[0:3], v[48:51]
  s_waitcnt lgkmcnt(6)
  buffer_load_dwordx4 v3, s[8:11], s25 offen offset:1024 lds
  v_mfma_f32_16x16x32_bf16 v[64:67], a[40:43], a[0:3], v[64:67]
  ds_read_b64_tr_b16 a[36:37], v21 offset:28672
  v_mfma_f32_16x16x32_bf16 v[68:71], a[40:43], a[4:7], v[68:71]
  ds_read_b64_tr_b16 a[38:39], v21 offset:34816
  buffer_load_dwordx4 v4, s[8:11], s25 offen offset:2048 lds
  v_mfma_f32_16x16x32_bf16 v[72:75], a[40:43], a[8:11], v[72:75]
  ds_read_b128 a[24:27], v23 offset:10240
  v_mfma_f32_16x16x32_bf16 v[76:79], a[40:43], a[12:15], v[76:79]
  s_waitcnt lgkmcnt(7)
  v_add_u32 v16, s27, v12
  v_mfma_f32_16x16x32_bf16 v[92:95], a[44:47], a[12:15], v[92:95]
  ds_read_b64_tr_b16 a[40:41], v20 offset:8192
  buffer_load_dwordx4 v5, s[8:11], s25 offen offset:3072 lds
  v_mfma_f32_16x16x32_bf16 v[88:91], a[44:47], a[8:11], v[88:91]
  ds_read_b64_tr_b16 a[42:43], v20 offset:14336
  v_add_u32 v17, s27, v13
  v_mfma_f32_16x16x32_bf16 v[84:87], a[44:47], a[4:7], v[84:87]
  s_add_u32 m0, s26, 4096
  ds_read_b128 a[28:31], v23 offset:12288
  v_mfma_f32_16x16x32_bf16 v[80:83], a[44:47], a[0:3], v[80:83]
  s_waitcnt lgkmcnt(7)
  buffer_load_dwordx4 v6, s[4:7], s24 offen lds
  v_mfma_f32_16x16x32_bf16 v[96:99], a[0:3], a[32:35], v[96:99]
  ds_read_b64_tr_b16 a[44:45], v21 offset:8192
  v_mfma_f32_16x16x32_bf16 v[100:103], a[4:7], a[32:35], v[100:103]
  ds_read_b64_tr_b16 a[46:47], v21 offset:14336
  v_mfma_f32_16x16x32_bf16 v[104:107], a[8:11], a[32:35], v[104:107]
  v_add_u32 v18, s27, v14
  v_mfma_f32_16x16x32_bf16 v[108:111], a[12:15], a[32:35], v[108:111]
  s_waitcnt lgkmcnt(6)
  buffer_load_dwordx4 v7, s[4:7], s24 offen offset:1024 lds
  v_mfma_f32_16x16x32_bf16 v[124:127], a[12:15], a[36:39], v[124:127]
  ds_read_b64_tr_b16 a[32:33], v20 offset:24576
  v_mfma_f32_16x16x32_bf16 v[120:123], a[8:11], a[36:39], v[120:123]
  ds_read_b64_tr_b16 a[34:35], v20 offset:26624
  v_mfma_f32_16x16x32_bf16 v[116:119], a[4:7], a[36:39], v[116:119]
  buffer_load_dwordx4 v8, s[4:7], s24 offen offset:2048 lds
  v_mfma_f32_16x16x32_bf16 v[112:115], a[0:3], a[36:39], v[112:115]
  s_waitcnt lgkmcnt(4)
  v_mfma_f32_16x16x32_bf16 v[32:35], a[40:43], a[16:19], v[32:35]
  ds_read_b64_tr_b16 a[36:37], v21 offset:24576
  v_mfma_f32_16x16x32_bf16 v[36:39], a[40:43], a[20:23], v[36:39]
  ds_read_b64_tr_b16 a[38:39], v21 offset:26624
  v_mfma_f32_16x16x32_bf16 v[40:43], a[40:43], a[24:27], v[40:43]
  buffer_load_dwordx4 v9, s[4:7], s24 offen offset:3072 lds
  v_mfma_f32_16x16x32_bf16 v[44:47], a[40:43], a[28:31], v[44:47]
  s_waitcnt lgkmcnt(4)
  v_add_u32 v19, s27, v15
  v_mfma_f32_16x16x32_bf16 v[60:63], a[44:47], a[28:31], v[60:63]
  ds_read_b64_tr_b16 a[40:41], v20 offset:36864
  v_mfma_f32_16x16x32_bf16 v[56:59], a[44:47], a[24:27], v[56:59]
  s_add_u32 m0, s26, 8192
  ds_read_b64_tr_b16 a[42:43], v20 offset:38912
  v_mfma_f32_16x16x32_bf16 v[52:55], a[44:47], a[20:23], v[52:55]
  buffer_load_dwordx4 v10, s[4:7], s24 offen lds
  v_mfma_f32_16x16x32_bf16 v[48:51], a[44:47], a[16:19], v[48:51]
  s_waitcnt vmcnt(9) lgkmcnt(4)
  s_barrier
  v_mfma_f32_16x16x32_bf16 v[64:67], a[32:35], a[16:19], v[64:67]
  ds_read_b64_tr_b16 a[44:45], v21 offset:36864
  ds_read_b128 a[0:3], v18 offset:0
  v_mfma_f32_16x16x32_bf16 v[68:71], a[32:35], a[20:23], v[68:71]
  ds_read_b64_tr_b16 a[46:47], v21 offset:38912
  v_mfma_f32_16x16x32_bf16 v[72:75], a[32:35], a[24:27], v[72:75]
  ds_read_b128 a[4:7], v18 offset:2048
  v_mfma_f32_16x16x32_bf16 v[76:79], a[32:35], a[28:31], v[76:79]
  s_waitcnt lgkmcnt(6)
  buffer_load_dwordx4 v11, s[4:7], s24 offen offset:1024 lds
  s_add_u32 s24, s24, 393216
  v_mfma_f32_16x16x32_bf16 v[92:95], a[36:39], a[28:31], v[92:95]
  s_add_u32 s25, s25, 128
  ds_read_b64_tr_b16 a[32:33], v16 offset:4096
  ds_read_b128 a[8:11], v18 offset:10240
  v_mfma_f32_16x16x32_bf16 v[88:91], a[36:39], a[24:27], v[88:91]
  s_add_u32 s26, s26, 40960
  ds_read_b64_tr_b16 a[34:35], v16 offset:6144
  v_mfma_f32_16x16x32_bf16 v[84:87], a[36:39], a[20:23], v[84:87]
  s_cmp_ge_u32 s26, s29
  ds_read_b128 a[12:15], v18 offset:12288
  s_cselect_b32 s26, s23, s26
  v_mfma_f32_16x16x32_bf16 v[80:83], a[36:39], a[16:19], v[80:83]
  s_waitcnt lgkmcnt(8)
  v_mfma_f32_16x16x32_bf16 v[96:99], a[16:19], a[40:43], v[96:99]
  ds_read_b64_tr_b16 a[36:37], v17 offset:4096
  v_mfma_f32_16x16x32_bf16 v[100:103], a[20:23], a[40:43], v[100:103]
  ds_read_b64_tr_b16 a[38:39], v17 offset:6144
  v_mfma_f32_16x16x32_bf16 v[104:107], a[24:27], a[40:43], v[104:107]
  v_mfma_f32_16x16x32_bf16 v[108:111], a[28:31], a[40:43], v[108:111]
  s_waitcnt lgkmcnt(7)
  v_mfma_f32_16x16x32_bf16 v[124:127], a[28:31], a[44:47], v[124:127]
  ds_read_b64_tr_b16 a[40:41], v16 offset:16384
  v_mfma_f32_16x16x32_bf16 v[120:123], a[24:27], a[44:47], v[120:123]
  ds_read_b64_tr_b16 a[42:43], v16 offset:18432
  v_mfma_f32_16x16x32_bf16 v[116:119], a[20:23], a[44:47], v[116:119]
  v_mfma_f32_16x16x32_bf16 v[112:115], a[16:19], a[44:47], v[112:115]
  s_waitcnt lgkmcnt(4)
  s_bitcmp1_b32 103, s28
  s_cbranch_scc0 L_k1_loop
  s_cmp_lg_u32 s28, 6
  s_cbranch_scc1 L_k1_loop_n6
  v_mfma_f32_16x16x32_bf16 v[180:183], v[176:179], v[144:147], 0
  v_mfma_f32_16x16x32_bf16 v[180:183], v[176:179], v[148:151], v[180:183]
  v_mfma_f32_16x16x32_bf16 v[180:183], v[176:179], v[152:155], v[180:183]
  v_mfma_f32_16x16x32_bf16 v[180:183], v[176:179], v[156:159], v[180:183]
  v_mfma_f32_16x16x32_bf16 v[180:183], v[176:179], v[160:163], v[180:183]
  v_mfma_f32_16x16x32_bf16 v[180:183], v[176:179], v[164:167], v[180:183]
  v_mfma_f32_16x16x32_bf16 v[180:183], v[176:179], v[168:171], v[180:183]
  v_mfma_f32_16x16x32_bf16 v[180:183], v[176:179], v[172:175], v[180:183]
  s_nop 7
  s_cmp_eq_u32 s20, 3
  s_cbranch_scc1 L_p1_wo
  v_add_f32_dpp v180, v180, v180 row_ror:8 row_mask:0xf bank_mask:0xf
  v_add_f32_dpp v181, v181, v181 row_ror:8 row_mask:0xf bank_mask:0xf
  v_add_f32_dpp v182, v182, v182 row_ror:8 row_mask:0xf bank_mask:0xf
  v_add_f32_dpp v183, v183, v183 row_ror:8 row_mask:0xf bank_mask:0xf
  v_lshlrev_b32 v28, 5, v24
  v_lshl_add_u32 v28, v25, 4, v28
  s_mul_i32 s30, s21, 12288
  s_mul_i32 s31, s22, 768
  s_add_u32 s30, s30, s31
  s_lshl_b32 s31, s20, 8
  s_add_u32 s30, s30, s31
  s_add_u32 s30, s30, 163840
  s_mov_b32 exec_lo, 0x00ff00ff
  s_mov_b32 exec_hi, 0
  buffer_store_dwordx4 v[180:183], v28, s[12:15], s30 offen sc1
  s_branch L_p1_ad
L_p1_wo:
  v_add_f32_dpp v180, v180, v180 row_ror:4 row_mask:0xf bank_mask:0xf
  s_nop 1
  v_add_f32_dpp v180, v180, v180 row_ror:8 row_mask:0xf bank_mask:0xf
  v_mul_f32 v28, 0x3a800000, v180
  v_cvt_pk_bf16_f32 v29, v28, v28
  v_lshlrev_b32 v30, 16, v29
  v_sub_f32 v30, v28, v30
  v_cvt_pk_bf16_f32 v30, v30, v30
  v_cmp_eq_u32 vcc, 1, v25
  s_nop 1
  v_cndmask_b32 v29, v29, v30, vcc
  v_lshlrev_b32 v28, 1, v24
  v_lshl_add_u32 v28, v25, 6, v28
  s_lshr_b32 s30, s2, 3
  s_lshl_b32 s30, s30, 7
  s_and_b32 s31, s2, 3
  s_lshl_b32 s31, s31, 4
  s_add_u32 s30, s30, s31
  s_and_b32 s31, s2, 4
  s_lshl_b32 s31, s31, 1
  s_add_u32 s30, s30, s31
  s_add_u32 s30, s30, 16384
  s_mov_b32 exec_lo, 0x000f000f
  s_mov_b32 exec_hi, 0
  buffer_store_short v29, v28, s[12:15], s30 offen sc1
L_p1_ad:
  s_mov_b64 exec, -1
  s_branch L_k1_loop
L_k1_loop_n6:
  s_cmp_lg_u32 s28, 5
  s_cbranch_scc1 L_k1_loop_n5
  s_cmp_lg_u32 s20, 0
  s_cbranch_scc1 L_p1_b
  s_and_b32 s30, s2, 3
  s_mul_i32 s30, s30, 64
  v_mov_b32 v30, s30
  v_mov_b32 v31, 1
  s_mov_b64 exec, 1
  global_atomic_add v30, v31, s[60:61] sc1
  s_mov_b64 exec, -1
L_p1_b:
  s_branch L_k1_loop
L_k1_loop_n5:
  s_cmp_lg_u32 s28, 2
  s_cbranch_scc1 L_k1_loop_n2
  v_and_b32 v30, 3, v1
  v_mul_u32_u24 v30, 64, v30
  global_load_dword v31, v30, s[60:61] sc1
  s_branch L_k1_loop
L_k1_loop_n2:
  s_cmp_lg_u32 s28, 1
  s_cbranch_scc1 L_k1_loop_n1
  s_mov_b32 s31, 0x40000
L_p1_poll:
  v_cmp_gt_u32 vcc, 64, v31
  s_sub_u32 s31, s31, 1
  s_cbranch_scc1 L_p1_have
  s_cbranch_vccz L_p1_have
  global_load_dword v31, v30, s[60:61] sc1
  s_waitcnt vmcnt(0)
  s_branch L_p1_poll
L_p1_have:
  s_cmp_eq_u32 s20, 3
  s_cbranch_scc1 L_p1_c3
  v_lshlrev_b32 v28, 2, v1
  s_mul_i32 s30, s22, 768
  s_lshl_b32 s31, s20, 8
  s_add_u32 s30, s30, s31
  s_add_u32 s30, s30, 163840
  buffer_load_dword v128, v28, s[12:15], s30 offen sc1
  s_add_u32 s30, s30, 12288
  buffer_load_dword v129, v28, s[12:15], s30 offen sc1
  s_add_u32 s30, s30, 12288
  buffer_load_dword v130, v28, s[12:15], s30 offen sc1
  s_add_u32 s30, s30, 12288
  buffer_load_dword v131, v28, s[12:15], s30 offen sc1
  s_add_u32 s30, s30, 12288
  buffer_load_dword v132, v28, s[12:15], s30 offen sc1
  s_add_u32 s30, s30, 12288
  buffer_load_dword v133, v28, s[12:15], s30 offen sc1
  s_add_u32 s30, s30, 12288
  buffer_load_dword v134, v28, s[12:15], s30 offen sc1
  s_add_u32 s30, s30, 12288
  buffer_load_dword v135, v28, s[12:15], s30 offen sc1
  s_add_u32 s30, s30, 12288
  buffer_load_dword v136, v28, s[12:15], s30 offen sc1
  s_add_u32 s30, s30, 12288
  buffer_load_dword v137, v28, s[12:15], s30 offen sc1
  s_add_u32 s30, s30, 12288
  buffer_load_dword v138, v28, s[12:15], s30 offen sc1
  s_add_u32 s30, s30, 12288
  buffer_load_dword v139, v28, s[12:15], s30 offen sc1
  s_add_u32 s30, s30, 12288
  buffer_load_dword v140, v28, s[12:15], s30 offen sc1
  s_add_u32 s30, s30, 12288
  buffer_load_dword v141, v28, s[12:15], s30 offen sc1
  s_add_u32 s30, s30, 12288
  buffer_load_dword v142, v28, s[12:15], s30 offen sc1
  s_add_u32 s30, s30, 12288
  buffer_load_dword v143, v28, s[12:15], s30 offen sc1
  s_add_u32 s30, s30, 12288
  s_branch L_p1_cd
L_p1_c3:
  v_lshlrev_b32 v28, 3, v1
  s_lshl_b32 s30, s21, 9
  s_add_u32 s31, s30, 24576
  buffer_load_dwordx2 v[128:129], v28, s[12:15], s30 offen offset:0 sc1
  buffer_load_dwordx2 v[130:131], v28, s[12:15], s31 offen sc1
L_p1_cd:
  s_branch L_k1_loop
L_k1_loop_n1:
L_c1:
  s_cmp_eq_u32 s20, 3
  s_cbranch_scc1 L_p1_s3
  v_add_f32 v128, v128, v129
  v_add_f32 v130, v130, v131
  v_add_f32 v128, v128, v130
  v_add_f32 v132, v132, v133
  v_add_f32 v134, v134, v135
  v_add_f32 v132, v132, v134
  v_add_f32 v136, v136, v137
  v_add_f32 v138, v138, v139
  v_add_f32 v136, v136, v138
  v_add_f32 v140, v140, v141
  v_add_f32 v142, v142, v143
  v_add_f32 v140, v140, v142
  v_add_f32 v128, v128, v132
  v_add_f32 v136, v136, v140
  v_add_f32 v128, v128, v136
  v_lshlrev_b32 v28, 2, v0
  ds_write_b32 v28, v128
  s_branch L_p1_sd
L_p1_s3:
  ds_write_b64 v28, v[128:129] offset:1024
  ds_write_b64 v28, v[130:131] offset:1536
L_p1_sd:
  s_lshl_b32 s30, s45, 7
  v_lshl_add_u32 v2, v25, 4, s30
  v_lshl_add_u32 v3, v24, 2, s30
  s_lshl_b32 s30, s44, 8
  v_lshl_add_u32 v4, v24, 2, s30
  v_lshl_add_u32 v5, v25, 4, s30
  v_lshlrev_b32 v28, 9, v25
  v_lshl_add_u32 v6, v24, 4, v28
  v_and_b32 v7, 7, v24
  v_lshl_add_u32 v7, v7, 4, v28
  v_lshrrev_b32 v29, 3, v24
  v_lshl_add_u32 v7, v29, 8, v7
  s_lshl_b32 s30, s45, 17
  s_lshl_b32 s31, s21, 13
  s_add_u32 s30, s30, s31
  s_lshl_b32 s31, s44, 12
  s_add_u32 s30, s30, s31
  s_bfe_u32 s31, s46, 262144
  s_lshl_b32 s31, s31, 18
  s_add_u32 s36, s30, s31
  s_bfe_u32 s31, s46, 262152
  s_lshl_b32 s31, s31, 18
  s_add_u32 s37, s30, s31
  s_add_u32 s37, s37, 4194304
  s_bfe_u32 s31, s46, 262160
  s_lshl_b32 s31, s31, 18
  s_add_u32 s38, s30, s31
  s_add_u32 s38, s38, 8388608
  s_waitcnt lgkmcnt(0)
  s_add_u32 s27, s27, 40960
  s_cmp_ge_u32 s27, 163840
  s_cselect_b32 s27, 0, s27
  v_add_u32 v20, s27, v12
  v_add_u32 v21, s27, v13
  v_add_u32 v22, s27, v14
  v_add_u32 v23, s27, v15
  v_mfma_f32_16x16x32_bf16 v[32:35], a[32:35], a[0:3], v[32:35]
  ds_read_b64_tr_b16 a[44:45], v17 offset:16384
  v_mfma_f32_16x16x32_bf16 v[36:39], a[32:35], a[4:7], v[36:39]
  ds_read_b64_tr_b16 a[46:47], v17 offset:18432
  v_mfma_f32_16x16x32_bf16 v[40:43], a[32:35], a[8:11], v[40:43]
  ds_read_b128 a[16:19], v19 offset:0
  v_mfma_f32_16x16x32_bf16 v[44:47], a[32:35], a[12:15], v[44:47]
  s_waitcnt lgkmcnt(5)
  ds_read_b128 a[20:23], v19 offset:2048
  v_mfma_f32_16x16x32_bf16 v[60:63], a[36:39], a[12:15], v[60:63]
  ds_read_b64_tr_b16 a[32:33], v16 offset:28672
  v_mfma_f32_16x16x32_bf16 v[56:59], a[36:39], a[8:11], v[56:59]
  ds_read_b64_tr_b16 a[34:35], v16 offset:34816
  v_mfma_f32_16x16x32_bf16 v[52:55], a[36:39], a[4:7], v[52:55]
  ds_read_b128 a[24:27], v19 offset:10240
  v_mfma_f32_16x16x32_bf16 v[48:51], a[36:39], a[0:3], v[48:51]
  s_waitcnt lgkmcnt(7)
  ds_read_b128 a[28:31], v19 offset:12288
  v_mfma_f32_16x16x32_bf16 v[64:67], a[40:43], a[0:3], v[64:67]
  ds_read_b64_tr_b16 a[36:37], v17 offset:28672
  v_mfma_f32_16x16x32_bf16 v[68:71], a[40:43], a[4:7], v[68:71]
  ds_read_b64_tr_b16 a[38:39], v17 offset:34816
  v_mfma_f32_16x16x32_bf16 v[72:75], a[40:43], a[8:11], v[72:75]
  v_mfma_f32_16x16x32_bf16 v[76:79], a[40:43], a[12:15], v[76:79]
  s_waitcnt lgkmcnt(8)
  v_mfma_f32_16x16x32_bf16 v[92:95], a[44:47], a[12:15], v[92:95]
  ds_read_b64_tr_b16 a[40:41], v16 offset:8192
  v_mfma_f32_16x16x32_bf16 v[88:91], a[44:47], a[8:11], v[88:91]
  ds_read_b64_tr_b16 a[42:43], v16 offset:14336
  v_mfma_f32_16x16x32_bf16 v[84:87], a[44:47], a[4:7], v[84:87]
  v_mfma_f32_16x16x32_bf16 v[80:83], a[44:47], a[0:3], v[80:83]
  s_waitcnt lgkmcnt(6)
  v_mfma_f32_16x16x32_bf16 v[96:99], a[0:3], a[32:35], v[96:99]
  ds_read_b64_tr_b16 a[44:45], v17 offset:8192
  v_mfma_f32_16x16x32_bf16 v[100:103], a[4:7], a[32:35], v[100:103]
  ds_read_b64_tr_b16 a[46:47], v17 offset:14336
  v_mfma_f32_16x16x32_bf16 v[104:107], a[8:11], a[32:35], v[104:107]
  v_mfma_f32_16x16x32_bf16 v[108:111], a[12:15], a[32:35], v[108:111]
  s_waitcnt lgkmcnt(4)
  v_mfma_f32_16x16x32_bf16 v[124:127], a[12:15], a[36:39], v[124:127]
  ds_read_b64_tr_b16 a[32:33], v16 offset:24576
  v_mfma_f32_16x16x32_bf16 v[120:123], a[8:11], a[36:39], v[120:123]
  ds_read_b64_tr_b16 a[34:35], v16 offset:26624
  v_mfma_f32_16x16x32_bf16 v[116:119], a[4:7], a[36:39], v[116:119]
  v_mfma_f32_16x16x32_bf16 v[112:115], a[0:3], a[36:39], v[112:115]
  s_waitcnt lgkmcnt(4)
  s_waitcnt vmcnt(0)
  s_barrier
  v_mfma_f32_16x16x32_bf16 v[32:35], a[40:43], a[16:19], v[32:35]
  ds_read_b64_tr_b16 a[36:37], v17 offset:24576
  v_mfma_f32_16x16x32_bf16 v[36:39], a[40:43], a[20:23], v[36:39]
  ds_read_b64_tr_b16 a[38:39], v17 offset:26624
  v_mfma_f32_16x16x32_bf16 v[40:43], a[40:43], a[24:27], v[40:43]
  ds_read_b128 a[48:51], v22 offset:0
  v_mfma_f32_16x16x32_bf16 v[44:47], a[40:43], a[28:31], v[44:47]
  s_waitcnt lgkmcnt(5)
  ds_read_b128 a[52:55], v22 offset:2048
  v_mfma_f32_16x16x32_bf16 v[60:63], a[44:47], a[28:31], v[60:63]
  ds_read_b64_tr_b16 a[40:41], v20 offset:4096
  v_mfma_f32_16x16x32_bf16 v[56:59], a[44:47], a[24:27], v[56:59]
  ds_read_b64_tr_b16 a[42:43], v20 offset:6144
  v_mfma_f32_16x16x32_bf16 v[52:55], a[44:47], a[20:23], v[52:55]
  ds_read_b128 a[56:59], v22 offset:10240
  v_mfma_f32_16x16x32_bf16 v[48:51], a[44:47], a[16:19], v[48:51]
  s_waitcnt lgkmcnt(7)
  ds_read_b128 a[60:63], v22 offset:12288
  v_mfma_f32_16x16x32_bf16 v[64:67], a[32:35], a[16:19], v[64:67]
  ds_read_b64_tr_b16 a[44:45], v21 offset:4096
  v_mfma_f32_16x16x32_bf16 v[68:71], a[32:35], a[20:23], v[68:71]
  ds_read_b64_tr_b16 a[46:47], v21 offset:6144
  v_mfma_f32_16x16x32_bf16 v[72:75], a[32:35], a[24:27], v[72:75]
  ds_read_b128 a[64:67], v23 offset:0
  v_mfma_f32_16x16x32_bf16 v[76:79], a[32:35], a[28:31], v[76:79]
  s_waitcnt lgkmcnt(9)
  ds_read_b128 a[68:71], v23 offset:2048
  v_mfma_f32_16x16x32_bf16 v[92:95], a[36:39], a[28:31], v[92:95]
  ds_read_b64_tr_b16 a[32:33], v20 offset:8192
  v_mfma_f32_16x16x32_bf16 v[88:91], a[36:39], a[24:27], v[88:91]
  ds_read_b64_tr_b16 a[34:35], v20 offset:14336
  v_mfma_f32_16x16x32_bf16 v[84:87], a[36:39], a[20:23], v[84:87]
  ds_read_b128 a[72:75], v23 offset:10240
  v_mfma_f32_16x16x32_bf16 v[80:83], a[36:39], a[16:19], v[80:83]
  s_waitcnt lgkmcnt(7)
  ds_read_b128 a[76:79], v23 offset:12288
  v_mfma_f32_16x16x32_bf16 v[32:35], a[40:43], a[48:51], v[32:35]
  ds_read_b64_tr_b16 a[36:37], v21 offset:8192
  v_mfma_f32_16x16x32_bf16 v[36:39], a[40:43], a[52:55], v[36:39]
  ds_read_b64_tr_b16 a[38:39], v21 offset:14336
  v_mfma_f32_16x16x32_bf16 v[40:43], a[40:43], a[56:59], v[40:43]
  ds_read_b128 v[144:147], v2 offset:0
  v_mfma_f32_16x16x32_bf16 v[44:47], a[40:43], a[60:63], v[44:47]
  s_waitcnt lgkmcnt(9)
  ds_read_b128 v[148:151], v2 offset:64
  v_mfma_f32_16x16x32_bf16 v[60:63], a[44:47], a[60:63], v[60:63]
  ds_read_b64_tr_b16 a[40:41], v20 offset:16384
  v_mfma_f32_16x16x32_bf16 v[56:59], a[44:47], a[56:59], v[56:59]
  ds_read_b64_tr_b16 a[42:43], v20 offset:18432
  v_mfma_f32_16x16x32_bf16 v[52:55], a[44:47], a[52:55], v[52:55]
  ds_read_b128 v[152:155], v2 offset:256
  v_mfma_f32_16x16x32_bf16 v[48:51], a[44:47], a[48:51], v[48:51]
  s_waitcnt lgkmcnt(7)
  ds_read_b128 v[156:159], v2 offset:320
  v_mfma_f32_16x16x32_bf16 v[32:35], a[32:35], a[64:67], v[32:35]
  ds_read_b64_tr_b16 a[44:45], v21 offset:16384
  v_mfma_f32_16x16x32_bf16 v[36:39], a[32:35], a[68:71], v[36:39]
  ds_read_b64_tr_b16 a[46:47], v21 offset:18432
  v_mfma_f32_16x16x32_bf16 v[40:43], a[32:35], a[72:75], v[40:43]
  ds_read_b32 v162, v4 offset:1024
  v_mfma_f32_16x16x32_bf16 v[44:47], a[32:35], a[76:79], v[44:47]
  s_waitcnt lgkmcnt(9)
  ds_read_b32 v163, v4 offset:1088
  v_mfma_f32_16x16x32_bf16 v[60:63], a[36:39], a[76:79], v[60:63]
  ds_read_b64_tr_b16 a[32:33], v20 offset:24576
  v_mfma_f32_16x16x32_bf16 v[56:59], a[36:39], a[72:75], v[56:59]
  ds_read_b64_tr_b16 a[34:35], v20 offset:26624
  v_mfma_f32_16x16x32_bf16 v[52:55], a[36:39], a[68:71], v[52:55]
  ds_read_b32 v164, v4 offset:1152
  v_mfma_f32_16x16x32_bf16 v[48:51], a[36:39], a[64:67], v[48:51]
  s_waitcnt lgkmcnt(9)
  ds_read_b32 v165, v4 offset:1216
  v_mfma_f32_16x16x32_bf16 v[64:67], a[40:43], a[48:51], v[64:67]
  ds_read_b64_tr_b16 a[36:37], v21 offset:24576
  v_mfma_f32_16x16x32_bf16 v[68:71], a[40:43], a[52:55], v[68:71]
  ds_read_b64_tr_b16 a[38:39], v21 offset:26624
  v_mfma_f32_16x16x32_bf16 v[72:75], a[40:43], a[56:59], v[72:75]
  ds_read_b32 v166, v4 offset:1536
  v_mfma_f32_16x16x32_bf16 v[76:79], a[40:43], a[60:63], v[76:79]
  s_waitcnt lgkmcnt(9)
  ds_read_b32 v167, v4 offset:1600
  v_mfma_f32_16x16x32_bf16 v[92:95], a[44:47], a[60:63], v[92:95]
  ds_read_b64_tr_b16 a[40:41], v16 offset:36864
  v_mfma_f32_16x16x32_bf16 v[88:91], a[44:47], a[56:59], v[88:91]
  ds_read_b64_tr_b16 a[42:43], v16 offset:38912
  v_mfma_f32_16x16x32_bf16 v[84:87], a[44:47], a[52:55], v[84:87]
  ds_read_b32 v168, v4 offset:1664
  v_mfma_f32_16x16x32_bf16 v[80:83], a[44:47], a[48:51], v[80:83]
  s_waitcnt lgkmcnt(9)
  ds_read_b32 v169, v4 offset:1728
  v_mfma_f32_16x16x32_bf16 v[64:67], a[32:35], a[64:67], v[64:67]
  ds_read_b64_tr_b16 a[44:45], v17 offset:36864
  v_mfma_f32_16x16x32_bf16 v[68:71], a[32:35], a[68:71], v[68:71]
  ds_read_b64_tr_b16 a[46:47], v17 offset:38912
  v_mfma_f32_16x16x32_bf16 v[72:75], a[32:35], a[72:75], v[72:75]
  v_mfma_f32_16x16x32_bf16 v[76:79], a[32:35], a[76:79], v[76:79]
  s_waitcnt lgkmcnt(8)
  s_waitcnt lgkmcnt(2)
  v_mfma_f32_16x16x32_bf16 v[92:95], a[36:39], a[76:79], v[92:95]
  ds_read_b64_tr_b16 a[32:33], v20 offset:28672
  v_mul_f32 v170, 0x3e8293ee, v166
  v_mfma_f32_16x16x32_bf16 v[88:91], a[36:39], a[72:75], v[88:91]
  ds_read_b64_tr_b16 a[34:35], v20 offset:34816
  v_mul_f32 v171, 0x3e8293ee, v167
  v_mfma_f32_16x16x32_bf16 v[84:87], a[36:39], a[68:71], v[84:87]
  v_mul_f32 v172, 0x3e8293ee, v168
  v_mul_f32 v173, 0x3e8293ee, v169
  v_mfma_f32_16x16x32_bf16 v[80:83], a[36:39], a[64:67], v[80:83]
  s_waitcnt lgkmcnt(6)
  v_fma_f32 v32, -v162, v144, v32
  v_mul_f32 v32, v32, v170
  v_mfma_f32_16x16x32_bf16 v[96:99], a[16:19], a[40:43], v[96:99]
  ds_read_b64_tr_b16 a[36:37], v21 offset:28672
  v_fma_f32 v33, -v162, v145, v33
  v_mfma_f32_16x16x32_bf16 v[100:103], a[20:23], a[40:43], v[100:103]
  ds_read_b64_tr_b16 a[38:39], v21 offset:34816
  v_mul_f32 v33, v33, v170
  v_mfma_f32_16x16x32_bf16 v[104:107], a[24:27], a[40:43], v[104:107]
  v_fma_f32 v34, -v162, v146, v34
  v_mul_f32 v34, v34, v170
  v_mfma_f32_16x16x32_bf16 v[108:111], a[28:31], a[40:43], v[108:111]
  s_waitcnt lgkmcnt(4)
  v_fma_f32 v35, -v162, v147, v35
  v_mul_f32 v35, v35, v170
  v_mfma_f32_16x16x32_bf16 v[124:127], a[28:31], a[44:47], v[124:127]
  ds_read_b64_tr_b16 a[40:41], v20 offset:36864
  v_fma_f32 v48, -v162, v148, v48
  v_mfma_f32_16x16x32_bf16 v[120:123], a[24:27], a[44:47], v[120:123]
  ds_read_b64_tr_b16 a[42:43], v20 offset:38912
  v_mul_f32 v48, v48, v170
  v_mfma_f32_16x16x32_bf16 v[116:119], a[20:23], a[44:47], v[116:119]
  v_fma_f32 v49, -v162, v149, v49
  v_mul_f32 v49, v49, v170
  v_mfma_f32_16x16x32_bf16 v[112:115], a[16:19], a[44:47], v[112:115]
  s_waitcnt lgkmcnt(4)
  v_fma_f32 v50, -v162, v150, v50
  v_mul_f32 v50, v50, v170
  v_mfma_f32_16x16x32_bf16 v[96:99], a[48:51], a[32:35], v[96:99]
  ds_read_b64_tr_b16 a[44:45], v21 offset:36864
  v_fma_f32 v51, -v162, v151, v51
  v_mfma_f32_16x16x32_bf16 v[100:103], a[52:55], a[32:35], v[100:103]
  ds_read_b64_tr_b16 a[46:47], v21 offset:38912
  v_mul_f32 v51, v51, v170
  v_mfma_f32_16x16x32_bf16 v[104:107], a[56:59], a[32:35], v[104:107]
  v_cvt_pk_bf16_f32 v208, v32, v33
  v_cvt_pk_bf16_f32 v209, v34, v35
  v_mfma_f32_16x16x32_bf16 v[108:111], a[60:63], a[32:35], v[108:111]
  s_waitcnt lgkmcnt(4)
  v_cvt_pk_bf16_f32 v210, v48, v49
  v_cvt_pk_bf16_f32 v211, v50, v51
  v_mfma_f32_16x16x32_bf16 v[124:127], a[60:63], a[36:39], v[124:127]
  buffer_store_dwordx4 v[208:211], v6, s[48:51], s36 offen offset:0 sc1
  v_mfma_f32_16x16x32_bf16 v[120:123], a[56:59], a[36:39], v[120:123]
  v_fma_f32 v36, -v163, v144, v36
  v_mul_f32 v36, v36, v171
  v_mfma_f32_16x16x32_bf16 v[116:119], a[52:55], a[36:39], v[116:119]
  v_fma_f32 v37, -v163, v145, v37
  v_mul_f32 v37, v37, v171
  v_mfma_f32_16x16x32_bf16 v[112:115], a[48:51], a[36:39], v[112:115]
  s_waitcnt lgkmcnt(2)
  v_fma_f32 v38, -v163, v146, v38
  v_mul_f32 v38, v38, v171
  v_mfma_f32_16x16x32_bf16 v[96:99], a[64:67], a[40:43], v[96:99]
  v_fma_f32 v39, -v163, v147, v39
  v_mul_f32 v39, v39, v171
  v_mfma_f32_16x16x32_bf16 v[100:103], a[68:71], a[40:43], v[100:103]
  v_fma_f32 v52, -v163, v148, v52
  v_mul_f32 v52, v52, v171
  v_mfma_f32_16x16x32_bf16 v[104:107], a[72:75], a[40:43], v[104:107]
  v_fma_f32 v53, -v163, v149, v53
  v_mul_f32 v53, v53, v171
  v_mfma_f32_16x16x32_bf16 v[108:111], a[76:79], a[40:43], v[108:111]
  s_waitcnt lgkmcnt(0)
  v_fma_f32 v54, -v163, v150, v54
  v_mul_f32 v54, v54, v171
  v_mfma_f32_16x16x32_bf16 v[124:127], a[76:79], a[44:47], v[124:127]
  v_fma_f32 v55, -v163, v151, v55
  v_mul_f32 v55, v55, v171
  v_mfma_f32_16x16x32_bf16 v[120:123], a[72:75], a[44:47], v[120:123]
  v_cvt_pk_bf16_f32 v212, v36, v37
  v_cvt_pk_bf16_f32 v213, v38, v39
  v_mfma_f32_16x16x32_bf16 v[116:119], a[68:71], a[44:47], v[116:119]
  v_cvt_pk_bf16_f32 v214, v52, v53
  v_cvt_pk_bf16_f32 v215, v54, v55
  v_mfma_f32_16x16x32_bf16 v[112:115], a[64:67], a[44:47], v[112:115]
  buffer_store_dwordx4 v[212:215], v6, s[48:51], s36 offen offset:256 sc1
  v_fma_f32 v40, -v164, v144, v40
  v_mul_f32 v40, v40, v172
  v_fma_f32 v41, -v164, v145, v41
  v_mul_f32 v41, v41, v172
  v_fma_f32 v42, -v164, v146, v42
  v_mul_f32 v42, v42, v172
  v_fma_f32 v43, -v164, v147, v43
  v_mul_f32 v43, v43, v172
  v_fma_f32 v56, -v164, v148, v56
  v_mul_f32 v56, v56, v172
  v_fma_f32 v57, -v164, v149, v57
  v_mul_f32 v57, v57, v172
  v_fma_f32 v58, -v164, v150, v58
  v_mul_f32 v58, v58, v172
  v_fma_f32 v59, -v164, v151, v59
  v_mul_f32 v59, v59, v172
  v_cvt_pk_bf16_f32 v216, v40, v41
  v_cvt_pk_bf16_f32 v217, v42, v43
  v_cvt_pk_bf16_f32 v218, v56, v57
  v_cvt_pk_bf16_f32 v219, v58, v59
  buffer_store_dwordx4 v[216:219], v6, s[48:51], s36 offen offset:2048 sc1
  v_fma_f32 v44, -v165, v144, v44
  v_mul_f32 v44, v44, v173
  v_fma_f32 v45, -v165, v145, v45
  v_mul_f32 v45, v45, v173
  v_fma_f32 v46, -v165, v146, v46
  v_mul_f32 v46, v46, v173
  v_fma_f32 v47, -v165, v147, v47
  v_mul_f32 v47, v47, v173
  v_fma_f32 v60, -v165, v148, v60
  v_mul_f32 v60, v60, v173
  v_fma_f32 v61, -v165, v149, v61
  v_mul_f32 v61, v61, v173
  v_fma_f32 v62, -v165, v150, v62
  v_mul_f32 v62, v62, v173
  v_fma_f32 v63, -v165, v151, v63
  v_mul_f32 v63, v63, v173
  v_cvt_pk_bf16_f32 v220, v44, v45
  v_cvt_pk_bf16_f32 v221, v46, v47
  v_cvt_pk_bf16_f32 v222, v60, v61
  v_cvt_pk_bf16_f32 v223, v62, v63
  buffer_store_dwordx4 v[220:223], v6, s[48:51], s36 offen offset:2304 sc1
  ds_read_b32 v160, v3 offset:512
  ds_read_b32 v161, v3 offset:576
  ds_read_b128 v[176:179], v5 offset:1024
  ds_read_b128 v[180:183], v5 offset:1088
  ds_read_b128 v[184:187], v5 offset:1152
  ds_read_b128 v[188:191], v5 offset:1216
  ds_read_b128 v[192:195], v5 offset:1536
  ds_read_b128 v[196:199], v5 offset:1600
  ds_read_b128 v[200:203], v5 offset:1664
  ds_read_b128 v[204:207], v5 offset:1728
  v_pk_fma_f32 v[64:65], v[152:153], v[162:163], v[64:65] op_sel:[0,0,0] op_sel_hi:[1,0,1] neg_lo:[0,1,0] neg_hi:[0,1,0]
  v_pk_mul_f32 v[64:65], v[64:65], v[166:167] op_sel:[0,0] op_sel_hi:[1,0]
  v_pk_fma_f32 v[66:67], v[154:155], v[162:163], v[66:67] op_sel:[0,0,0] op_sel_hi:[1,0,1] neg_lo:[0,1,0] neg_hi:[0,1,0]
  v_pk_mul_f32 v[66:67], v[66:67], v[166:167] op_sel:[0,0] op_sel_hi:[1,0]
  v_pk_fma_f32 v[80:81], v[156:157], v[162:163], v[80:81] op_sel:[0,0,0] op_sel_hi:[1,0,1] neg_lo:[0,1,0] neg_hi:[0,1,0]
  v_pk_mul_f32 v[80:81], v[80:81], v[166:167] op_sel:[0,0] op_sel_hi:[1,0]
  v_pk_fma_f32 v[82:83], v[158:159], v[162:163], v[82:83] op_sel:[0,0,0] op_sel_hi:[1,0,1] neg_lo:[0,1,0] neg_hi:[0,1,0]
  v_pk_mul_f32 v[82:83], v[82:83], v[166:167] op_sel:[0,0] op_sel_hi:[1,0]
  v_cvt_pk_bf16_f32 v224, v64, v65
  v_cvt_pk_bf16_f32 v225, v66, v67
  v_cvt_pk_bf16_f32 v226, v80, v81
  v_cvt_pk_bf16_f32 v227, v82, v83
  buffer_store_dwordx4 v[224:227], v7, s[48:51], s37 offen offset:0 sc1
  v_pk_fma_f32 v[68:69], v[152:153], v[162:163], v[68:69] op_sel:[0,1,0] op_sel_hi:[1,1,1] neg_lo:[0,1,0] neg_hi:[0,1,0]
  v_pk_mul_f32 v[68:69], v[68:69], v[166:167] op_sel:[0,1] op_sel_hi:[1,1]
  v_pk_fma_f32 v[70:71], v[154:155], v[162:163], v[70:71] op_sel:[0,1,0] op_sel_hi:[1,1,1] neg_lo:[0,1,0] neg_hi:[0,1,0]
  v_pk_mul_f32 v[70:71], v[70:71], v[166:167] op_sel:[0,1] op_sel_hi:[1,1]
  v_pk_fma_f32 v[84:85], v[156:157], v[162:163], v[84:85] op_sel:[0,1,0] op_sel_hi:[1,1,1] neg_lo:[0,1,0] neg_hi:[0,1,0]
  v_pk_mul_f32 v[84:85], v[84:85], v[166:167] op_sel:[0,1] op_sel_hi:[1,1]
  v_pk_fma_f32 v[86:87], v[158:159], v[162:163], v[86:87] op_sel:[0,1,0] op_sel_hi:[1,1,1] neg_lo:[0,1,0] neg_hi:[0,1,0]
  v_pk_mul_f32 v[86:87], v[86:87], v[166:167] op_sel:[0,1] op_sel_hi:[1,1]
  v_cvt_pk_bf16_f32 v228, v68, v69
  v_cvt_pk_bf16_f32 v229, v70, v71
  v_cvt_pk_bf16_f32 v230, v84, v85
  v_cvt_pk_bf16_f32 v231, v86, v87
  buffer_store_dwordx4 v[228:231], v7, s[48:51], s37 offen offset:128 sc1
  v_pk_fma_f32 v[72:73], v[152:153], v[164:165], v[72:73] op_sel:[0,0,0] op_sel_hi:[1,0,1] neg_lo:[0,1,0] neg_hi:[0,1,0]
  v_pk_mul_f32 v[72:73], v[72:73], v[168:169] op_sel:[0,0] op_sel_hi:[1,0]
  v_pk_fma_f32 v[74:75], v[154:155], v[164:165], v[74:75] op_sel:[0,0,0] op_sel_hi:[1,0,1] neg_lo:[0,1,0] neg_hi:[0,1,0]
  v_pk_mul_f32 v[74:75], v[74:75], v[168:169] op_sel:[0,0] op_sel_hi:[1,0]
  v_pk_fma_f32 v[88:89], v[156:157], v[164:165], v[88:89] op_sel:[0,0,0] op_sel_hi:[1,0,1] neg_lo:[0,1,0] neg_hi:[0,1,0]
  v_pk_mul_f32 v[88:89], v[88:89], v[168:169] op_sel:[0,0] op_sel_hi:[1,0]
  v_pk_fma_f32 v[90:91], v[158:159], v[164:165], v[90:91] op_sel:[0,0,0] op_sel_hi:[1,0,1] neg_lo:[0,1,0] neg_hi:[0,1,0]
  v_pk_mul_f32 v[90:91], v[90:91], v[168:169] op_sel:[0,0] op_sel_hi:[1,0]
  v_cvt_pk_bf16_f32 v208, v72, v73
  v_cvt_pk_bf16_f32 v209, v74, v75
  v_cvt_pk_bf16_f32 v210, v88, v89
  v_cvt_pk_bf16_f32 v211, v90, v91
  buffer_store_dwordx4 v[208:211], v7, s[48:51], s37 offen offset:2048 sc1
  v_pk_fma_f32 v[76:77], v[152:153], v[164:165], v[76:77] op_sel:[0,1,0] op_sel_hi:[1,1,1] neg_lo:[0,1,0] neg_hi:[0,1,0]
  v_pk_mul_f32 v[76:77], v[76:77], v[168:169] op_sel:[0,1] op_sel_hi:[1,1]
  v_pk_fma_f32 v[78:79], v[154:155], v[164:165], v[78:79] op_sel:[0,1,0] op_sel_hi:[1,1,1] neg_lo:[0,1,0] neg_hi:[0,1,0]
  v_pk_mul_f32 v[78:79], v[78:79], v[168:169] op_sel:[0,1] op_sel_hi:[1,1]
  v_pk_fma_f32 v[92:93], v[156:157], v[164:165], v[92:93] op_sel:[0,1,0] op_sel_hi:[1,1,1] neg_lo:[0,1,0] neg_hi:[0,1,0]
  v_pk_mul_f32 v[92:93], v[92:93], v[168:169] op_sel:[0,1] op_sel_hi:[1,1]
  v_pk_fma_f32 v[94:95], v[158:159], v[164:165], v[94:95] op_sel:[0,1,0] op_sel_hi:[1,1,1] neg_lo:[0,1,0] neg_hi:[0,1,0]
  v_pk_mul_f32 v[94:95], v[94:95], v[168:169] op_sel:[0,1] op_sel_hi:[1,1]
  v_cvt_pk_bf16_f32 v212, v76, v77
  v_cvt_pk_bf16_f32 v213, v78, v79
  v_cvt_pk_bf16_f32 v214, v92, v93
  v_cvt_pk_bf16_f32 v215, v94, v95
  buffer_store_dwordx4 v[212:215], v7, s[48:51], s37 offen offset:2176 sc1
  s_waitcnt lgkmcnt(0)
  v_pk_fma_f32 v[96:97], v[176:177], v[160:161], v[96:97] op_sel:[0,0,0] op_sel_hi:[1,0,1] neg_lo:[0,1,0] neg_hi:[0,1,0]
  v_pk_mul_f32 v[96:97], v[96:97], v[192:193]
  v_pk_fma_f32 v[98:99], v[178:179], v[160:161], v[98:99] op_sel:[0,0,0] op_sel_hi:[1,0,1] neg_lo:[0,1,0] neg_hi:[0,1,0]
  v_pk_mul_f32 v[98:99], v[98:99], v[194:195]
  v_pk_fma_f32 v[100:101], v[180:181], v[160:161], v[100:101] op_sel:[0,0,0] op_sel_hi:[1,0,1] neg_lo:[0,1,0] neg_hi:[0,1,0]
  v_pk_mul_f32 v[100:101], v[100:101], v[196:197]
  v_pk_fma_f32 v[102:103], v[182:183], v[160:161], v[102:103] op_sel:[0,0,0] op_sel_hi:[1,0,1] neg_lo:[0,1,0] neg_hi:[0,1,0]
  v_pk_mul_f32 v[102:103], v[102:103], v[198:199]
  v_cvt_pk_bf16_f32 v216, v96, v97
  v_cvt_pk_bf16_f32 v217, v98, v99
  v_cvt_pk_bf16_f32 v218, v100, v101
  v_cvt_pk_bf16_f32 v219, v102, v103
  buffer_store_dwordx4 v[216:219], v6, s[48:51], s38 offen offset:0 sc1
  v_pk_fma_f32 v[112:113], v[176:177], v[160:161], v[112:113] op_sel:[0,1,0] op_sel_hi:[1,1,1] neg_lo:[0,1,0] neg_hi:[0,1,0]
  v_pk_mul_f32 v[112:113], v[112:113], v[192:193]
  v_pk_fma_f32 v[114:115], v[178:179], v[160:161], v[114:115] op_sel:[0,1,0] op_sel_hi:[1,1,1] neg_lo:[0,1,0] neg_hi:[0,1,0]
  v_pk_mul_f32 v[114:115], v[114:115], v[194:195]
  v_pk_fma_f32 v[116:117], v[180:181], v[160:161], v[116:117] op_sel:[0,1,0] op_sel_hi:[1,1,1] neg_lo:[0,1,0] neg_hi:[0,1,0]
  v_pk_mul_f32 v[116:117], v[116:117], v[196:197]
  v_pk_fma_f32 v[118:119], v[182:183], v[160:161], v[118:119] op_sel:[0,1,0] op_sel_hi:[1,1,1] neg_lo:[0,1,0] neg_hi:[0,1,0]
  v_pk_mul_f32 v[118:119], v[118:119], v[198:199]
  v_cvt_pk_bf16_f32 v220, v112, v113
  v_cvt_pk_bf16_f32 v221, v114, v115
  v_cvt_pk_bf16_f32 v222, v116, v117
  v_cvt_pk_bf16_f32 v223, v118, v119
  buffer_store_dwordx4 v[220:223], v6, s[48:51], s38 offen offset:256 sc1
  v_pk_fma_f32 v[104:105], v[184:185], v[160:161], v[104:105] op_sel:[0,0,0] op_sel_hi:[1,0,1] neg_lo:[0,1,0] neg_hi:[0,1,0]
  v_pk_mul_f32 v[104:105], v[104:105], v[200:201]
  v_pk_fma_f32 v[106:107], v[186:187], v[160:161], v[106:107] op_sel:[0,0,0] op_sel_hi:[1,0,1] neg_lo:[0,1,0] neg_hi:[0,1,0]
  v_pk_mul_f32 v[106:107], v[106:107], v[202:203]
  v_pk_fma_f32 v[108:109], v[188:189], v[160:161], v[108:109] op_sel:[0,0,0] op_sel_hi:[1,0,1] neg_lo:[0,1,0] neg_hi:[0,1,0]
  v_pk_mul_f32 v[108:109], v[108:109], v[204:205]
  v_pk_fma_f32 v[110:111], v[190:191], v[160:161], v[110:111] op_sel:[0,0,0] op_sel_hi:[1,0,1] neg_lo:[0,1,0] neg_hi:[0,1,0]
  v_pk_mul_f32 v[110:111], v[110:111], v[206:207]
  v_cvt_pk_bf16_f32 v224, v104, v105
  v_cvt_pk_bf16_f32 v225, v106, v107
  v_cvt_pk_bf16_f32 v226, v108, v109
  v_cvt_pk_bf16_f32 v227, v110, v111
  buffer_store_dwordx4 v[224:227], v6, s[48:51], s38 offen offset:2048 sc1
  v_pk_fma_f32 v[120:121], v[184:185], v[160:161], v[120:121] op_sel:[0,1,0] op_sel_hi:[1,1,1] neg_lo:[0,1,0] neg_hi:[0,1,0]
  v_pk_mul_f32 v[120:121], v[120:121], v[200:201]
  v_pk_fma_f32 v[122:123], v[186:187], v[160:161], v[122:123] op_sel:[0,1,0] op_sel_hi:[1,1,1] neg_lo:[0,1,0] neg_hi:[0,1,0]
  v_pk_mul_f32 v[122:123], v[122:123], v[202:203]
  v_pk_fma_f32 v[124:125], v[188:189], v[160:161], v[124:125] op_sel:[0,1,0] op_sel_hi:[1,1,1] neg_lo:[0,1,0] neg_hi:[0,1,0]
  v_pk_mul_f32 v[124:125], v[124:125], v[204:205]
  v_pk_fma_f32 v[126:127], v[190:191], v[160:161], v[126:127] op_sel:[0,1,0] op_sel_hi:[1,1,1] neg_lo:[0,1,0] neg_hi:[0,1,0]
  v_pk_mul_f32 v[126:127], v[126:127], v[206:207]
  v_cvt_pk_bf16_f32 v228, v120, v121
  v_cvt_pk_bf16_f32 v229, v122, v123
  v_cvt_pk_bf16_f32 v230, v124, v125
  v_cvt_pk_bf16_f32 v231, v126, v127
  buffer_store_dwordx4 v[228:231], v6, s[48:51], s38 offen offset:2304 sc1
  s_mov_b32 s85, s46
  s_and_b32 s30, s2, 7
  s_lshr_b32 s31, s2, 3
  s_lshl_b32 s30, s30, 2
  s_and_b32 s32, s31, 3
  s_add_u32 s21, s30, s32
  s_lshr_b32 s22, s31, 2
  v_lshlrev_b32 v9, 4, v1
  v_add_u32 v2, 98304, v9
  s_mov_b32 s33, 137
  s_lshl_b32 s34, s21, 17
  s_lshl_b32 s30, s22, 14
  s_lshl_b32 s31, s20, 12
  s_add_u32 s30, s30, s31
  s_add_u32 s41, s30, s34
  s_add_u32 s29, s31, 98304
  s_add_u32 s4, s62, 8388608
  s_addc_u32 s5, s63, 0
  s_mov_b32 s6, 8388608
  s_mov_b32 s7, 0x20000
  s_add_u32 s8, s62, 4194304
  s_addc_u32 s9, s63, 0
  s_mov_b32 s10, 4194304
  s_mov_b32 s11, 0x20000
  s_add_u32 s12, s62, 16777216
  s_addc_u32 s13, s63, 0
  s_mov_b32 s14, 4194304
  s_mov_b32 s15, 0x20000
  v_lshrrev_b32 v5, 4, v1
  v_lshrrev_b32 v6, 2, v1
  v_xor_b32 v5, v5, v6
  v_and_b32 v5, 1, v5
  v_subrev_u32 v5, 1, v5
  v_and_b32 v5, 0x3f803f80, v5
  v_bfe_u32 v5, v1, 2, 1
  v_subrev_u32 v6, 1, v5
  v_and_b32 v6, 0x3f803f80, v6
  v_mov_b32 v160, v6
  v_mov_b32 v161, v6
  v_xor_b32 v162, 0x3f803f80, v6
  v_mov_b32 v163, v162
  v_and_b32 v5, 1, v1
  v_mul_u32_u24 v5, 0xaaaa, v5
  v_add_u32 v167, 0x4444, v5
  v_and_b32 v5, 15, v1
  v_lshlrev_b32 v5, 4, v5
  v_bfe_u32 v6, v1, 4, 1
  v_lshl_add_u32 v5, v6, 10, v5
  v_lshrrev_b32 v6, 5, v1
  v_lshl_add_u32 v166, v6, 8, v5
  s_cmp_eq_u32 s20, 1
  s_cselect_b32 s16, s74, s72
  s_cselect_b32 s17, s75, s73
  s_cmp_eq_u32 s20, 2
  s_cselect_b32 s16, s76, s16
  s_cselect_b32 s17, s77, s17
  s_cmp_eq_u32 s20, 3
  s_cselect_b32 s18, 0, 7340032
  s_mov_b32 s19, 0x20000
  s_lshl_b32 s40, s2, 15
  v_lshrrev_b32 v164, 1, v1
  v_lshlrev_b32 v164, 7, v164
  s_and_b32 s30, s2, 7
  s_lshr_b32 s31, s2, 3
  s_and_b32 s80, s30, 3
  s_lshl_b32 s80, s80, 2
  s_and_b32 s32, s31, 3
  s_add_u32 s80, s80, s32
  s_lshr_b32 s81, s30, 2
  s_mul_i32 s81, s81, 8
  s_lshr_b32 s32, s31, 2
  s_add_u32 s81, s81, s32
  v_bfe_u32 v28, v1, 4, 2
  v_bfe_u32 v29, v1, 1, 2
  v_xor_b32 v28, v28, v29
  v_and_b32 v29, 1, v1
  v_lshlrev_b32 v29, 4, v29
  v_lshl_add_u32 v27, v28, 5, v29
  s_lshl_b32 s30, s81, 7
  s_lshl_b32 s31, s20, 16
  s_add_u32 s30, s30, s31
  v_lshrrev_b32 v28, 3, v1
  v_lshl_add_u32 v27, v28, 11, v27
  v_add_u32 v168, s30, v27
  v_add_u32 v169, 15360, v168
  v_add_u32 v170, 30720, v168
  v_add_u32 v171, 46080, v168
  v_mov_b32 v172, v168
  v_mov_b32 v173, v169
  v_mov_b32 v174, v170
  v_mov_b32 v175, v171
  s_mov_b32 s52, s68
  s_mov_b32 s53, s69
  s_mov_b32 s54, 2097152
  s_mov_b32 s55, 0x20000
  s_add_u32 s48, s62, 46137344
  s_addc_u32 s49, s63, 0
  s_mov_b32 s50, 4194304
  s_mov_b32 s51, 0x20000
  s_mov_b32 s82, -262144
  s_lshl_b32 s83, s20, 12
  s_mov_b32 s44, 262144
  s_movk_i32 s45, 0x4000
  s_lshl_b32 s30, s22, 19
  s_lshl_b32 s31, s21, 14
  s_add_u32 s30, s30, s31
  s_add_u32 s84, s30, s83
  v_mov_b32 v12, -1
  v_mov_b32 v13, -1
  v_mov_b32 v14, -1
  v_mov_b32 v15, -1
  s_lshr_b32 s30, s20, 1
  s_lshl_b32 s30, s30, 22
  s_and_b32 s31, s20, 1
  s_mul_i32 s31, s31, 4096
  s_add_u32 s24, s34, s30
  s_add_u32 s24, s24, s31
  s_add_u32 s35, s24, 131072
  s_mov_b32 s26, 0
  s_mov_b32 s27, 0
  s_mov_b32 s6, 8388608
  v_mov_b32 v3, v2
  v_mov_b32 v56, 0
  v_mov_b32 v57, 0
  v_mov_b32 v58, 0
  v_mov_b32 v59, 0
  v_mov_b32 v60, 0
  v_mov_b32 v61, 0
  v_mov_b32 v62, 0
  v_mov_b32 v63, 0
  v_mov_b32 v64, 0
  v_mov_b32 v65, 0
  v_mov_b32 v66, 0
  v_mov_b32 v67, 0
  v_mov_b32 v68, 0
  v_mov_b32 v69, 0
  v_mov_b32 v70, 0
  v_mov_b32 v71, 0
  v_mov_b32 v72, 0
  v_mov_b32 v73, 0
  v_mov_b32 v74, 0
  v_mov_b32 v75, 0
  v_mov_b32 v76, 0
  v_mov_b32 v77, 0
  v_mov_b32 v78, 0
  v_mov_b32 v79, 0
  v_mov_b32 v80, 0
  v_mov_b32 v81, 0
  v_mov_b32 v82, 0
  v_mov_b32 v83, 0
  v_mov_b32 v84, 0
  v_mov_b32 v85, 0
  v_mov_b32 v86, 0
  v_mov_b32 v87, 0
  v_mov_b32 v88, 0
  v_mov_b32 v89, 0
  v_mov_b32 v90, 0
  v_mov_b32 v91, 0
  v_mov_b32 v92, 0
  v_mov_b32 v93, 0
  v_mov_b32 v94, 0
  v_mov_b32 v95, 0
  v_mov_b32 v48, 0
  v_mov_b32 v49, 0
  v_mov_b32 v50, 0
  v_mov_b32 v51, 0
  v_mov_b32 v52, 0
  v_mov_b32 v53, 0
  v_mov_b32 v54, 0
  v_mov_b32 v55, 0
  s_lshr_b32 s42, s21, 1
  v_lshlrev_b32 v29, 3, v1
  v_lshrrev_b32 v29, v29, s85
  v_and_b32 v29, 15, v29
  v_add_u32 v30, 0, v29
  v_lshlrev_b32 v30, 8, v30
  v_mov_b32 v31, 1
  s_waitcnt vmcnt(0) lgkmcnt(0)
  s_barrier
  s_cmp_lg_u32 s20, 0
  s_cbranch_scc1 L_sig_p1
  s_mov_b64 exec, 7
  global_atomic_add v30, v31, s[58:59] sc1
  s_mov_b64 exec, -1
L_sig_p1:
  s_add_u32 s30, s42, 0
  s_lshl_b32 s30, s30, 8
  v_mov_b32 v30, s30
  v_mov_b32 v29, 0
  s_cmp_lg_u32 s20, 0
  s_cbranch_scc1 L_np_p2
  s_mov_b64 exec, 1
  global_atomic_add v31, v30, v29, s[58:59] sc0 sc1
  s_mov_b64 exec, -1
L_np_p2:
  s_cmp_lg_u32 s20, 0
  s_cbranch_scc1 L_go_p2
  s_mov_b32 s31, 0x40000
  s_waitcnt vmcnt(0)
L_poll_p2:
  v_readfirstlane_b32 s30, v31
  s_sub_u32 s31, s31, 1
  s_nop 0
  s_cselect_b32 s30, 48, s30
  s_cmp_ge_u32 s30, 48
  s_cbranch_scc1 L_go_p2
  s_sleep 2
  s_mov_b64 exec, 1
  global_atomic_add v31, v30, v29, s[58:59] sc0 sc1
  s_mov_b64 exec, -1
  s_waitcnt vmcnt(0)
  s_branch L_poll_p2
L_go_p2:
  s_barrier
L_attn_start:
  s_add_u32 m0, s26, s29
  s_nop 0
  buffer_load_dwordx4 v9, s[4:7], s24 offen sc1 lds
  buffer_load_dwordx4 v9, s[4:7], s24 offen offset:1024 sc1 lds
  buffer_load_dwordx4 v9, s[4:7], s24 offen offset:2048 sc1 lds
  buffer_load_dwordx4 v9, s[4:7], s24 offen offset:3072 sc1 lds
  s_add_u32 s24, s24, 8192
  s_cmp_lt_u32 s24, s35
  s_cselect_b32 s6, s6, 0
  s_add_u32 s26, s26, 16384
  s_and_b32 s26, s26, 65535
  buffer_load_dwordx4 v[128:131], v9, s[8:11], s41 offen offset:0 sc1
  buffer_load_dwordx4 v[132:135], v9, s[8:11], s41 offen offset:1024 sc1
  buffer_load_dwordx4 v[136:139], v9, s[8:11], s41 offen offset:2048 sc1
  buffer_load_dwordx4 v[140:143], v9, s[8:11], s41 offen offset:3072 sc1
  s_add_u32 m0, s26, s29
  s_nop 0
  buffer_load_dwordx4 v9, s[4:7], s24 offen sc1 lds
  buffer_load_dwordx4 v9, s[4:7], s24 offen offset:1024 sc1 lds
  buffer_load_dwordx4 v9, s[4:7], s24 offen offset:2048 sc1 lds
  buffer_load_dwordx4 v9, s[4:7], s24 offen offset:3072 sc1 lds
  s_add_u32 s24, s24, 8192
  s_cmp_lt_u32 s24, s35
  s_cselect_b32 s6, s6, 0
  s_add_u32 s26, s26, 16384
  s_and_b32 s26, s26, 65535
  s_waitcnt vmcnt(4)
  s_barrier
  ds_read_b128 v[144:147], v3 offset:0
  ds_read_b128 v[148:151], v3 offset:1024
  ds_read_b128 v[156:159], v3 offset:9216
  ds_read_b128 v[152:155], v3 offset:8192
  s_waitcnt lgkmcnt(2)
  s_cmp_eq_u32 s33, 1
  s_cbranch_scc1 L_attn_havemax
  v_mfma_f32_32x32x16_bf16 v[16:31], v[144:147], v[128:131], 0
  v_mfma_f32_32x32x16_bf16 v[16:31], v[148:151], v[132:135], v[16:31]
  v_mfma_f32_32x32x16_bf16 v[32:47], v[144:147], v[136:139], 0
  v_mfma_f32_32x32x16_bf16 v[32:47], v[148:151], v[140:143], v[32:47]
  s_nop 9
  v_max3_f32 v5, v16, v17, v18
  v_max3_f32 v5, v5, v19, v20
  v_max3_f32 v5, v5, v21, v22
  v_max3_f32 v5, v5, v23, v24
  v_max3_f32 v5, v5, v25, v26
  v_max3_f32 v5, v5, v27, v28
  v_max3_f32 v5, v5, v29, v30
  v_max_f32 v5, v5, v31
  v_max3_f32 v6, v32, v33, v34
  v_max3_f32 v6, v6, v35, v36
  v_max3_f32 v6, v6, v37, v38
  v_max3_f32 v6, v6, v39, v40
  v_max3_f32 v6, v6, v41, v42
  v_max3_f32 v6, v6, v43, v44
  v_max3_f32 v6, v6, v45, v46
  v_max_f32 v6, v6, v47
  v_mov_b32 v7, v5
  s_nop 1
  v_permlane32_swap_b32 v5, v7
  v_max_f32 v5, v5, v7
  v_sub_f32 v96, 0, v5
  v_sub_f32 v97, 0, v5
  v_sub_f32 v98, 0, v5
  v_sub_f32 v99, 0, v5
  v_sub_f32 v100, 0, v5
  v_sub_f32 v101, 0, v5
  v_sub_f32 v102, 0, v5
  v_sub_f32 v103, 0, v5
  v_sub_f32 v104, 0, v5
  v_sub_f32 v105, 0, v5
  v_sub_f32 v106, 0, v5
  v_sub_f32 v107, 0, v5
  v_sub_f32 v108, 0, v5
  v_sub_f32 v109, 0, v5
  v_sub_f32 v110, 0, v5
  v_sub_f32 v111, 0, v5
  v_mov_b32 v7, v6
  s_nop 1
  v_permlane32_swap_b32 v6, v7
  v_max_f32 v6, v6, v7
  v_sub_f32 v112, 0, v6
  v_sub_f32 v113, 0, v6
  v_sub_f32 v114, 0, v6
  v_sub_f32 v115, 0, v6
  v_sub_f32 v116, 0, v6
  v_sub_f32 v117, 0, v6
  v_sub_f32 v118, 0, v6
  v_sub_f32 v119, 0, v6
  v_sub_f32 v120, 0, v6
  v_sub_f32 v121, 0, v6
  v_sub_f32 v122, 0, v6
  v_sub_f32 v123, 0, v6
  v_sub_f32 v124, 0, v6
  v_sub_f32 v125, 0, v6
  v_sub_f32 v126, 0, v6
  v_sub_f32 v127, 0, v6
L_attn_havemax:
  v_mfma_f32_32x32x16_bf16 v[16:31], v[144:147], v[128:131], v[96:111]
  v_mfma_f32_32x32x16_bf16 v[16:31], v[148:151], v[132:135], v[16:31]
  s_mov_b32 s28, 8
  s_waitcnt lgkmcnt(0)
  s_nop 7
.p2align 5
L_attn_loop:
  v_mfma_f32_32x32x16_bf16 v[32:47], v[144:147], v[136:139], v[112:127]
  s_add_u32 s27, s27, 16384
  ds_read_b128 v[144:147], v3 offset:2048
  v_exp_f32 v16, v16
  v_exp_f32 v17, v17
  v_exp_f32 v18, v18
  v_exp_f32 v19, v19
  v_smfmac_f32_16x16x64_bf16 v[92:95], v[160:163], v[48:55], v167
  s_waitcnt lgkmcnt(1)
  v_exp_f32 v20, v20
  v_exp_f32 v21, v21
  v_mfma_f32_32x32x16_bf16 v[32:47], v[148:151], v[140:143], v[32:47]
  s_and_b32 s27, s27, 65535
  ds_read_b128 v[148:151], v3 offset:3072
  v_exp_f32 v22, v22
  v_exp_f32 v23, v23
  v_cvt_pk_bf16_f32 v48, v16, v17
  v_cvt_pk_bf16_f32 v49, v18, v19
  v_cvt_pk_bf16_f32 v50, v20, v21
  v_cvt_pk_bf16_f32 v51, v22, v23
  v_mfma_f32_32x32x16_bf16 v[72:87], v[156:159], v[52:55], v[72:87]
  s_add_u32 m0, s26, s29
  ds_read_b128 v[156:159], v3 offset:9216
  v_exp_f32 v24, v24
  v_exp_f32 v25, v25
  v_exp_f32 v26, v26
  v_exp_f32 v27, v27
  v_mfma_f32_32x32x16_bf16 v[56:71], v[152:155], v[48:51], v[56:71]
  s_waitcnt lgkmcnt(2)
  v_exp_f32 v28, v28
  v_exp_f32 v29, v29
  v_exp_f32 v30, v30
  v_exp_f32 v31, v31
  v_cvt_pk_bf16_f32 v52, v24, v25
  v_cvt_pk_bf16_f32 v53, v26, v27
  v_cvt_pk_bf16_f32 v54, v28, v29
  v_cvt_pk_bf16_f32 v55, v30, v31
  v_mfma_f32_32x32x16_bf16 v[16:31], v[144:147], v[128:131], v[96:111]
  buffer_load_dwordx4 v9, s[4:7], s24 offen sc1 lds
  v_exp_f32 v32, v32
  v_exp_f32 v33, v33
  v_exp_f32 v34, v34
  v_exp_f32 v35, v35
  v_smfmac_f32_16x16x64_bf16 v[88:91], v[160:163], v[48:55], v167
  s_waitcnt lgkmcnt(0)
  v_exp_f32 v36, v36
  v_exp_f32 v37, v37
  v_mfma_f32_32x32x16_bf16 v[16:31], v[148:151], v[132:135], v[16:31]
  s_add_u32 s82, s82, s44
  v_exp_f32 v38, v38
  v_exp_f32 v39, v39
  v_cvt_pk_bf16_f32 v48, v32, v33
  v_cvt_pk_bf16_f32 v49, v34, v35
  v_cvt_pk_bf16_f32 v50, v36, v37
  v_cvt_pk_bf16_f32 v51, v38, v39
  v_mfma_f32_32x32x16_bf16 v[56:71], v[156:159], v[52:55], v[56:71]
  buffer_load_dwordx4 v9, s[4:7], s24 offen offset:1024 sc1 lds
  v_exp_f32 v40, v40
  v_exp_f32 v41, v41
  v_exp_f32 v42, v42
  v_exp_f32 v43, v43
  v_mfma_f32_32x32x16_bf16 v[72:87], v[152:155], v[48:51], v[72:87]
  ds_read_b128 v[152:155], v3 offset:10240
  v_exp_f32 v44, v44
  v_exp_f32 v45, v45
  v_exp_f32 v46, v46
  v_exp_f32 v47, v47
  v_cvt_pk_bf16_f32 v52, v40, v41
  v_cvt_pk_bf16_f32 v53, v42, v43
  v_cvt_pk_bf16_f32 v54, v44, v45
  v_cvt_pk_bf16_f32 v55, v46, v47
  v_mfma_f32_32x32x16_bf16 v[32:47], v[144:147], v[136:139], v[112:127]
  ds_read_b128 v[144:147], v3 offset:4096
  v_exp_f32 v16, v16
  v_exp_f32 v17, v17
  v_exp_f32 v18, v18
  v_exp_f32 v19, v19
  v_smfmac_f32_16x16x64_bf16 v[92:95], v[160:163], v[48:55], v167
  s_waitcnt lgkmcnt(1)
  v_add_u32 v4, s27, v2
  v_exp_f32 v20, v20
  v_exp_f32 v21, v21
  v_mfma_f32_32x32x16_bf16 v[32:47], v[148:151], v[140:143], v[32:47]
  ds_read_b128 v[148:151], v3 offset:5120
  v_exp_f32 v22, v22
  v_exp_f32 v23, v23
  v_cvt_pk_bf16_f32 v48, v16, v17
  v_cvt_pk_bf16_f32 v49, v18, v19
  v_cvt_pk_bf16_f32 v50, v20, v21
  v_cvt_pk_bf16_f32 v51, v22, v23
  v_mfma_f32_32x32x16_bf16 v[72:87], v[156:159], v[52:55], v[72:87]
  ds_read_b128 v[156:159], v3 offset:11264
  v_exp_f32 v24, v24
  v_exp_f32 v25, v25
  v_exp_f32 v26, v26
  v_exp_f32 v27, v27
  v_mfma_f32_32x32x16_bf16 v[56:71], v[152:155], v[48:51], v[56:71]
  s_waitcnt lgkmcnt(2)
  v_exp_f32 v28, v28
  v_exp_f32 v29, v29
  v_exp_f32 v30, v30
  v_exp_f32 v31, v31
  v_cvt_pk_bf16_f32 v52, v24, v25
  v_cvt_pk_bf16_f32 v53, v26, v27
  v_cvt_pk_bf16_f32 v54, v28, v29
  v_cvt_pk_bf16_f32 v55, v30, v31
  v_mfma_f32_32x32x16_bf16 v[16:31], v[144:147], v[128:131], v[96:111]
  buffer_load_dwordx4 v9, s[4:7], s24 offen offset:2048 sc1 lds
  v_exp_f32 v32, v32
  v_exp_f32 v33, v33
  v_exp_f32 v34, v34
  v_exp_f32 v35, v35
  v_smfmac_f32_16x16x64_bf16 v[88:91], v[160:163], v[48:55], v167
  s_waitcnt lgkmcnt(0)
  v_exp_f32 v36, v36
  v_exp_f32 v37, v37
  v_mfma_f32_32x32x16_bf16 v[16:31], v[148:151], v[132:135], v[16:31]
  v_exp_f32 v38, v38
  v_exp_f32 v39, v39
  v_cvt_pk_bf16_f32 v48, v32, v33
  v_cvt_pk_bf16_f32 v49, v34, v35
  v_cvt_pk_bf16_f32 v50, v36, v37
  v_cvt_pk_bf16_f32 v51, v38, v39
  v_mfma_f32_32x32x16_bf16 v[56:71], v[156:159], v[52:55], v[56:71]
  buffer_load_dwordx4 v9, s[4:7], s24 offen offset:3072 sc1 lds
  v_exp_f32 v40, v40
  v_exp_f32 v41, v41
  v_exp_f32 v42, v42
  v_exp_f32 v43, v43
  v_mfma_f32_32x32x16_bf16 v[72:87], v[152:155], v[48:51], v[72:87]
  s_add_u32 s24, s24, 8192
  ds_read_b128 v[152:155], v3 offset:12288
  v_exp_f32 v44, v44
  v_exp_f32 v45, v45
  v_exp_f32 v46, v46
  v_exp_f32 v47, v47
  v_cvt_pk_bf16_f32 v52, v40, v41
  v_cvt_pk_bf16_f32 v53, v42, v43
  v_cvt_pk_bf16_f32 v54, v44, v45
  v_cvt_pk_bf16_f32 v55, v46, v47
  v_mfma_f32_32x32x16_bf16 v[32:47], v[144:147], v[136:139], v[112:127]
  s_cmp_lt_u32 s24, s35
  ds_read_b128 v[144:147], v3 offset:6144
  v_exp_f32 v16, v16
  v_exp_f32 v17, v17
  v_exp_f32 v18, v18
  v_exp_f32 v19, v19
  v_smfmac_f32_16x16x64_bf16 v[92:95], v[160:163], v[48:55], v167
  s_waitcnt lgkmcnt(1)
  v_exp_f32 v20, v20
  v_exp_f32 v21, v21
  v_mfma_f32_32x32x16_bf16 v[32:47], v[148:151], v[140:143], v[32:47]
  s_cselect_b32 s6, s6, 0
  ds_read_b128 v[148:151], v3 offset:7168
  v_exp_f32 v22, v22
  v_exp_f32 v23, v23
  v_cvt_pk_bf16_f32 v48, v16, v17
  v_cvt_pk_bf16_f32 v49, v18, v19
  v_cvt_pk_bf16_f32 v50, v20, v21
  v_cvt_pk_bf16_f32 v51, v22, v23
  v_mfma_f32_32x32x16_bf16 v[72:87], v[156:159], v[52:55], v[72:87]
  ds_read_b128 v[156:159], v3 offset:13312
  v_exp_f32 v24, v24
  v_exp_f32 v25, v25
  v_exp_f32 v26, v26
  v_exp_f32 v27, v27
  v_mfma_f32_32x32x16_bf16 v[56:71], v[152:155], v[48:51], v[56:71]
  s_waitcnt lgkmcnt(2)
  v_exp_f32 v28, v28
  v_exp_f32 v29, v29
  v_exp_f32 v30, v30
  v_exp_f32 v31, v31
  v_cvt_pk_bf16_f32 v52, v24, v25
  v_cvt_pk_bf16_f32 v53, v26, v27
  v_cvt_pk_bf16_f32 v54, v28, v29
  v_cvt_pk_bf16_f32 v55, v30, v31
  v_mfma_f32_32x32x16_bf16 v[16:31], v[144:147], v[128:131], v[96:111]
  buffer_load_dword v165, v164, s[16:19], s40 offen
  v_exp_f32 v32, v32
  v_exp_f32 v33, v33
  v_exp_f32 v34, v34
  v_exp_f32 v35, v35
  v_smfmac_f32_16x16x64_bf16 v[88:91], v[160:163], v[48:55], v167
  s_waitcnt lgkmcnt(0)
  v_exp_f32 v36, v36
  v_exp_f32 v37, v37
  v_mfma_f32_32x32x16_bf16 v[16:31], v[148:151], v[132:135], v[16:31]
  s_add_u32 s26, s26, 16384
  v_exp_f32 v38, v38
  v_exp_f32 v39, v39
  v_cvt_pk_bf16_f32 v48, v32, v33
  v_cvt_pk_bf16_f32 v49, v34, v35
  v_cvt_pk_bf16_f32 v50, v36, v37
  v_cvt_pk_bf16_f32 v51, v38, v39
  v_mfma_f32_32x32x16_bf16 v[56:71], v[156:159], v[52:55], v[56:71]
  v_exp_f32 v40, v40
  v_exp_f32 v41, v41
  v_exp_f32 v42, v42
  v_exp_f32 v43, v43
  v_mfma_f32_32x32x16_bf16 v[72:87], v[152:155], v[48:51], v[72:87]
  s_waitcnt vmcnt(5)
  s_barrier
  ds_read_b128 v[152:155], v3 offset:14336
  v_exp_f32 v44, v44
  v_exp_f32 v45, v45
  v_exp_f32 v46, v46
  v_exp_f32 v47, v47
  v_cvt_pk_bf16_f32 v52, v40, v41
  v_cvt_pk_bf16_f32 v53, v42, v43
  v_cvt_pk_bf16_f32 v54, v44, v45
  v_cvt_pk_bf16_f32 v55, v46, v47
  v_mfma_f32_32x32x16_bf16 v[32:47], v[144:147], v[136:139], v[112:127]
  s_and_b32 s26, s26, 65535
  ds_read_b128 v[144:147], v4 offset:0
  v_exp_f32 v16, v16
  v_exp_f32 v17, v17
  v_exp_f32 v18, v18
  v_exp_f32 v19, v19
  v_smfmac_f32_16x16x64_bf16 v[92:95], v[160:163], v[48:55], v167
  s_waitcnt lgkmcnt(1)
  v_exp_f32 v20, v20
  v_exp_f32 v21, v21
  v_mfma_f32_32x32x16_bf16 v[32:47], v[148:151], v[140:143], v[32:47]
  s_add_u32 s40, s40, 4096
  ds_read_b128 v[148:151], v4 offset:1024
  v_exp_f32 v22, v22
  v_exp_f32 v23, v23
  v_cvt_pk_bf16_f32 v48, v16, v17
  v_cvt_pk_bf16_f32 v49, v18, v19
  v_cvt_pk_bf16_f32 v50, v20, v21
  v_cvt_pk_bf16_f32 v51, v22, v23
  v_mfma_f32_32x32x16_bf16 v[72:87], v[156:159], v[52:55], v[72:87]
  ds_read_b128 v[156:159], v3 offset:15360
  v_exp_f32 v24, v24
  v_exp_f32 v25, v25
  v_exp_f32 v26, v26
  v_exp_f32 v27, v27
  v_mfma_f32_32x32x16_bf16 v[56:71], v[152:155], v[48:51], v[56:71]
  s_waitcnt lgkmcnt(2)
  v_exp_f32 v28, v28
  v_exp_f32 v29, v29
  v_exp_f32 v30, v30
  v_exp_f32 v31, v31
  v_cvt_pk_bf16_f32 v52, v24, v25
  v_cvt_pk_bf16_f32 v53, v26, v27
  v_cvt_pk_bf16_f32 v54, v28, v29
  v_cvt_pk_bf16_f32 v55, v30, v31
  v_mfma_f32_32x32x16_bf16 v[16:31], v[144:147], v[128:131], v[96:111]
  v_exp_f32 v32, v32
  v_exp_f32 v33, v33
  v_exp_f32 v34, v34
  v_exp_f32 v35, v35
  v_smfmac_f32_16x16x64_bf16 v[88:91], v[160:163], v[48:55], v167
  s_waitcnt lgkmcnt(0)
  v_exp_f32 v36, v36
  v_exp_f32 v37, v37
  v_mfma_f32_32x32x16_bf16 v[16:31], v[148:151], v[132:135], v[16:31]
  v_exp_f32 v38, v38
  v_exp_f32 v39, v39
  v_cvt_pk_bf16_f32 v48, v32, v33
  v_cvt_pk_bf16_f32 v49, v34, v35
  v_cvt_pk_bf16_f32 v50, v36, v37
  v_cvt_pk_bf16_f32 v51, v38, v39
  v_mfma_f32_32x32x16_bf16 v[56:71], v[156:159], v[52:55], v[56:71]
  v_exp_f32 v40, v40
  v_exp_f32 v41, v41
  v_exp_f32 v42, v42
  v_exp_f32 v43, v43
  v_mfma_f32_32x32x16_bf16 v[72:87], v[152:155], v[48:51], v[72:87]
  ds_read_b128 v[152:155], v4 offset:8192
  v_exp_f32 v44, v44
  v_exp_f32 v45, v45
  v_exp_f32 v46, v46
  v_exp_f32 v47, v47
  v_cvt_pk_bf16_f32 v52, v40, v41
  v_cvt_pk_bf16_f32 v53, v42, v43
  v_cvt_pk_bf16_f32 v54, v44, v45
  v_cvt_pk_bf16_f32 v55, v46, v47
  v_mfma_f32_32x32x16_bf16 v[32:47], v[144:147], v[136:139], v[112:127]
  s_add_u32 s27, s27, 16384
  ds_read_b128 v[144:147], v4 offset:2048
  v_exp_f32 v16, v16
  v_exp_f32 v17, v17
  v_exp_f32 v18, v18
  v_exp_f32 v19, v19
  v_smfmac_f32_16x16x64_bf16 v[92:95], v[160:163], v[48:55], v167
  s_waitcnt lgkmcnt(1)
  v_exp_f32 v20, v20
  v_exp_f32 v21, v21
  v_mfma_f32_32x32x16_bf16 v[32:47], v[148:151], v[140:143], v[32:47]
  s_and_b32 s27, s27, 65535
  ds_read_b128 v[148:151], v4 offset:3072
  v_exp_f32 v22, v22
  v_exp_f32 v23, v23
  v_cvt_pk_bf16_f32 v48, v16, v17
  v_cvt_pk_bf16_f32 v49, v18, v19
  v_cvt_pk_bf16_f32 v50, v20, v21
  v_cvt_pk_bf16_f32 v51, v22, v23
  v_mfma_f32_32x32x16_bf16 v[72:87], v[156:159], v[52:55], v[72:87]
  s_add_u32 m0, s26, s29
  ds_read_b128 v[156:159], v4 offset:9216
  v_exp_f32 v24, v24
  v_exp_f32 v25, v25
  v_exp_f32 v26, v26
  v_exp_f32 v27, v27
  v_mfma_f32_32x32x16_bf16 v[56:71], v[152:155], v[48:51], v[56:71]
  s_waitcnt lgkmcnt(2)
  v_exp_f32 v28, v28
  v_exp_f32 v29, v29
  v_exp_f32 v30, v30
  v_exp_f32 v31, v31
  v_cvt_pk_bf16_f32 v52, v24, v25
  v_cvt_pk_bf16_f32 v53, v26, v27
  v_cvt_pk_bf16_f32 v54, v28, v29
  v_cvt_pk_bf16_f32 v55, v30, v31
  v_mfma_f32_32x32x16_bf16 v[16:31], v[144:147], v[128:131], v[96:111]
  buffer_load_dwordx4 v9, s[4:7], s24 offen sc1 lds
  v_exp_f32 v32, v32
  v_exp_f32 v33, v33
  v_exp_f32 v34, v34
  v_exp_f32 v35, v35
  v_smfmac_f32_16x16x64_bf16 v[88:91], v[160:163], v[48:55], v167
  s_waitcnt lgkmcnt(0)
  v_exp_f32 v36, v36
  v_exp_f32 v37, v37
  v_mfma_f32_32x32x16_bf16 v[16:31], v[148:151], v[132:135], v[16:31]
  v_exp_f32 v38, v38
  v_exp_f32 v39, v39
  v_cvt_pk_bf16_f32 v48, v32, v33
  v_cvt_pk_bf16_f32 v49, v34, v35
  v_cvt_pk_bf16_f32 v50, v36, v37
  v_cvt_pk_bf16_f32 v51, v38, v39
  v_mfma_f32_32x32x16_bf16 v[56:71], v[156:159], v[52:55], v[56:71]
  buffer_load_dwordx4 v9, s[4:7], s24 offen offset:1024 sc1 lds
  v_exp_f32 v40, v40
  v_exp_f32 v41, v41
  v_exp_f32 v42, v42
  v_exp_f32 v43, v43
  v_mfma_f32_32x32x16_bf16 v[72:87], v[152:155], v[48:51], v[72:87]
  ds_read_b128 v[152:155], v4 offset:10240
  v_exp_f32 v44, v44
  v_exp_f32 v45, v45
  v_exp_f32 v46, v46
  v_exp_f32 v47, v47
  v_cvt_pk_bf16_f32 v52, v40, v41
  v_cvt_pk_bf16_f32 v53, v42, v43
  v_cvt_pk_bf16_f32 v54, v44, v45
  v_cvt_pk_bf16_f32 v55, v46, v47
  v_mfma_f32_32x32x16_bf16 v[32:47], v[144:147], v[136:139], v[112:127]
  ds_read_b128 v[144:147], v4 offset:4096
  v_exp_f32 v16, v16
  v_exp_f32 v17, v17
  v_exp_f32 v18, v18
  v_exp_f32 v19, v19
  v_smfmac_f32_16x16x64_bf16 v[92:95], v[160:163], v[48:55], v167
  s_waitcnt lgkmcnt(1)
  v_add_u32 v3, s27, v2
  v_exp_f32 v20, v20
  v_exp_f32 v21, v21
  v_mfma_f32_32x32x16_bf16 v[32:47], v[148:151], v[140:143], v[32:47]
  ds_read_b128 v[148:151], v4 offset:5120
  v_exp_f32 v22, v22
  v_exp_f32 v23, v23
  v_cvt_pk_bf16_f32 v48, v16, v17
  v_cvt_pk_bf16_f32 v49, v18, v19
  v_cvt_pk_bf16_f32 v50, v20, v21
  v_cvt_pk_bf16_f32 v51, v22, v23
  v_mfma_f32_32x32x16_bf16 v[72:87], v[156:159], v[52:55], v[72:87]
  ds_read_b128 v[156:159], v4 offset:11264
  v_exp_f32 v24, v24
  v_exp_f32 v25, v25
  v_exp_f32 v26, v26
  v_exp_f32 v27, v27
  v_mfma_f32_32x32x16_bf16 v[56:71], v[152:155], v[48:51], v[56:71]
  s_waitcnt lgkmcnt(2)
  v_exp_f32 v28, v28
  v_exp_f32 v29, v29
  v_exp_f32 v30, v30
  v_exp_f32 v31, v31
  v_cvt_pk_bf16_f32 v52, v24, v25
  v_cvt_pk_bf16_f32 v53, v26, v27
  v_cvt_pk_bf16_f32 v54, v28, v29
  v_cvt_pk_bf16_f32 v55, v30, v31
  v_mfma_f32_32x32x16_bf16 v[16:31], v[144:147], v[128:131], v[96:111]
  buffer_load_dwordx4 v9, s[4:7], s24 offen offset:2048 sc1 lds
  v_exp_f32 v32, v32
  v_exp_f32 v33, v33
  v_exp_f32 v34, v34
  v_exp_f32 v35, v35
  v_smfmac_f32_16x16x64_bf16 v[88:91], v[160:163], v[48:55], v167
  s_waitcnt lgkmcnt(0)
  v_exp_f32 v36, v36
  v_exp_f32 v37, v37
  v_mfma_f32_32x32x16_bf16 v[16:31], v[148:151], v[132:135], v[16:31]
  v_exp_f32 v38, v38
  v_exp_f32 v39, v39
  v_cvt_pk_bf16_f32 v48, v32, v33
  v_cvt_pk_bf16_f32 v49, v34, v35
  v_cvt_pk_bf16_f32 v50, v36, v37
  v_cvt_pk_bf16_f32 v51, v38, v39
  v_mfma_f32_32x32x16_bf16 v[56:71], v[156:159], v[52:55], v[56:71]
  buffer_load_dwordx4 v9, s[4:7], s24 offen offset:3072 sc1 lds
  v_exp_f32 v40, v40
  v_exp_f32 v41, v41
  v_exp_f32 v42, v42
  v_exp_f32 v43, v43
  v_mfma_f32_32x32x16_bf16 v[72:87], v[152:155], v[48:51], v[72:87]
  s_add_u32 s24, s24, 8192
  ds_read_b128 v[152:155], v4 offset:12288
  v_exp_f32 v44, v44
  v_exp_f32 v45, v45
  v_exp_f32 v46, v46
  v_exp_f32 v47, v47
  v_cvt_pk_bf16_f32 v52, v40, v41
  v_cvt_pk_bf16_f32 v53, v42, v43
  v_cvt_pk_bf16_f32 v54, v44, v45
  v_cvt_pk_bf16_f32 v55, v46, v47
  v_mfma_f32_32x32x16_bf16 v[32:47], v[144:147], v[136:139], v[112:127]
  s_cmp_lt_u32 s24, s35
  ds_read_b128 v[144:147], v4 offset:6144
  v_exp_f32 v16, v16
  v_exp_f32 v17, v17
  v_exp_f32 v18, v18
  v_exp_f32 v19, v19
  v_smfmac_f32_16x16x64_bf16 v[92:95], v[160:163], v[48:55], v167
  s_waitcnt lgkmcnt(1)
  v_exp_f32 v20, v20
  v_exp_f32 v21, v21
  v_mfma_f32_32x32x16_bf16 v[32:47], v[148:151], v[140:143], v[32:47]
  s_cselect_b32 s6, s6, 0
  ds_read_b128 v[148:151], v4 offset:7168
  v_exp_f32 v22, v22
  v_exp_f32 v23, v23
  v_cvt_pk_bf16_f32 v48, v16, v17
  v_cvt_pk_bf16_f32 v49, v18, v19
  v_cvt_pk_bf16_f32 v50, v20, v21
  v_cvt_pk_bf16_f32 v51, v22, v23
  v_mfma_f32_32x32x16_bf16 v[72:87], v[156:159], v[52:55], v[72:87]
  s_mov_b32 m0, s83
  ds_read_b128 v[156:159], v4 offset:13312
  v_exp_f32 v24, v24
  v_exp_f32 v25, v25
  v_exp_f32 v26, v26
  v_exp_f32 v27, v27
  v_mfma_f32_32x32x16_bf16 v[56:71], v[152:155], v[48:51], v[56:71]
  s_waitcnt lgkmcnt(2)
  v_exp_f32 v28, v28
  v_exp_f32 v29, v29
  v_exp_f32 v30, v30
  v_exp_f32 v31, v31
  v_cvt_pk_bf16_f32 v52, v24, v25
  v_cvt_pk_bf16_f32 v53, v26, v27
  v_cvt_pk_bf16_f32 v54, v28, v29
  v_cvt_pk_bf16_f32 v55, v30, v31
  v_mfma_f32_32x32x16_bf16 v[16:31], v[144:147], v[128:131], v[96:111]
  buffer_load_dwordx4 v172, s[52:55], s82 offen offset:0 sc1 lds
  v_exp_f32 v32, v32
  v_exp_f32 v33, v33
  v_exp_f32 v34, v34
  v_exp_f32 v35, v35
  v_smfmac_f32_16x16x64_bf16 v[88:91], v[160:163], v[48:55], v167
  s_waitcnt lgkmcnt(0)
  v_exp_f32 v36, v36
  v_exp_f32 v37, v37
  v_mfma_f32_32x32x16_bf16 v[16:31], v[148:151], v[132:135], v[16:31]
  s_add_u32 s26, s26, 16384
  v_exp_f32 v38, v38
  v_exp_f32 v39, v39
  v_cvt_pk_bf16_f32 v48, v32, v33
  v_cvt_pk_bf16_f32 v49, v34, v35
  v_cvt_pk_bf16_f32 v50, v36, v37
  v_cvt_pk_bf16_f32 v51, v38, v39
  v_mfma_f32_32x32x16_bf16 v[56:71], v[156:159], v[52:55], v[56:71]
  buffer_load_dwordx4 v173, s[52:55], s82 offen offset:1024 sc1 lds
  v_exp_f32 v40, v40
  v_exp_f32 v41, v41
  v_exp_f32 v42, v42
  v_exp_f32 v43, v43
  v_mfma_f32_32x32x16_bf16 v[72:87], v[152:155], v[48:51], v[72:87]
  s_waitcnt vmcnt(7)
  s_barrier
  ds_read_b128 v[152:155], v4 offset:14336
  v_exp_f32 v44, v44
  v_exp_f32 v45, v45
  v_exp_f32 v46, v46
  v_exp_f32 v47, v47
  v_cvt_pk_bf16_f32 v52, v40, v41
  v_cvt_pk_bf16_f32 v53, v42, v43
  v_cvt_pk_bf16_f32 v54, v44, v45
  v_cvt_pk_bf16_f32 v55, v46, v47
  v_mfma_f32_32x32x16_bf16 v[32:47], v[144:147], v[136:139], v[112:127]
  s_and_b32 s26, s26, 65535
  ds_read_b128 v[144:147], v3 offset:0
  v_exp_f32 v16, v16
  v_exp_f32 v17, v17
  v_exp_f32 v18, v18
  v_exp_f32 v19, v19
  v_smfmac_f32_16x16x64_bf16 v[92:95], v[160:163], v[48:55], v167
  s_waitcnt lgkmcnt(1)
  v_exp_f32 v20, v20
  v_exp_f32 v21, v21
  v_mfma_f32_32x32x16_bf16 v[32:47], v[148:151], v[140:143], v[32:47]
  s_add_u32 s83, s83, s45
  ds_read_b128 v[148:151], v3 offset:1024
  v_exp_f32 v22, v22
  v_exp_f32 v23, v23
  v_cvt_pk_bf16_f32 v48, v16, v17
  v_cvt_pk_bf16_f32 v49, v18, v19
  v_cvt_pk_bf16_f32 v50, v20, v21
  v_cvt_pk_bf16_f32 v51, v22, v23
  v_mfma_f32_32x32x16_bf16 v[72:87], v[156:159], v[52:55], v[72:87]
  s_sub_u32 s28, s28, 1
  ds_read_b128 v[156:159], v4 offset:15360
  v_exp_f32 v24, v24
  v_exp_f32 v25, v25
  v_exp_f32 v26, v26
  v_exp_f32 v27, v27
  v_mfma_f32_32x32x16_bf16 v[56:71], v[152:155], v[48:51], v[56:71]
  s_waitcnt lgkmcnt(2)
  v_exp_f32 v28, v28
  v_exp_f32 v29, v29
  v_exp_f32 v30, v30
  v_exp_f32 v31, v31
  v_cvt_pk_bf16_f32 v52, v24, v25
  v_cvt_pk_bf16_f32 v53, v26, v27
  v_cvt_pk_bf16_f32 v54, v28, v29
  v_cvt_pk_bf16_f32 v55, v30, v31
  v_mfma_f32_32x32x16_bf16 v[16:31], v[144:147], v[128:131], v[96:111]
  buffer_load_dwordx4 v174, s[52:55], s82 offen offset:2048 sc1 lds
  v_exp_f32 v32, v32
  v_exp_f32 v33, v33
  v_exp_f32 v34, v34
  v_exp_f32 v35, v35
  v_smfmac_f32_16x16x64_bf16 v[88:91], v[160:163], v[48:55], v167
  s_waitcnt lgkmcnt(0)
  v_exp_f32 v36, v36
  v_exp_f32 v37, v37
  v_mfma_f32_32x32x16_bf16 v[16:31], v[148:151], v[132:135], v[16:31]
  v_exp_f32 v38, v38
  v_exp_f32 v39, v39
  v_cvt_pk_bf16_f32 v48, v32, v33
  v_cvt_pk_bf16_f32 v49, v34, v35
  v_cvt_pk_bf16_f32 v50, v36, v37
  v_cvt_pk_bf16_f32 v51, v38, v39
  v_mfma_f32_32x32x16_bf16 v[56:71], v[156:159], v[52:55], v[56:71]
  buffer_load_dwordx4 v175, s[52:55], s82 offen offset:3072 sc1 lds
  v_exp_f32 v40, v40
  v_exp_f32 v41, v41
  v_exp_f32 v42, v42
  v_exp_f32 v43, v43
  v_mfma_f32_32x32x16_bf16 v[72:87], v[152:155], v[48:51], v[72:87]
  s_bitcmp1_b32 s33, s28
  ds_read_b128 v[152:155], v3 offset:8192
  v_exp_f32 v44, v44
  v_exp_f32 v45, v45
  v_exp_f32 v46, v46
  v_exp_f32 v47, v47
  v_cvt_pk_bf16_f32 v52, v40, v41
  v_cvt_pk_bf16_f32 v53, v42, v43
  v_cvt_pk_bf16_f32 v54, v44, v45
  v_cvt_pk_bf16_f32 v55, v46, v47
  s_cbranch_scc0 L_attn_loop
  s_bitcmp1_b32 128, s28
  s_cbranch_scc0 L_attn_n7
  buffer_store_dwordx4 v[12:15], v9, s[48:51], s84 offen offset:0 sc1
  buffer_store_dwordx4 v[12:15], v9, s[48:51], s84 offen offset:1024 sc1
  buffer_store_dwordx4 v[12:15], v9, s[48:51], s84 offen offset:2048 sc1
  buffer_store_dwordx4 v[12:15], v9, s[48:51], s84 offen offset:3072 sc1
  s_branch L_attn_loop
L_attn_n7:
  s_bitcmp1_b32 8, s28
  s_cbranch_scc0 L_attn_n3
  s_add_u32 s52, s62, 41943040
  s_addc_u32 s53, s63, 0
  s_mov_b32 s54, 360448
  s_mov_b32 s55, 0x20000
  s_mov_b32 s82, 16384
  s_mov_b32 s83, 86016
  s_mov_b32 s44, 0
  s_mov_b32 s45, 0
  v_mov_b32 v172, v9
  v_mov_b32 v173, v9
  v_mov_b32 v174, v9
  v_mov_b32 v175, v9
  s_branch L_attn_loop
L_attn_n3:
L_c2:
  v_mfma_f32_32x32x16_bf16 v[72:87], v[156:159], v[52:55], v[72:87]
  v_smfmac_f32_16x16x64_bf16 v[92:95], v[160:163], v[48:55], v167
  v_add_f32 v88, v88, v89
  s_nop 6
  v_add_f32 v92, v92, v93
  v_rcp_f32 v6, v88
  v_mul_f32 v12, 0, v56
  v_mul_f32 v13, 0, v57
  v_mov_b32 v7, v6
  v_pk_mul_f32 v[56:57], v[56:57], v[6:7]
  v_pk_fma_f32 v[12:13], v[58:59], 0, v[12:13] op_sel_hi:[1,0,1]
  v_pk_mul_f32 v[58:59], v[58:59], v[6:7]
  v_pk_fma_f32 v[12:13], v[60:61], 0, v[12:13] op_sel_hi:[1,0,1]
  v_pk_mul_f32 v[60:61], v[60:61], v[6:7]
  v_pk_fma_f32 v[12:13], v[62:63], 0, v[12:13] op_sel_hi:[1,0,1]
  v_pk_mul_f32 v[62:63], v[62:63], v[6:7]
  v_pk_fma_f32 v[12:13], v[64:65], 0, v[12:13] op_sel_hi:[1,0,1]
  v_pk_mul_f32 v[64:65], v[64:65], v[6:7]
  v_pk_fma_f32 v[12:13], v[66:67], 0, v[12:13] op_sel_hi:[1,0,1]
  v_pk_mul_f32 v[66:67], v[66:67], v[6:7]
  v_pk_fma_f32 v[12:13], v[68:69], 0, v[12:13] op_sel_hi:[1,0,1]
  v_pk_mul_f32 v[68:69], v[68:69], v[6:7]
  v_pk_fma_f32 v[12:13], v[70:71], 0, v[12:13] op_sel_hi:[1,0,1]
  v_pk_mul_f32 v[70:71], v[70:71], v[6:7]
  v_cvt_pk_bf16_f32 v32, v56, v57
  v_cvt_pk_bf16_f32 v33, v58, v59
  v_cvt_pk_bf16_f32 v34, v64, v65
  v_cvt_pk_bf16_f32 v35, v66, v67
  buffer_store_dwordx4 v[32:35], v166, s[12:15], s41 offen offset:0 sc1
  v_cvt_pk_bf16_f32 v36, v60, v61
  v_cvt_pk_bf16_f32 v37, v62, v63
  v_cvt_pk_bf16_f32 v38, v68, v69
  v_cvt_pk_bf16_f32 v39, v70, v71
  buffer_store_dwordx4 v[36:39], v166, s[12:15], s41 offen offset:512 sc1
  v_rcp_f32 v6, v92
  s_nop 0
  v_mov_b32 v7, v6
  v_pk_fma_f32 v[12:13], v[72:73], 0, v[12:13] op_sel_hi:[1,0,1]
  v_pk_mul_f32 v[72:73], v[72:73], v[6:7]
  v_pk_fma_f32 v[12:13], v[74:75], 0, v[12:13] op_sel_hi:[1,0,1]
  v_pk_mul_f32 v[74:75], v[74:75], v[6:7]
  v_pk_fma_f32 v[12:13], v[76:77], 0, v[12:13] op_sel_hi:[1,0,1]
  v_pk_mul_f32 v[76:77], v[76:77], v[6:7]
  v_pk_fma_f32 v[12:13], v[78:79], 0, v[12:13] op_sel_hi:[1,0,1]
  v_pk_mul_f32 v[78:79], v[78:79], v[6:7]
  v_pk_fma_f32 v[12:13], v[80:81], 0, v[12:13] op_sel_hi:[1,0,1]
  v_pk_mul_f32 v[80:81], v[80:81], v[6:7]
  v_pk_fma_f32 v[12:13], v[82:83], 0, v[12:13] op_sel_hi:[1,0,1]
  v_pk_mul_f32 v[82:83], v[82:83], v[6:7]
  v_pk_fma_f32 v[12:13], v[84:85], 0, v[12:13] op_sel_hi:[1,0,1]
  v_pk_mul_f32 v[84:85], v[84:85], v[6:7]
  v_pk_fma_f32 v[12:13], v[86:87], 0, v[12:13] op_sel_hi:[1,0,1]
  v_pk_mul_f32 v[86:87], v[86:87], v[6:7]
  v_cvt_pk_bf16_f32 v40, v72, v73
  v_cvt_pk_bf16_f32 v41, v74, v75
  v_cvt_pk_bf16_f32 v42, v80, v81
  v_cvt_pk_bf16_f32 v43, v82, v83
  buffer_store_dwordx4 v[40:43], v166, s[12:15], s41 offen offset:2048 sc1
  v_cvt_pk_bf16_f32 v44, v76, v77
  v_cvt_pk_bf16_f32 v45, v78, v79
  v_cvt_pk_bf16_f32 v46, v84, v85
  v_cvt_pk_bf16_f32 v47, v86, v87
  buffer_store_dwordx4 v[44:47], v166, s[12:15], s41 offen offset:2560 sc1
  v_max_f32 v5, v88, v92
  v_mov_b32 v8, 0x5d800000
  v_cmp_u_f32 s[30:31], v88, v92
  v_cmp_nle_f32 s[56:57], v5, v8
  v_cmp_u_f32 vcc, v12, v13
  s_nop 0
  s_or_b64 s[30:31], s[30:31], s[56:57]
  s_or_b64 s[30:31], s[30:31], vcc
  s_cselect_b32 s30, 1, 0
  v_mov_b32 v5, s30
  s_lshl_b32 s31, s20, 2
  s_add_u32 s31, s31, 90112
  v_mov_b32 v6, s31
  ds_write_b32 v6, v5
  v_mov_b32 v6, 90112
  s_waitcnt vmcnt(4) lgkmcnt(0)
  s_barrier
  ds_read_b128 v[12:15], v6
  s_waitcnt lgkmcnt(0)
  v_or3_b32 v12, v12, v13, v14
  v_or_b32 v12, v12, v15
  s_nop 0
  v_readfirstlane_b32 s30, v12
  s_cmp_eq_u32 s33, 1
  s_nop 0
  s_cselect_b32 s30, 0, s30
  s_cmp_lg_u32 s30, 0
  s_cbranch_scc1 L_attn_redo
  s_mov_b32 s85, s22
  s_add_u32 s8, s62, 16777216
  s_addc_u32 s9, s63, 0
  s_mov_b32 s10, 4194304
  s_mov_b32 s11, 0x20000
  s_add_u32 s12, s62, 41943040
  s_addc_u32 s13, s63, 0
  s_mov_b32 s14, 360448
  s_mov_b32 s15, 0x20000
  s_add_u32 s48, s62, 20971520
  s_addc_u32 s49, s63, 0
  s_mov_b32 s50, 4194304
  s_mov_b32 s51, 0x20000
  s_lshl_b32 s25, s80, 13
  s_lshl_b32 s30, s20, 11
  s_add_u32 s25, s25, s30
  s_mov_b32 s38, s25
  s_lshl_b32 s39, s80, 7
  s_lshl_b32 s30, s20, 5
  s_add_u32 s39, s39, s30
  v_and_b32 v185, 15, v1
  v_lshrrev_b32 v186, 4, v1
  v_lshlrev_b32 v187, 2, v185
  s_lshl_b32 s35, s39, 2
  v_lshrrev_b32 v28, 2, v1
  v_lshlrev_b32 v29, 7, v28
  v_and_b32 v30, 3, v1
  v_lshl_add_u32 v29, v30, 3, v29
  v_bfe_u32 v28, v28, 1, 2
  v_xor_b32 v30, 0, v28
  v_lshl_add_u32 v172, v30, 5, v29
  v_mov_b32 v176, v172
  v_xor_b32 v30, 1, v28
  v_lshl_add_u32 v173, v30, 5, v29
  v_mov_b32 v177, v173
  v_xor_b32 v30, 2, v28
  v_lshl_add_u32 v174, v30, 5, v29
  v_mov_b32 v178, v174
  v_xor_b32 v30, 3, v28
  v_lshl_add_u32 v175, v30, 5, v29
  v_mov_b32 v179, v175
  v_add_u32 v176, 65536, v172
  v_add_u32 v180, 131072, v172
  v_add_u32 v177, 65536, v173
  v_add_u32 v181, 131072, v173
  v_add_u32 v178, 65536, v174
  v_add_u32 v182, 131072, v174
  v_add_u32 v179, 65536, v175
  v_add_u32 v183, 131072, v175
  v_and_b32 v28, 1, v1
  v_lshlrev_b32 v28, 6, v28
  v_lshl_add_u32 v184, v186, 4, v28
  v_add_u32 v184, 86016, v184
  v_mov_b32 v64, 0
  v_mov_b32 v65, 0
  v_mov_b32 v66, 0
  v_mov_b32 v67, 0
  v_mov_b32 v68, 0
  v_mov_b32 v69, 0
  v_mov_b32 v70, 0
  v_mov_b32 v71, 0
  v_mov_b32 v72, 0
  v_mov_b32 v73, 0
  v_mov_b32 v74, 0
  v_mov_b32 v75, 0
  v_mov_b32 v76, 0
  v_mov_b32 v77, 0
  v_mov_b32 v78, 0
  v_mov_b32 v79, 0
  v_mov_b32 v80, 0
  v_mov_b32 v81, 0
  v_mov_b32 v82, 0
  v_mov_b32 v83, 0
  v_mov_b32 v84, 0
  v_mov_b32 v85, 0
  v_mov_b32 v86, 0
  v_mov_b32 v87, 0
  v_mov_b32 v88, 0
  v_mov_b32 v89, 0
  v_mov_b32 v90, 0
  v_mov_b32 v91, 0
  v_mov_b32 v92, 0
  v_mov_b32 v93, 0
  v_mov_b32 v94, 0
  v_mov_b32 v95, 0
  v_mov_b32 v96, 0
  v_mov_b32 v97, 0
  v_mov_b32 v98, 0
  v_mov_b32 v99, 0
  v_mov_b32 v100, 0
  v_mov_b32 v101, 0
  v_mov_b32 v102, 0
  v_mov_b32 v103, 0
  s_lshl_b32 s30, s81, 18
  s_add_u32 s38, s38, s30
  s_add_u32 s39, s38, 131072
  s_lshl_b32 s40, s81, 13
  s_add_u32 s40, s40, s35
  s_add_u32 s40, s40, 32768
  s_add_u32 s41, s35, 8192
  s_lshr_b32 s42, s80, 1
  s_lshl_b32 s83, s20, 12
  s_mov_b32 s82, 1310720
  s_mov_b32 s52, s68
  s_mov_b32 s53, s69
  s_mov_b32 s54, 2097152
  s_mov_b32 s55, 0x20000
  s_mov_b32 s16, s64
  s_mov_b32 s17, s65
  s_mov_b32 s18, 4194304
  s_mov_b32 s19, 0x20000
  v_lshlrev_b32 v188, 11, v185
  v_and_b32 v28, 1, v186
  v_lshl_add_u32 v188, v28, 5, v188
  v_lshrrev_b32 v28, 1, v186
  v_lshl_add_u32 v188, v28, 4, v188
  s_mov_b32 s43, s35
  s_lshl_b32 s46, s35, 9
  s_lshl_b32 s30, s81, 7
  s_add_u32 s46, s46, s30
  s_add_u32 s47, s46, 32768
  s_add_u32 s30, s85, 16
  s_lshl_b32 s30, s30, 8
  v_mov_b32 v30, s30
  v_mov_b32 v31, 1
  s_waitcnt vmcnt(0) lgkmcnt(0)
  s_barrier
  s_cmp_lg_u32 s20, 0
  s_cbranch_scc1 L_sig_p2
  s_mov_b64 exec, 1
  global_atomic_add v30, v31, s[58:59] sc1
  s_mov_b64 exec, -1
L_sig_p2:
  ds_read_b64_tr_b16 a[64:65], v172 offset:0
  ds_read_b64_tr_b16 a[66:67], v172 offset:2048
  ds_read_b64_tr_b16 a[68:69], v173 offset:0
  ds_read_b64_tr_b16 a[70:71], v173 offset:2048
  ds_read_b64_tr_b16 a[72:73], v174 offset:0
  ds_read_b64_tr_b16 a[74:75], v174 offset:2048
  ds_read_b64_tr_b16 a[76:77], v175 offset:0
  ds_read_b64_tr_b16 a[78:79], v175 offset:2048
  ds_read_b128 a[80:83], v184 offset:0
  ds_read_b64_tr_b16 a[84:85], v172 offset:4096
  ds_read_b64_tr_b16 a[86:87], v172 offset:6144
  ds_read_b64_tr_b16 a[88:89], v173 offset:4096
  ds_read_b64_tr_b16 a[90:91], v173 offset:6144
  s_add_u32 s30, s42, 16
  s_lshl_b32 s30, s30, 8
  v_mov_b32 v30, s30
  v_mov_b32 v29, 0
  s_cmp_lg_u32 s20, 0
  s_cbranch_scc1 L_np_p3
  s_mov_b64 exec, 1
  global_atomic_add v31, v30, v29, s[58:59] sc0 sc1
  s_mov_b64 exec, -1
L_np_p3:
  s_add_u32 m0, s83, 98304
  s_nop 0
  buffer_load_dwordx4 v168, s[52:55], s82 offen offset:0 lds
  buffer_load_dwordx4 v169, s[52:55], s82 offen offset:1024 lds
  buffer_load_dwordx4 v170, s[52:55], s82 offen offset:2048 lds
  buffer_load_dwordx4 v171, s[52:55], s82 offen offset:3072 lds
  s_add_u32 s82, s82, 262144
  s_add_u32 m0, s83, 114688
  s_nop 0
  buffer_load_dwordx4 v168, s[52:55], s82 offen offset:0 lds
  buffer_load_dwordx4 v169, s[52:55], s82 offen offset:1024 lds
  buffer_load_dwordx4 v170, s[52:55], s82 offen offset:2048 lds
  buffer_load_dwordx4 v171, s[52:55], s82 offen offset:3072 lds
  s_add_u32 s82, s82, 262144
  s_add_u32 m0, s83, 131072
  s_nop 0
  buffer_load_dwordx4 v168, s[52:55], s82 offen offset:0 lds
  buffer_load_dwordx4 v169, s[52:55], s82 offen offset:1024 lds
  buffer_load_dwordx4 v170, s[52:55], s82 offen offset:2048 lds
  buffer_load_dwordx4 v171, s[52:55], s82 offen offset:3072 lds
  s_add_u32 s82, s82, 262144
  s_cmp_lg_u32 s20, 0
  s_cbranch_scc1 L_go_p3
  s_mov_b32 s31, 0x40000
  s_waitcnt vmcnt(12)
L_poll_p3:
  v_readfirstlane_b32 s30, v31
  s_sub_u32 s31, s31, 1
  s_nop 0
  s_cselect_b32 s30, 32, s30
  s_cmp_ge_u32 s30, 32
  s_cbranch_scc1 L_go_p3
  s_sleep 2
  s_mov_b64 exec, 1
  global_atomic_add v31, v30, v29, s[58:59] sc0 sc1
  s_mov_b64 exec, -1
  s_waitcnt vmcnt(0)
  s_branch L_poll_p3
L_go_p3:
  s_barrier
  buffer_load_dwordx4 a[0:3], v9, s[8:11], s25 offen offset:0 sc1
  buffer_load_dwordx4 a[4:7], v9, s[8:11], s25 offen offset:1024 sc1
  s_add_u32 s25, s25, 131072
  buffer_load_dwordx4 a[8:11], v9, s[8:11], s25 offen offset:0 sc1
  buffer_load_dwordx4 a[12:15], v9, s[8:11], s25 offen offset:1024 sc1
  s_add_u32 s25, s25, 131072
  buffer_load_dwordx4 a[16:19], v9, s[8:11], s25 offen offset:0 sc1
  buffer_load_dwordx4 a[20:23], v9, s[8:11], s25 offen offset:1024 sc1
  s_add_u32 s25, s25, 131072
  buffer_load_dwordx4 a[24:27], v9, s[8:11], s25 offen offset:0 sc1
  buffer_load_dwordx4 a[28:31], v9, s[8:11], s25 offen offset:1024 sc1
  s_add_u32 s25, s25, 131072
  buffer_load_dwordx4 a[32:35], v9, s[8:11], s25 offen offset:0 sc1
  buffer_load_dwordx4 a[36:39], v9, s[8:11], s25 offen offset:1024 sc1
  s_add_u32 s25, s25, 131072
  buffer_load_dwordx4 a[40:43], v9, s[8:11], s25 offen offset:0 sc1
  buffer_load_dwordx4 a[44:47], v9, s[8:11], s25 offen offset:1024 sc1
  s_add_u32 s25, s25, 131072
  buffer_load_dwordx4 a[48:51], v9, s[8:11], s25 offen offset:0 sc1
  buffer_load_dwordx4 a[52:55], v9, s[8:11], s25 offen offset:1024 sc1
  s_add_u32 s25, s25, 131072
  s_waitcnt vmcnt(12) lgkmcnt(9)
  v_mfma_f32_16x16x32_bf16 v[64:67], a[64:67], a[0:3], v[64:67]
  ds_read_b64_tr_b16 a[92:93], v174 offset:4096
  v_mfma_f32_16x16x32_bf16 v[68:71], a[64:67], a[4:7], v[68:71]
  ds_read_b64_tr_b16 a[94:95], v174 offset:6144
  v_mfma_f32_16x16x32_bf16 v[76:79], a[68:71], a[4:7], v[76:79]
  ds_read_b64_tr_b16 a[64:65], v175 offset:4096
  s_and_b32 s30, s2, 7
  v_mfma_f32_16x16x32_bf16 v[72:75], a[68:71], a[0:3], v[72:75]
  s_waitcnt lgkmcnt(8)
  ds_read_b64_tr_b16 a[66:67], v175 offset:6144
  buffer_load_dwordx4 a[56:59], v9, s[8:11], s25 offen offset:0 sc1
  s_lshr_b32 s31, s2, 3
  v_mfma_f32_16x16x32_bf16 v[80:83], a[72:75], a[0:3], v[80:83]
  ds_read_b128 a[68:71], v184 offset:128
  s_and_b32 s21, s30, 1
  v_mfma_f32_16x16x32_bf16 v[84:87], a[72:75], a[4:7], v[84:87]
  s_lshl_b32 s21, s21, 2
  v_mfma_f32_16x16x32_bf16 v[92:95], a[76:79], a[4:7], v[92:95]
  ds_read_b64_tr_b16 a[72:73], v172 offset:8192
  s_and_b32 s32, s31, 3
  v_mfma_f32_16x16x32_bf16 v[88:91], a[76:79], a[0:3], v[88:91]
  s_waitcnt lgkmcnt(8)
  ds_read_b64_tr_b16 a[74:75], v172 offset:10240
  s_add_u32 s21, s21, s32
  v_mfma_f32_16x16x32_bf16 v[96:99], a[80:83], a[0:3], v[96:99]
  ds_read_b64_tr_b16 a[76:77], v173 offset:8192
  buffer_load_dwordx4 a[60:63], v9, s[8:11], s25 offen offset:1024 sc1
  s_add_u32 s25, s25, 131072
  v_mfma_f32_16x16x32_bf16 v[100:103], a[80:83], a[4:7], v[100:103]
  s_waitcnt vmcnt(12)
  ds_read_b64_tr_b16 a[78:79], v173 offset:10240
  s_lshr_b32 s22, s30, 1
  v_mfma_f32_16x16x32_bf16 v[68:71], a[84:87], a[12:15], v[68:71]
  ds_read_b64_tr_b16 a[80:81], v174 offset:8192
  s_mul_i32 s22, s22, 8
  v_mfma_f32_16x16x32_bf16 v[64:67], a[84:87], a[8:11], v[64:67]
  s_waitcnt lgkmcnt(8)
  ds_read_b64_tr_b16 a[82:83], v174 offset:10240
  s_lshr_b32 s32, s31, 2
  v_mfma_f32_16x16x32_bf16 v[72:75], a[88:91], a[8:11], v[72:75]
  ds_read_b64_tr_b16 a[84:85], v175 offset:8192
  s_add_u32 s22, s22, s32
  v_mfma_f32_16x16x32_bf16 v[76:79], a[88:91], a[12:15], v[76:79]
  ds_read_b64_tr_b16 a[86:87], v175 offset:10240
  buffer_load_dwordx4 a[0:3], v9, s[8:11], s25 offen offset:0 sc1
  s_and_b32 s30, s20, 1
  v_mfma_f32_16x16x32_bf16 v[84:87], a[92:95], a[12:15], v[84:87]
  ds_read_b128 a[88:91], v184 offset:256
  s_mul_i32 s30, s30, 448
  v_mfma_f32_16x16x32_bf16 v[80:83], a[92:95], a[8:11], v[80:83]
  s_waitcnt lgkmcnt(9)
  s_and_b32 s33, s22, 1
  v_mfma_f32_16x16x32_bf16 v[88:91], a[64:67], a[8:11], v[88:91]
  ds_read_b64_tr_b16 a[92:93], v172 offset:12288
  s_lshl_b32 s36, s33, 4
  v_mfma_f32_16x16x32_bf16 v[92:95], a[64:67], a[12:15], v[92:95]
  ds_read_b64_tr_b16 a[94:95], v172 offset:14336
  s_sub_u32 s37, s33, 12
  v_mfma_f32_16x16x32_bf16 v[100:103], a[68:71], a[12:15], v[100:103]
  ds_read_b64_tr_b16 a[64:65], v173 offset:12288
  buffer_load_dwordx4 a[4:7], v9, s[8:11], s25 offen offset:1024 sc1
  s_add_u32 s25, s25, 131072
  v_mfma_f32_16x16x32_bf16 v[96:99], a[68:71], a[8:11], v[96:99]
  s_waitcnt vmcnt(12) lgkmcnt(8)
  ds_read_b64_tr_b16 a[66:67], v173 offset:14336
  s_lshr_b32 s35, s22, 1
  v_mfma_f32_16x16x32_bf16 v[64:67], a[72:75], a[16:19], v[64:67]
  ds_read_b64_tr_b16 a[68:69], v174 offset:12288
  s_mul_i32 s35, s35, 448
  v_mfma_f32_16x16x32_bf16 v[68:71], a[72:75], a[20:23], v[68:71]
  ds_read_b64_tr_b16 a[70:71], v174 offset:14336
  s_movk_i32 s34, 7168
  v_mfma_f32_16x16x32_bf16 v[76:79], a[76:79], a[20:23], v[76:79]
  ds_read_b64_tr_b16 a[72:73], v175 offset:12288
  v_add_u32 v27, s30, v1
  v_mfma_f32_16x16x32_bf16 v[72:75], a[76:79], a[16:19], v[72:75]
  s_waitcnt lgkmcnt(8)
  ds_read_b64_tr_b16 a[74:75], v175 offset:14336
  buffer_load_dwordx4 a[8:11], v9, s[8:11], s25 offen offset:0 sc1
  v_mfma_f32_16x16x32_bf16 v[80:83], a[80:83], a[16:19], v[80:83]
  ds_read_b128 a[76:79], v184 offset:384
  v_mov_b32 v28, v27
  v_mfma_f32_16x16x32_bf16 v[84:87], a[80:83], a[20:23], v[84:87]
  v_mul_u32_u24 v29, 4682, v28
  v_lshrrev_b32 v29, 16, v29
  v_mfma_f32_16x16x32_bf16 v[92:95], a[84:87], a[20:23], v[92:95]
  ds_read_b64_tr_b16 a[80:81], v172 offset:16384
  v_mul_u32_u24 v30, 14, v29
  v_mfma_f32_16x16x32_bf16 v[88:91], a[84:87], a[16:19], v[88:91]
  s_waitcnt lgkmcnt(8)
  ds_read_b64_tr_b16 a[82:83], v172 offset:18432
  v_sub_u32 v30, v28, v30
  v_mfma_f32_16x16x32_bf16 v[96:99], a[88:91], a[16:19], v[96:99]
  ds_read_b64_tr_b16 a[84:85], v173 offset:16384
  buffer_load_dwordx4 a[12:15], v9, s[8:11], s25 offen offset:1024 sc1
  s_add_u32 s25, s25, 131072
  v_mfma_f32_16x16x32_bf16 v[100:103], a[88:91], a[20:23], v[100:103]
  s_waitcnt vmcnt(12)
  ds_read_b64_tr_b16 a[86:87], v173 offset:18432
  v_lshl_add_u32 v31, v30, 1, s37
  v_mfma_f32_16x16x32_bf16 v[68:71], a[92:95], a[28:31], v[68:71]
  ds_read_b64_tr_b16 a[88:89], v174 offset:16384
  v_cmp_gt_u32 vcc, 12, v30
  v_mfma_f32_16x16x32_bf16 v[64:67], a[92:95], a[24:27], v[64:67]
  s_waitcnt lgkmcnt(8)
  ds_read_b64_tr_b16 a[90:91], v174 offset:18432
  v_add_u32 v30, s36, v30
  v_mfma_f32_16x16x32_bf16 v[72:75], a[64:67], a[24:27], v[72:75]
  ds_read_b64_tr_b16 a[92:93], v175 offset:16384
  v_mul_lo_u32 v29, s34, v29
  s_sub_u32 s31, s35, 0
  v_mfma_f32_16x16x32_bf16 v[76:79], a[64:67], a[28:31], v[76:79]
  ds_read_b64_tr_b16 a[94:95], v175 offset:18432
  buffer_load_dwordx4 a[16:19], v9, s[8:11], s25 offen offset:0 sc1
  v_mfma_f32_16x16x32_bf16 v[84:87], a[68:71], a[28:31], v[84:87]
  ds_read_b128 a[64:67], v184 offset:512
  v_cndmask_b32 v30, v31, v30, vcc
  v_mfma_f32_16x16x32_bf16 v[80:83], a[68:71], a[24:27], v[80:83]
  s_waitcnt lgkmcnt(9)
  v_lshl_add_u32 v29, v30, 4, v29
  v_add_u32 v2, s31, v29
  v_mfma_f32_16x16x32_bf16 v[88:91], a[72:75], a[24:27], v[88:91]
  ds_read_b64_tr_b16 a[68:69], v172 offset:20480
  v_add_u32 v28, 64, v27
  v_mfma_f32_16x16x32_bf16 v[92:95], a[72:75], a[28:31], v[92:95]
  ds_read_b64_tr_b16 a[70:71], v172 offset:22528
  v_mul_u32_u24 v29, 4682, v28
  v_mfma_f32_16x16x32_bf16 v[100:103], a[76:79], a[28:31], v[100:103]
  ds_read_b64_tr_b16 a[72:73], v173 offset:20480
  buffer_load_dwordx4 a[20:23], v9, s[8:11], s25 offen offset:1024 sc1
  s_add_u32 s25, s25, 131072
  v_mfma_f32_16x16x32_bf16 v[96:99], a[76:79], a[24:27], v[96:99]
  s_waitcnt vmcnt(12) lgkmcnt(8)
  ds_read_b64_tr_b16 a[74:75], v173 offset:22528
  v_lshrrev_b32 v29, 16, v29
  v_mfma_f32_16x16x32_bf16 v[64:67], a[80:83], a[32:35], v[64:67]
  ds_read_b64_tr_b16 a[76:77], v174 offset:20480
  v_mul_u32_u24 v30, 14, v29
  v_mfma_f32_16x16x32_bf16 v[68:71], a[80:83], a[36:39], v[68:71]
  ds_read_b64_tr_b16 a[78:79], v174 offset:22528
  v_sub_u32 v30, v28, v30
  v_mfma_f32_16x16x32_bf16 v[76:79], a[84:87], a[36:39], v[76:79]
  ds_read_b64_tr_b16 a[80:81], v175 offset:20480
  v_lshl_add_u32 v31, v30, 1, s37
  v_mfma_f32_16x16x32_bf16 v[72:75], a[84:87], a[32:35], v[72:75]
  s_waitcnt lgkmcnt(8)
  ds_read_b64_tr_b16 a[82:83], v175 offset:22528
  buffer_load_dwordx4 a[24:27], v9, s[8:11], s25 offen offset:0 sc1
  v_mfma_f32_16x16x32_bf16 v[80:83], a[88:91], a[32:35], v[80:83]
  ds_read_b128 a[84:87], v184 offset:640
  v_cmp_gt_u32 vcc, 12, v30
  v_mfma_f32_16x16x32_bf16 v[84:87], a[88:91], a[36:39], v[84:87]
  v_add_u32 v30, s36, v30
  v_mul_lo_u32 v29, s34, v29
  s_sub_u32 s31, s35, 1024
  v_mfma_f32_16x16x32_bf16 v[92:95], a[92:95], a[36:39], v[92:95]
  ds_read_b64_tr_b16 a[88:89], v172 offset:24576
  v_cndmask_b32 v30, v31, v30, vcc
  v_mfma_f32_16x16x32_bf16 v[88:91], a[92:95], a[32:35], v[88:91]
  s_waitcnt lgkmcnt(8)
  ds_read_b64_tr_b16 a[90:91], v172 offset:26624
  v_lshl_add_u32 v29, v30, 4, v29
  v_mfma_f32_16x16x32_bf16 v[96:99], a[64:67], a[32:35], v[96:99]
  ds_read_b64_tr_b16 a[92:93], v173 offset:24576
  buffer_load_dwordx4 a[28:31], v9, s[8:11], s25 offen offset:1024 sc1
  s_add_u32 s25, s25, 131072
  v_mfma_f32_16x16x32_bf16 v[100:103], a[64:67], a[36:39], v[100:103]
  s_waitcnt vmcnt(12)
  ds_read_b64_tr_b16 a[94:95], v173 offset:26624
  v_add_u32 v3, s31, v29
  v_mfma_f32_16x16x32_bf16 v[68:71], a[68:71], a[44:47], v[68:71]
  ds_read_b64_tr_b16 a[64:65], v174 offset:24576
  v_add_u32 v28, 128, v27
  v_mfma_f32_16x16x32_bf16 v[64:67], a[68:71], a[40:43], v[64:67]
  s_waitcnt lgkmcnt(8)
  ds_read_b64_tr_b16 a[66:67], v174 offset:26624
  v_mul_u32_u24 v29, 4682, v28
  v_mfma_f32_16x16x32_bf16 v[72:75], a[72:75], a[40:43], v[72:75]
  ds_read_b64_tr_b16 a[68:69], v175 offset:24576
  v_lshrrev_b32 v29, 16, v29
  v_mfma_f32_16x16x32_bf16 v[76:79], a[72:75], a[44:47], v[76:79]
  ds_read_b64_tr_b16 a[70:71], v175 offset:26624
  buffer_load_dwordx4 a[32:35], v9, s[8:11], s25 offen offset:0 sc1
  v_mfma_f32_16x16x32_bf16 v[84:87], a[76:79], a[44:47], v[84:87]
  ds_read_b128 a[72:75], v184 offset:768
  v_mul_u32_u24 v30, 14, v29
  v_mfma_f32_16x16x32_bf16 v[80:83], a[76:79], a[40:43], v[80:83]
  s_waitcnt lgkmcnt(9)
  v_sub_u32 v30, v28, v30
  v_lshl_add_u32 v31, v30, 1, s37
  v_mfma_f32_16x16x32_bf16 v[88:91], a[80:83], a[40:43], v[88:91]
  ds_read_b64_tr_b16 a[76:77], v172 offset:28672
  v_cmp_gt_u32 vcc, 12, v30
  v_mfma_f32_16x16x32_bf16 v[92:95], a[80:83], a[44:47], v[92:95]
  ds_read_b64_tr_b16 a[78:79], v172 offset:30720
  v_add_u32 v30, s36, v30
  v_mfma_f32_16x16x32_bf16 v[100:103], a[84:87], a[44:47], v[100:103]
  ds_read_b64_tr_b16 a[80:81], v173 offset:28672
  buffer_load_dwordx4 a[36:39], v9, s[8:11], s25 offen offset:1024 sc1
  s_add_u32 s25, s25, 131072
  v_mfma_f32_16x16x32_bf16 v[96:99], a[84:87], a[40:43], v[96:99]
  s_waitcnt vmcnt(12) lgkmcnt(8)
  ds_read_b64_tr_b16 a[82:83], v173 offset:30720
  v_mul_lo_u32 v29, s34, v29
  s_sub_u32 s31, s35, 2048
  v_mfma_f32_16x16x32_bf16 v[64:67], a[88:91], a[48:51], v[64:67]
  ds_read_b64_tr_b16 a[84:85], v174 offset:28672
  v_cndmask_b32 v30, v31, v30, vcc
  v_mfma_f32_16x16x32_bf16 v[68:71], a[88:91], a[52:55], v[68:71]
  ds_read_b64_tr_b16 a[86:87], v174 offset:30720
  v_lshl_add_u32 v29, v30, 4, v29
  v_mfma_f32_16x16x32_bf16 v[76:79], a[92:95], a[52:55], v[76:79]
  ds_read_b64_tr_b16 a[88:89], v175 offset:28672
  v_add_u32 v4, s31, v29
  v_mfma_f32_16x16x32_bf16 v[72:75], a[92:95], a[48:51], v[72:75]
  s_waitcnt lgkmcnt(8)
  ds_read_b64_tr_b16 a[90:91], v175 offset:30720
  buffer_load_dwordx4 a[40:43], v9, s[8:11], s25 offen offset:0 sc1
  v_mfma_f32_16x16x32_bf16 v[80:83], a[64:67], a[48:51], v[80:83]
  ds_read_b128 a[92:95], v184 offset:896
  v_add_u32 v28, 192, v27
  v_mfma_f32_16x16x32_bf16 v[84:87], a[64:67], a[52:55], v[84:87]
  v_mul_u32_u24 v29, 4682, v28
  v_lshrrev_b32 v29, 16, v29
  v_mfma_f32_16x16x32_bf16 v[92:95], a[68:71], a[52:55], v[92:95]
  ds_read_b64_tr_b16 a[64:65], v172 offset:32768
  v_mul_u32_u24 v30, 14, v29
  v_mfma_f32_16x16x32_bf16 v[88:91], a[68:71], a[48:51], v[88:91]
  s_waitcnt lgkmcnt(8)
  ds_read_b64_tr_b16 a[66:67], v172 offset:34816
  v_sub_u32 v30, v28, v30
  v_mfma_f32_16x16x32_bf16 v[96:99], a[72:75], a[48:51], v[96:99]
  ds_read_b64_tr_b16 a[68:69], v173 offset:32768
  buffer_load_dwordx4 a[44:47], v9, s[8:11], s25 offen offset:1024 sc1
  s_add_u32 s25, s25, 131072
  v_mfma_f32_16x16x32_bf16 v[100:103], a[72:75], a[52:55], v[100:103]
  s_waitcnt vmcnt(12)
  ds_read_b64_tr_b16 a[70:71], v173 offset:34816
  v_lshl_add_u32 v31, v30, 1, s37
  v_mfma_f32_16x16x32_bf16 v[68:71], a[76:79], a[60:63], v[68:71]
  ds_read_b64_tr_b16 a[72:73], v174 offset:32768
  v_cmp_gt_u32 vcc, 12, v30
  v_mfma_f32_16x16x32_bf16 v[64:67], a[76:79], a[56:59], v[64:67]
  s_waitcnt lgkmcnt(8)
  ds_read_b64_tr_b16 a[74:75], v174 offset:34816
  v_add_u32 v30, s36, v30
  v_mfma_f32_16x16x32_bf16 v[72:75], a[80:83], a[56:59], v[72:75]
  ds_read_b64_tr_b16 a[76:77], v175 offset:32768
  v_mul_lo_u32 v29, s34, v29
  s_sub_u32 s31, s35, 3072
  v_mfma_f32_16x16x32_bf16 v[76:79], a[80:83], a[60:63], v[76:79]
  ds_read_b64_tr_b16 a[78:79], v175 offset:34816
  buffer_load_dwordx4 a[48:51], v9, s[8:11], s25 offen offset:0 sc1
  v_mfma_f32_16x16x32_bf16 v[84:87], a[84:87], a[60:63], v[84:87]
  ds_read_b128 a[80:83], v184 offset:1024
  v_cndmask_b32 v30, v31, v30, vcc
  v_mfma_f32_16x16x32_bf16 v[80:83], a[84:87], a[56:59], v[80:83]
  s_waitcnt lgkmcnt(9)
  v_lshl_add_u32 v29, v30, 4, v29
  v_add_u32 v5, s31, v29
  v_mfma_f32_16x16x32_bf16 v[88:91], a[88:91], a[56:59], v[88:91]
  ds_read_b64_tr_b16 a[84:85], v172 offset:36864
  v_add_u32 v28, 256, v27
  v_mfma_f32_16x16x32_bf16 v[92:95], a[88:91], a[60:63], v[92:95]
  ds_read_b64_tr_b16 a[86:87], v172 offset:38912
  v_mul_u32_u24 v29, 4682, v28
  v_mfma_f32_16x16x32_bf16 v[100:103], a[92:95], a[60:63], v[100:103]
  ds_read_b64_tr_b16 a[88:89], v173 offset:36864
  buffer_load_dwordx4 a[52:55], v9, s[8:11], s25 offen offset:1024 sc1
  s_add_u32 s25, s25, 131072
  v_mfma_f32_16x16x32_bf16 v[96:99], a[92:95], a[56:59], v[96:99]
  s_waitcnt vmcnt(12) lgkmcnt(8)
  ds_read_b64_tr_b16 a[90:91], v173 offset:38912
  v_lshrrev_b32 v29, 16, v29
  v_mfma_f32_16x16x32_bf16 v[64:67], a[64:67], a[0:3], v[64:67]
  ds_read_b64_tr_b16 a[92:93], v174 offset:36864
  v_mul_u32_u24 v30, 14, v29
  v_mfma_f32_16x16x32_bf16 v[68:71], a[64:67], a[4:7], v[68:71]
  ds_read_b64_tr_b16 a[94:95], v174 offset:38912
  v_sub_u32 v30, v28, v30
  v_mfma_f32_16x16x32_bf16 v[76:79], a[68:71], a[4:7], v[76:79]
  ds_read_b64_tr_b16 a[64:65], v175 offset:36864
  v_lshl_add_u32 v31, v30, 1, s37
  v_mfma_f32_16x16x32_bf16 v[72:75], a[68:71], a[0:3], v[72:75]
  s_waitcnt lgkmcnt(8)
  ds_read_b64_tr_b16 a[66:67], v175 offset:38912
  buffer_load_dwordx4 a[56:59], v9, s[8:11], s25 offen offset:0 sc1
  v_mfma_f32_16x16x32_bf16 v[80:83], a[72:75], a[0:3], v[80:83]
  ds_read_b128 a[68:71], v184 offset:1152
  v_cmp_gt_u32 vcc, 12, v30
  v_mfma_f32_16x16x32_bf16 v[84:87], a[72:75], a[4:7], v[84:87]
  v_add_u32 v30, s36, v30
  v_mul_lo_u32 v29, s34, v29
  s_sub_u32 s31, s35, 0
  v_mfma_f32_16x16x32_bf16 v[92:95], a[76:79], a[4:7], v[92:95]
  ds_read_b64_tr_b16 a[72:73], v172 offset:40960
  v_cndmask_b32 v30, v31, v30, vcc
  v_mfma_f32_16x16x32_bf16 v[88:91], a[76:79], a[0:3], v[88:91]
  s_waitcnt lgkmcnt(8)
  ds_read_b64_tr_b16 a[74:75], v172 offset:43008
  v_lshl_add_u32 v29, v30, 4, v29
  v_mfma_f32_16x16x32_bf16 v[96:99], a[80:83], a[0:3], v[96:99]
  ds_read_b64_tr_b16 a[76:77], v173 offset:40960
  buffer_load_dwordx4 a[60:63], v9, s[8:11], s25 offen offset:1024 sc1
  s_add_u32 s25, s25, 131072
  v_mfma_f32_16x16x32_bf16 v[100:103], a[80:83], a[4:7], v[100:103]
  s_waitcnt vmcnt(12)
  ds_read_b64_tr_b16 a[78:79], v173 offset:43008
  v_add_u32 v6, s31, v29
  v_mfma_f32_16x16x32_bf16 v[68:71], a[84:87], a[12:15], v[68:71]
  ds_read_b64_tr_b16 a[80:81], v174 offset:40960
  v_add_u32 v28, 320, v27
  v_mfma_f32_16x16x32_bf16 v[64:67], a[84:87], a[8:11], v[64:67]
  s_waitcnt lgkmcnt(8)
  ds_read_b64_tr_b16 a[82:83], v174 offset:43008
  v_mul_u32_u24 v29, 4682, v28
  v_mfma_f32_16x16x32_bf16 v[72:75], a[88:91], a[8:11], v[72:75]
  ds_read_b64_tr_b16 a[84:85], v175 offset:40960
  v_lshrrev_b32 v29, 16, v29
  v_mfma_f32_16x16x32_bf16 v[76:79], a[88:91], a[12:15], v[76:79]
  ds_read_b64_tr_b16 a[86:87], v175 offset:43008
  buffer_load_dwordx4 a[0:3], v9, s[8:11], s25 offen offset:0 sc1
  v_mfma_f32_16x16x32_bf16 v[84:87], a[92:95], a[12:15], v[84:87]
  ds_read_b128 a[88:91], v184 offset:1280
  v_mul_u32_u24 v30, 14, v29
  v_mfma_f32_16x16x32_bf16 v[80:83], a[92:95], a[8:11], v[80:83]
  s_waitcnt lgkmcnt(9)
  v_sub_u32 v30, v28, v30
  v_lshl_add_u32 v31, v30, 1, s37
  v_mfma_f32_16x16x32_bf16 v[88:91], a[64:67], a[8:11], v[88:91]
  ds_read_b64_tr_b16 a[92:93], v172 offset:45056
  v_cmp_gt_u32 vcc, 12, v30
  v_mfma_f32_16x16x32_bf16 v[92:95], a[64:67], a[12:15], v[92:95]
  ds_read_b64_tr_b16 a[94:95], v172 offset:47104
  v_add_u32 v30, s36, v30
  v_mfma_f32_16x16x32_bf16 v[100:103], a[68:71], a[12:15], v[100:103]
  ds_read_b64_tr_b16 a[64:65], v173 offset:45056
  buffer_load_dwordx4 a[4:7], v9, s[8:11], s25 offen offset:1024 sc1
  s_add_u32 s25, s25, 131072
  v_mfma_f32_16x16x32_bf16 v[96:99], a[68:71], a[8:11], v[96:99]
  s_waitcnt vmcnt(12) lgkmcnt(8)
  ds_read_b64_tr_b16 a[66:67], v173 offset:47104
  v_mul_lo_u32 v29, s34, v29
  s_sub_u32 s31, s35, 1024
  v_mfma_f32_16x16x32_bf16 v[64:67], a[72:75], a[16:19], v[64:67]
  ds_read_b64_tr_b16 a[68:69], v174 offset:45056
  v_cndmask_b32 v30, v31, v30, vcc
  v_mfma_f32_16x16x32_bf16 v[68:71], a[72:75], a[20:23], v[68:71]
  ds_read_b64_tr_b16 a[70:71], v174 offset:47104
  v_lshl_add_u32 v29, v30, 4, v29
  v_mfma_f32_16x16x32_bf16 v[76:79], a[76:79], a[20:23], v[76:79]
  ds_read_b64_tr_b16 a[72:73], v175 offset:45056
  v_add_u32 v7, s31, v29
  v_mfma_f32_16x16x32_bf16 v[72:75], a[76:79], a[16:19], v[72:75]
  s_waitcnt lgkmcnt(8)
  ds_read_b64_tr_b16 a[74:75], v175 offset:47104
  buffer_load_dwordx4 a[8:11], v9, s[8:11], s25 offen offset:0 sc1
  v_mfma_f32_16x16x32_bf16 v[80:83], a[80:83], a[16:19], v[80:83]
  ds_read_b128 a[76:79], v184 offset:1408
  v_add_u32 v28, 384, v27
  v_mfma_f32_16x16x32_bf16 v[84:87], a[80:83], a[20:23], v[84:87]
  v_mul_u32_u24 v29, 4682, v28
  v_lshrrev_b32 v29, 16, v29
  v_mfma_f32_16x16x32_bf16 v[92:95], a[84:87], a[20:23], v[92:95]
  ds_read_b64_tr_b16 a[80:81], v172 offset:49152
  v_mul_u32_u24 v30, 14, v29
  v_mfma_f32_16x16x32_bf16 v[88:91], a[84:87], a[16:19], v[88:91]
  s_waitcnt lgkmcnt(8)
  ds_read_b64_tr_b16 a[82:83], v172 offset:51200
  v_sub_u32 v30, v28, v30
  v_mfma_f32_16x16x32_bf16 v[96:99], a[88:91], a[16:19], v[96:99]
  ds_read_b64_tr_b16 a[84:85], v173 offset:49152
  buffer_load_dwordx4 a[12:15], v9, s[8:11], s25 offen offset:1024 sc1
  s_add_u32 s25, s25, 131072
  v_mfma_f32_16x16x32_bf16 v[100:103], a[88:91], a[20:23], v[100:103]
  s_waitcnt vmcnt(12)
  ds_read_b64_tr_b16 a[86:87], v173 offset:51200
  v_lshl_add_u32 v31, v30, 1, s37
  v_mfma_f32_16x16x32_bf16 v[68:71], a[92:95], a[28:31], v[68:71]
  ds_read_b64_tr_b16 a[88:89], v174 offset:49152
  v_cmp_gt_u32 vcc, 12, v30
  v_mfma_f32_16x16x32_bf16 v[64:67], a[92:95], a[24:27], v[64:67]
  s_waitcnt lgkmcnt(8)
  ds_read_b64_tr_b16 a[90:91], v174 offset:51200
  v_add_u32 v30, s36, v30
  v_mfma_f32_16x16x32_bf16 v[72:75], a[64:67], a[24:27], v[72:75]
  ds_read_b64_tr_b16 a[92:93], v175 offset:49152
  v_mul_lo_u32 v29, s34, v29
  s_sub_u32 s31, s35, 2048
  v_mfma_f32_16x16x32_bf16 v[76:79], a[64:67], a[28:31], v[76:79]
  ds_read_b64_tr_b16 a[94:95], v175 offset:51200
  buffer_load_dwordx4 a[16:19], v9, s[8:11], s25 offen offset:0 sc1
  v_mfma_f32_16x16x32_bf16 v[84:87], a[68:71], a[28:31], v[84:87]
  ds_read_b128 a[64:67], v184 offset:1536
  v_cndmask_b32 v30, v31, v30, vcc
  v_mfma_f32_16x16x32_bf16 v[80:83], a[68:71], a[24:27], v[80:83]
  s_waitcnt lgkmcnt(9)
  v_lshl_add_u32 v29, v30, 4, v29
  v_add_u32 v8, s31, v29
  v_mfma_f32_16x16x32_bf16 v[88:91], a[72:75], a[24:27], v[88:91]
  ds_read_b64_tr_b16 a[68:69], v172 offset:53248
  v_lshlrev_b32 v9, 4, v1
  s_cmp_lt_u32 s20, 2
  s_cselect_b32 s4, s72, s74
  s_cselect_b32 s5, s73, s75
  v_mfma_f32_16x16x32_bf16 v[92:95], a[72:75], a[28:31], v[92:95]
  ds_read_b64_tr_b16 a[70:71], v172 offset:55296
  s_mov_b32 s6, 7340032
  v_mfma_f32_16x16x32_bf16 v[100:103], a[76:79], a[28:31], v[100:103]
  ds_read_b64_tr_b16 a[72:73], v173 offset:53248
  buffer_load_dwordx4 a[20:23], v9, s[8:11], s25 offen offset:1024 sc1
  s_add_u32 s25, s25, 131072
  v_mfma_f32_16x16x32_bf16 v[96:99], a[76:79], a[24:27], v[96:99]
  s_waitcnt vmcnt(12) lgkmcnt(8)
  ds_read_b64_tr_b16 a[74:75], v173 offset:55296
  s_mov_b32 s7, 0x20000
  v_mfma_f32_16x16x32_bf16 v[64:67], a[80:83], a[32:35], v[64:67]
  ds_read_b64_tr_b16 a[76:77], v174 offset:53248
  s_mov_b32 s24, 0
  v_mfma_f32_16x16x32_bf16 v[68:71], a[80:83], a[36:39], v[68:71]
  ds_read_b64_tr_b16 a[78:79], v174 offset:55296
  s_mul_i32 s26, s20, 7168
  v_mfma_f32_16x16x32_bf16 v[76:79], a[84:87], a[36:39], v[76:79]
  ds_read_b64_tr_b16 a[80:81], v175 offset:53248
  s_add_u32 s29, s26, 143360
  v_mfma_f32_16x16x32_bf16 v[72:75], a[84:87], a[32:35], v[72:75]
  s_waitcnt lgkmcnt(8)
  ds_read_b64_tr_b16 a[82:83], v175 offset:55296
  buffer_load_dwordx4 a[24:27], v9, s[8:11], s25 offen offset:0 sc1
  s_mov_b32 s23, s26
  v_mfma_f32_16x16x32_bf16 v[80:83], a[88:91], a[32:35], v[80:83]
  ds_read_b128 a[84:87], v184 offset:1664
  v_mfma_f32_16x16x32_bf16 v[84:87], a[88:91], a[36:39], v[84:87]
  v_mfma_f32_16x16x32_bf16 v[92:95], a[92:95], a[36:39], v[92:95]
  ds_read_b64_tr_b16 a[88:89], v172 offset:57344
  v_mfma_f32_16x16x32_bf16 v[88:91], a[92:95], a[32:35], v[88:91]
  s_waitcnt lgkmcnt(8)
  ds_read_b64_tr_b16 a[90:91], v172 offset:59392
  v_mfma_f32_16x16x32_bf16 v[96:99], a[64:67], a[32:35], v[96:99]
  ds_read_b64_tr_b16 a[92:93], v173 offset:57344
  buffer_load_dwordx4 a[28:31], v9, s[8:11], s25 offen offset:1024 sc1
  s_add_u32 s25, s25, 131072
  v_mfma_f32_16x16x32_bf16 v[100:103], a[64:67], a[36:39], v[100:103]
  s_waitcnt vmcnt(12)
  ds_read_b64_tr_b16 a[94:95], v173 offset:59392
  v_mfma_f32_16x16x32_bf16 v[68:71], a[68:71], a[44:47], v[68:71]
  ds_read_b64_tr_b16 a[64:65], v174 offset:57344
  v_mfma_f32_16x16x32_bf16 v[64:67], a[68:71], a[40:43], v[64:67]
  s_waitcnt lgkmcnt(8)
  ds_read_b64_tr_b16 a[66:67], v174 offset:59392
  v_mfma_f32_16x16x32_bf16 v[72:75], a[72:75], a[40:43], v[72:75]
  ds_read_b64_tr_b16 a[68:69], v175 offset:57344
  v_mfma_f32_16x16x32_bf16 v[76:79], a[72:75], a[44:47], v[76:79]
  ds_read_b64_tr_b16 a[70:71], v175 offset:59392
  buffer_load_dwordx4 a[32:35], v9, s[8:11], s25 offen offset:0 sc1
  v_mfma_f32_16x16x32_bf16 v[84:87], a[76:79], a[44:47], v[84:87]
  ds_read_b128 a[72:75], v184 offset:1792
  v_mfma_f32_16x16x32_bf16 v[80:83], a[76:79], a[40:43], v[80:83]
  s_waitcnt lgkmcnt(9)
  v_mfma_f32_16x16x32_bf16 v[88:91], a[80:83], a[40:43], v[88:91]
  ds_read_b64_tr_b16 a[76:77], v172 offset:61440
  v_mfma_f32_16x16x32_bf16 v[92:95], a[80:83], a[44:47], v[92:95]
  ds_read_b64_tr_b16 a[78:79], v172 offset:63488
  v_mfma_f32_16x16x32_bf16 v[100:103], a[84:87], a[44:47], v[100:103]
  ds_read_b64_tr_b16 a[80:81], v173 offset:61440
  buffer_load_dwordx4 a[36:39], v9, s[8:11], s25 offen offset:1024 sc1
  s_add_u32 s25, s25, 131072
  v_mfma_f32_16x16x32_bf16 v[96:99], a[84:87], a[40:43], v[96:99]
  s_waitcnt vmcnt(12) lgkmcnt(8)
  ds_read_b64_tr_b16 a[82:83], v173 offset:63488
  v_mfma_f32_16x16x32_bf16 v[64:67], a[88:91], a[48:51], v[64:67]
  ds_read_b64_tr_b16 a[84:85], v174 offset:61440
  v_mfma_f32_16x16x32_bf16 v[68:71], a[88:91], a[52:55], v[68:71]
  ds_read_b64_tr_b16 a[86:87], v174 offset:63488
  v_mfma_f32_16x16x32_bf16 v[76:79], a[92:95], a[52:55], v[76:79]
  ds_read_b64_tr_b16 a[88:89], v175 offset:61440
  buffer_load_dwordx4 a[40:43], v9, s[8:11], s25 offen offset:0 sc1
  v_mfma_f32_16x16x32_bf16 v[72:75], a[92:95], a[48:51], v[72:75]
  s_waitcnt lgkmcnt(8)
  ds_read_b64_tr_b16 a[90:91], v175 offset:63488
  v_mfma_f32_16x16x32_bf16 v[80:83], a[64:67], a[48:51], v[80:83]
  ds_read_b128 a[92:95], v184 offset:1920
  v_mfma_f32_16x16x32_bf16 v[84:87], a[64:67], a[52:55], v[84:87]
  buffer_load_dwordx4 v[232:235], v188, s[16:19], s46 offen offset:0
  v_mfma_f32_16x16x32_bf16 v[92:95], a[68:71], a[52:55], v[92:95]
  ds_read_b64_tr_b16 a[64:65], v176 offset:0
  v_mfma_f32_16x16x32_bf16 v[88:91], a[68:71], a[48:51], v[88:91]
  s_waitcnt lgkmcnt(8)
  ds_read_b64_tr_b16 a[66:67], v176 offset:2048
  v_mfma_f32_16x16x32_bf16 v[96:99], a[72:75], a[48:51], v[96:99]
  ds_read_b64_tr_b16 a[68:69], v177 offset:0
  buffer_load_dwordx4 a[44:47], v9, s[8:11], s25 offen offset:1024 sc1
  s_add_u32 s25, s25, 131072
  v_mfma_f32_16x16x32_bf16 v[100:103], a[72:75], a[52:55], v[100:103]
  s_waitcnt vmcnt(13)
  ds_read_b64_tr_b16 a[70:71], v177 offset:2048
  v_mfma_f32_16x16x32_bf16 v[68:71], a[76:79], a[60:63], v[68:71]
  ds_read_b64_tr_b16 a[72:73], v178 offset:0
  v_mfma_f32_16x16x32_bf16 v[64:67], a[76:79], a[56:59], v[64:67]
  s_waitcnt lgkmcnt(8)
  ds_read_b64_tr_b16 a[74:75], v178 offset:2048
  v_mfma_f32_16x16x32_bf16 v[72:75], a[80:83], a[56:59], v[72:75]
  ds_read_b64_tr_b16 a[76:77], v179 offset:0
  buffer_load_dwordx4 a[48:51], v9, s[8:11], s25 offen offset:0 sc1
  v_mfma_f32_16x16x32_bf16 v[76:79], a[80:83], a[60:63], v[76:79]
  ds_read_b64_tr_b16 a[78:79], v179 offset:2048
  v_mfma_f32_16x16x32_bf16 v[84:87], a[84:87], a[60:63], v[84:87]
  ds_read_b128 a[80:83], v184 offset:2048
  v_mfma_f32_16x16x32_bf16 v[80:83], a[84:87], a[56:59], v[80:83]
  s_waitcnt lgkmcnt(9)
  buffer_load_dwordx4 v[236:239], v188, s[16:19], s46 offen offset:64
  v_mfma_f32_16x16x32_bf16 v[88:91], a[88:91], a[56:59], v[88:91]
  ds_read_b64_tr_b16 a[84:85], v176 offset:4096
  v_mfma_f32_16x16x32_bf16 v[92:95], a[88:91], a[60:63], v[92:95]
  ds_read_b64_tr_b16 a[86:87], v176 offset:6144
  v_mfma_f32_16x16x32_bf16 v[100:103], a[92:95], a[60:63], v[100:103]
  ds_read_b64_tr_b16 a[88:89], v177 offset:4096
  buffer_load_dwordx4 a[52:55], v9, s[8:11], s25 offen offset:1024 sc1
  s_add_u32 s25, s25, 131072
  v_mfma_f32_16x16x32_bf16 v[96:99], a[92:95], a[56:59], v[96:99]
  s_waitcnt vmcnt(14) lgkmcnt(8)
  ds_read_b64_tr_b16 a[90:91], v177 offset:6144
  v_mfma_f32_16x16x32_bf16 v[64:67], a[64:67], a[0:3], v[64:67]
  ds_read_b64_tr_b16 a[92:93], v178 offset:4096
  v_mfma_f32_16x16x32_bf16 v[68:71], a[64:67], a[4:7], v[68:71]
  ds_read_b64_tr_b16 a[94:95], v178 offset:6144
  v_mfma_f32_16x16x32_bf16 v[76:79], a[68:71], a[4:7], v[76:79]
  ds_read_b64_tr_b16 a[64:65], v179 offset:4096
  buffer_load_dwordx4 a[56:59], v9, s[8:11], s25 offen offset:0 sc1
  v_mfma_f32_16x16x32_bf16 v[72:75], a[68:71], a[0:3], v[72:75]
  s_waitcnt lgkmcnt(8)
  ds_read_b64_tr_b16 a[66:67], v179 offset:6144
  v_mfma_f32_16x16x32_bf16 v[80:83], a[72:75], a[0:3], v[80:83]
  ds_read_b128 a[68:71], v184 offset:2176
  v_mfma_f32_16x16x32_bf16 v[84:87], a[72:75], a[4:7], v[84:87]
  buffer_load_dwordx4 v[240:243], v188, s[16:19], s47 offen offset:0
  v_mfma_f32_16x16x32_bf16 v[92:95], a[76:79], a[4:7], v[92:95]
  ds_read_b64_tr_b16 a[72:73], v176 offset:8192
  v_mfma_f32_16x16x32_bf16 v[88:91], a[76:79], a[0:3], v[88:91]
  s_waitcnt lgkmcnt(8)
  ds_read_b64_tr_b16 a[74:75], v176 offset:10240
  v_mfma_f32_16x16x32_bf16 v[96:99], a[80:83], a[0:3], v[96:99]
  ds_read_b64_tr_b16 a[76:77], v177 offset:8192
  buffer_load_dwordx4 a[60:63], v9, s[8:11], s25 offen offset:1024 sc1
  s_add_u32 s25, s25, 131072
  v_mfma_f32_16x16x32_bf16 v[100:103], a[80:83], a[4:7], v[100:103]
  s_waitcnt vmcnt(15)
  ds_read_b64_tr_b16 a[78:79], v177 offset:10240
  v_mfma_f32_16x16x32_bf16 v[68:71], a[84:87], a[12:15], v[68:71]
  ds_read_b64_tr_b16 a[80:81], v178 offset:8192
  v_mfma_f32_16x16x32_bf16 v[64:67], a[84:87], a[8:11], v[64:67]
  s_waitcnt lgkmcnt(8)
  ds_read_b64_tr_b16 a[82:83], v178 offset:10240
  v_mfma_f32_16x16x32_bf16 v[72:75], a[88:91], a[8:11], v[72:75]
  ds_read_b64_tr_b16 a[84:85], v179 offset:8192
  buffer_load_dwordx4 a[0:3], v9, s[8:11], s25 offen offset:0 sc1
  v_mfma_f32_16x16x32_bf16 v[76:79], a[88:91], a[12:15], v[76:79]
  ds_read_b64_tr_b16 a[86:87], v179 offset:10240
  v_mfma_f32_16x16x32_bf16 v[84:87], a[92:95], a[12:15], v[84:87]
  ds_read_b128 a[88:91], v184 offset:2304
  v_mfma_f32_16x16x32_bf16 v[80:83], a[92:95], a[8:11], v[80:83]
  s_waitcnt lgkmcnt(9)
  buffer_load_dwordx4 v[244:247], v188, s[16:19], s47 offen offset:64
  v_mfma_f32_16x16x32_bf16 v[88:91], a[64:67], a[8:11], v[88:91]
  ds_read_b64_tr_b16 a[92:93], v176 offset:12288
  v_mfma_f32_16x16x32_bf16 v[92:95], a[64:67], a[12:15], v[92:95]
  ds_read_b64_tr_b16 a[94:95], v176 offset:14336
  v_mfma_f32_16x16x32_bf16 v[100:103], a[68:71], a[12:15], v[100:103]
  ds_read_b64_tr_b16 a[64:65], v177 offset:12288
  buffer_load_dwordx4 a[4:7], v9, s[8:11], s25 offen offset:1024 sc1
  s_add_u32 s25, s25, 131072
  v_mfma_f32_16x16x32_bf16 v[96:99], a[68:71], a[8:11], v[96:99]
  s_waitcnt vmcnt(16) lgkmcnt(8)
  ds_read_b64_tr_b16 a[66:67], v177 offset:14336
  v_mfma_f32_16x16x32_bf16 v[64:67], a[72:75], a[16:19], v[64:67]
  ds_read_b64_tr_b16 a[68:69], v178 offset:12288
  v_mfma_f32_16x16x32_bf16 v[68:71], a[72:75], a[20:23], v[68:71]
  ds_read_b64_tr_b16 a[70:71], v178 offset:14336
  v_mfma_f32_16x16x32_bf16 v[76:79], a[76:79], a[20:23], v[76:79]
  ds_read_b64_tr_b16 a[72:73], v179 offset:12288
  buffer_load_dwordx4 a[8:11], v9, s[8:11], s25 offen offset:0 sc1
  v_mfma_f32_16x16x32_bf16 v[72:75], a[76:79], a[16:19], v[72:75]
  s_waitcnt lgkmcnt(8)
  ds_read_b64_tr_b16 a[74:75], v179 offset:14336
  v_mfma_f32_16x16x32_bf16 v[80:83], a[80:83], a[16:19], v[80:83]
  ds_read_b128 a[76:79], v184 offset:2432
  v_mfma_f32_16x16x32_bf16 v[84:87], a[80:83], a[20:23], v[84:87]
  s_waitcnt vmcnt(55)
  s_barrier
  v_mfma_f32_16x16x32_bf16 v[92:95], a[84:87], a[20:23], v[92:95]
  ds_read_b64_tr_b16 a[80:81], v176 offset:32768
  buffer_load_dword v248, v187, s[12:15], s43 offen offset:0 sc1
  v_mfma_f32_16x16x32_bf16 v[88:91], a[84:87], a[16:19], v[88:91]
  s_waitcnt lgkmcnt(8)
  ds_read_b64_tr_b16 a[82:83], v176 offset:34816
  v_mfma_f32_16x16x32_bf16 v[96:99], a[88:91], a[16:19], v[96:99]
  ds_read_b64_tr_b16 a[84:85], v177 offset:32768
  buffer_load_dwordx4 a[12:15], v9, s[8:11], s25 offen offset:1024 sc1
  s_add_u32 s25, s25, 131072
  v_mfma_f32_16x16x32_bf16 v[100:103], a[88:91], a[20:23], v[100:103]
  s_waitcnt vmcnt(17)
  ds_read_b64_tr_b16 a[86:87], v177 offset:34816
  v_mfma_f32_16x16x32_bf16 v[68:71], a[92:95], a[28:31], v[68:71]
  ds_read_b64_tr_b16 a[88:89], v178 offset:32768
  v_mfma_f32_16x16x32_bf16 v[64:67], a[92:95], a[24:27], v[64:67]
  s_waitcnt lgkmcnt(8)
  ds_read_b64_tr_b16 a[90:91], v178 offset:34816
  v_mfma_f32_16x16x32_bf16 v[72:75], a[64:67], a[24:27], v[72:75]
  ds_read_b64_tr_b16 a[92:93], v179 offset:32768
  buffer_load_dwordx4 a[16:19], v9, s[8:11], s25 offen offset:0 sc1
  v_mfma_f32_16x16x32_bf16 v[76:79], a[64:67], a[28:31], v[76:79]
  ds_read_b64_tr_b16 a[94:95], v179 offset:34816
  v_mfma_f32_16x16x32_bf16 v[84:87], a[68:71], a[28:31], v[84:87]
  ds_read_b128 a[64:67], v184 offset:2560
  v_mfma_f32_16x16x32_bf16 v[80:83], a[68:71], a[24:27], v[80:83]
  s_waitcnt lgkmcnt(9)
  buffer_load_dword v249, v187, s[12:15], s43 offen offset:64 sc1
  v_mfma_f32_16x16x32_bf16 v[88:91], a[72:75], a[24:27], v[88:91]
  ds_read_b64_tr_b16 a[68:69], v176 offset:36864
  v_mfma_f32_16x16x32_bf16 v[92:95], a[72:75], a[28:31], v[92:95]
  ds_read_b64_tr_b16 a[70:71], v176 offset:38912
  v_mfma_f32_16x16x32_bf16 v[100:103], a[76:79], a[28:31], v[100:103]
  ds_read_b64_tr_b16 a[72:73], v177 offset:36864
  buffer_load_dwordx4 a[20:23], v9, s[8:11], s25 offen offset:1024 sc1
  s_add_u32 s25, s25, 131072
  v_mfma_f32_16x16x32_bf16 v[96:99], a[76:79], a[24:27], v[96:99]
  s_waitcnt vmcnt(18) lgkmcnt(8)
  ds_read_b64_tr_b16 a[74:75], v177 offset:38912
  v_mfma_f32_16x16x32_bf16 v[64:67], a[80:83], a[32:35], v[64:67]
  ds_read_b64_tr_b16 a[76:77], v178 offset:36864
  v_mfma_f32_16x16x32_bf16 v[68:71], a[80:83], a[36:39], v[68:71]
  ds_read_b64_tr_b16 a[78:79], v178 offset:38912
  v_mfma_f32_16x16x32_bf16 v[76:79], a[84:87], a[36:39], v[76:79]
  ds_read_b64_tr_b16 a[80:81], v179 offset:36864
  v_mfma_f32_16x16x32_bf16 v[72:75], a[84:87], a[32:35], v[72:75]
  s_waitcnt lgkmcnt(8)
  ds_read_b64_tr_b16 a[82:83], v179 offset:38912
  buffer_load_dwordx4 a[24:27], v9, s[8:11], s25 offen offset:0 sc1
  v_mfma_f32_16x16x32_bf16 v[80:83], a[88:91], a[32:35], v[80:83]
  ds_read_b128 a[84:87], v184 offset:2688
  v_mfma_f32_16x16x32_bf16 v[84:87], a[88:91], a[36:39], v[84:87]
  v_mfma_f32_16x16x32_bf16 v[92:95], a[92:95], a[36:39], v[92:95]
  ds_read_b64_tr_b16 a[88:89], v176 offset:40960
  v_mfma_f32_16x16x32_bf16 v[88:91], a[92:95], a[32:35], v[88:91]
  s_waitcnt lgkmcnt(8)
  ds_read_b64_tr_b16 a[90:91], v176 offset:43008
  v_mfma_f32_16x16x32_bf16 v[96:99], a[64:67], a[32:35], v[96:99]
  ds_read_b64_tr_b16 a[92:93], v177 offset:40960
  buffer_load_dwordx4 a[28:31], v9, s[8:11], s25 offen offset:1024 sc1
  s_add_u32 s25, s25, 131072
  v_mfma_f32_16x16x32_bf16 v[100:103], a[64:67], a[36:39], v[100:103]
  s_waitcnt vmcnt(17)
  ds_read_b64_tr_b16 a[94:95], v177 offset:43008
  v_mfma_f32_16x16x32_bf16 v[68:71], a[68:71], a[44:47], v[68:71]
  ds_read_b64_tr_b16 a[64:65], v178 offset:40960
  v_mfma_f32_16x16x32_bf16 v[64:67], a[68:71], a[40:43], v[64:67]
  s_waitcnt lgkmcnt(8)
  ds_read_b64_tr_b16 a[66:67], v178 offset:43008
  v_mfma_f32_16x16x32_bf16 v[72:75], a[72:75], a[40:43], v[72:75]
  ds_read_b64_tr_b16 a[68:69], v179 offset:40960
  v_mfma_f32_16x16x32_bf16 v[76:79], a[72:75], a[44:47], v[76:79]
  ds_read_b64_tr_b16 a[70:71], v179 offset:43008
  buffer_load_dwordx4 a[32:35], v9, s[8:11], s25 offen offset:0 sc1
  v_mfma_f32_16x16x32_bf16 v[84:87], a[76:79], a[44:47], v[84:87]
  ds_read_b128 a[72:75], v184 offset:2816
  v_mfma_f32_16x16x32_bf16 v[80:83], a[76:79], a[40:43], v[80:83]
  s_waitcnt lgkmcnt(9)
  v_mfma_f32_16x16x32_bf16 v[88:91], a[80:83], a[40:43], v[88:91]
  ds_read_b64_tr_b16 a[76:77], v176 offset:45056
  v_mfma_f32_16x16x32_bf16 v[92:95], a[80:83], a[44:47], v[92:95]
  ds_read_b64_tr_b16 a[78:79], v176 offset:47104
  v_mfma_f32_16x16x32_bf16 v[100:103], a[84:87], a[44:47], v[100:103]
  ds_read_b64_tr_b16 a[80:81], v177 offset:45056
  buffer_load_dwordx4 a[36:39], v9, s[8:11], s25 offen offset:1024 sc1
  s_add_u32 s25, s25, 131072
  v_mfma_f32_16x16x32_bf16 v[96:99], a[84:87], a[40:43], v[96:99]
  s_waitcnt vmcnt(16) lgkmcnt(8)
  ds_read_b64_tr_b16 a[82:83], v177 offset:47104
  v_mfma_f32_16x16x32_bf16 v[64:67], a[88:91], a[48:51], v[64:67]
  ds_read_b64_tr_b16 a[84:85], v178 offset:45056
  v_mfma_f32_16x16x32_bf16 v[68:71], a[88:91], a[52:55], v[68:71]
  ds_read_b64_tr_b16 a[86:87], v178 offset:47104
  s_barrier
  v_mfma_f32_16x16x32_bf16 v[76:79], a[92:95], a[52:55], v[76:79]
  ds_read_b64_tr_b16 a[88:89], v179 offset:45056
  v_mfma_f32_16x16x32_bf16 v[72:75], a[92:95], a[48:51], v[72:75]
  s_waitcnt lgkmcnt(8)
  ds_read_b64_tr_b16 a[90:91], v179 offset:47104
  buffer_load_dwordx4 a[40:43], v9, s[8:11], s25 offen offset:0 sc1
  v_mfma_f32_16x16x32_bf16 v[80:83], a[64:67], a[48:51], v[80:83]
  ds_read_b128 a[92:95], v184 offset:2944
  v_mfma_f32_16x16x32_bf16 v[84:87], a[64:67], a[52:55], v[84:87]
  v_mfma_f32_16x16x32_bf16 v[92:95], a[68:71], a[52:55], v[92:95]
  ds_read_b64_tr_b16 a[64:65], v176 offset:49152
  v_mfma_f32_16x16x32_bf16 v[88:91], a[68:71], a[48:51], v[88:91]
  s_waitcnt lgkmcnt(8)
  ds_read_b64_tr_b16 a[66:67], v176 offset:51200
  v_mfma_f32_16x16x32_bf16 v[96:99], a[72:75], a[48:51], v[96:99]
  ds_read_b64_tr_b16 a[68:69], v177 offset:49152
  buffer_load_dwordx4 a[44:47], v9, s[8:11], s25 offen offset:1024 sc1
  s_add_u32 s25, s25, 131072
  v_mfma_f32_16x16x32_bf16 v[100:103], a[72:75], a[52:55], v[100:103]
  s_waitcnt vmcnt(15)
  ds_read_b64_tr_b16 a[70:71], v177 offset:51200
  v_mfma_f32_16x16x32_bf16 v[68:71], a[76:79], a[60:63], v[68:71]
  ds_read_b64_tr_b16 a[72:73], v178 offset:49152
  v_mfma_f32_16x16x32_bf16 v[64:67], a[76:79], a[56:59], v[64:67]
  s_waitcnt lgkmcnt(8)
  ds_read_b64_tr_b16 a[74:75], v178 offset:51200
  v_mfma_f32_16x16x32_bf16 v[72:75], a[80:83], a[56:59], v[72:75]
  ds_read_b64_tr_b16 a[76:77], v179 offset:49152
  v_mfma_f32_16x16x32_bf16 v[76:79], a[80:83], a[60:63], v[76:79]
  ds_read_b64_tr_b16 a[78:79], v179 offset:51200
  buffer_load_dwordx4 a[48:51], v9, s[8:11], s25 offen offset:0 sc1
  v_mfma_f32_16x16x32_bf16 v[84:87], a[84:87], a[60:63], v[84:87]
  ds_read_b128 a[80:83], v184 offset:3072
  v_mfma_f32_16x16x32_bf16 v[80:83], a[84:87], a[56:59], v[80:83]
  s_waitcnt lgkmcnt(9)
  v_mfma_f32_16x16x32_bf16 v[88:91], a[88:91], a[56:59], v[88:91]
  ds_read_b64_tr_b16 a[84:85], v176 offset:53248
  v_mfma_f32_16x16x32_bf16 v[92:95], a[88:91], a[60:63], v[92:95]
  ds_read_b64_tr_b16 a[86:87], v176 offset:55296
  v_mfma_f32_16x16x32_bf16 v[100:103], a[92:95], a[60:63], v[100:103]
  ds_read_b64_tr_b16 a[88:89], v177 offset:53248
  buffer_load_dwordx4 a[52:55], v9, s[8:11], s25 offen offset:1024 sc1
  s_add_u32 s25, s25, 131072
  v_mfma_f32_16x16x32_bf16 v[96:99], a[92:95], a[56:59], v[96:99]
  s_waitcnt vmcnt(14) lgkmcnt(8)
  ds_read_b64_tr_b16 a[90:91], v177 offset:55296
  v_mfma_f32_16x16x32_bf16 v[64:67], a[64:67], a[0:3], v[64:67]
  ds_read_b64_tr_b16 a[92:93], v178 offset:53248
  v_mfma_f32_16x16x32_bf16 v[68:71], a[64:67], a[4:7], v[68:71]
  ds_read_b64_tr_b16 a[94:95], v178 offset:55296
  v_mfma_f32_16x16x32_bf16 v[76:79], a[68:71], a[4:7], v[76:79]
  ds_read_b64_tr_b16 a[64:65], v179 offset:53248
  v_mfma_f32_16x16x32_bf16 v[72:75], a[68:71], a[0:3], v[72:75]
  s_waitcnt lgkmcnt(8)
  ds_read_b64_tr_b16 a[66:67], v179 offset:55296
  buffer_load_dwordx4 a[56:59], v9, s[8:11], s25 offen offset:0 sc1
  v_mfma_f32_16x16x32_bf16 v[80:83], a[72:75], a[0:3], v[80:83]
  ds_read_b128 a[68:71], v184 offset:3200
  v_mfma_f32_16x16x32_bf16 v[84:87], a[72:75], a[4:7], v[84:87]
  v_mfma_f32_16x16x32_bf16 v[92:95], a[76:79], a[4:7], v[92:95]
  ds_read_b64_tr_b16 a[72:73], v176 offset:57344
  v_mfma_f32_16x16x32_bf16 v[88:91], a[76:79], a[0:3], v[88:91]
  s_waitcnt lgkmcnt(8)
  ds_read_b64_tr_b16 a[74:75], v176 offset:59392
  v_mfma_f32_16x16x32_bf16 v[96:99], a[80:83], a[0:3], v[96:99]
  ds_read_b64_tr_b16 a[76:77], v177 offset:57344
  buffer_load_dwordx4 a[60:63], v9, s[8:11], s25 offen offset:1024 sc1
  s_add_u32 s25, s25, 131072
  v_mfma_f32_16x16x32_bf16 v[100:103], a[80:83], a[4:7], v[100:103]
  s_waitcnt vmcnt(13)
  ds_read_b64_tr_b16 a[78:79], v177 offset:59392
  v_mfma_f32_16x16x32_bf16 v[68:71], a[84:87], a[12:15], v[68:71]
  ds_read_b64_tr_b16 a[80:81], v178 offset:57344
  v_mfma_f32_16x16x32_bf16 v[64:67], a[84:87], a[8:11], v[64:67]
  s_waitcnt lgkmcnt(8)
  ds_read_b64_tr_b16 a[82:83], v178 offset:59392
  v_mfma_f32_16x16x32_bf16 v[72:75], a[88:91], a[8:11], v[72:75]
  ds_read_b64_tr_b16 a[84:85], v179 offset:57344
  v_mfma_f32_16x16x32_bf16 v[76:79], a[88:91], a[12:15], v[76:79]
  ds_read_b64_tr_b16 a[86:87], v179 offset:59392
  v_mfma_f32_16x16x32_bf16 v[84:87], a[92:95], a[12:15], v[84:87]
  ds_read_b128 a[88:91], v184 offset:3328
  s_mov_b32 m0, s26
  v_mfma_f32_16x16x32_bf16 v[80:83], a[92:95], a[8:11], v[80:83]
  s_waitcnt lgkmcnt(9)
  buffer_load_dwordx4 v2, s[4:7], s24 offen lds
  v_mfma_f32_16x16x32_bf16 v[88:91], a[64:67], a[8:11], v[88:91]
  ds_read_b64_tr_b16 a[92:93], v176 offset:61440
  v_mfma_f32_16x16x32_bf16 v[92:95], a[64:67], a[12:15], v[92:95]
  ds_read_b64_tr_b16 a[94:95], v176 offset:63488
  v_mfma_f32_16x16x32_bf16 v[100:103], a[68:71], a[12:15], v[100:103]
  ds_read_b64_tr_b16 a[64:65], v177 offset:61440
  v_mfma_f32_16x16x32_bf16 v[96:99], a[68:71], a[8:11], v[96:99]
  s_waitcnt vmcnt(11) lgkmcnt(8)
  ds_read_b64_tr_b16 a[66:67], v177 offset:63488
  v_mfma_f32_16x16x32_bf16 v[64:67], a[72:75], a[16:19], v[64:67]
  ds_read_b64_tr_b16 a[68:69], v178 offset:61440
  v_mfma_f32_16x16x32_bf16 v[68:71], a[72:75], a[20:23], v[68:71]
  ds_read_b64_tr_b16 a[70:71], v178 offset:63488
  v_mfma_f32_16x16x32_bf16 v[76:79], a[76:79], a[20:23], v[76:79]
  ds_read_b64_tr_b16 a[72:73], v179 offset:61440
  v_mfma_f32_16x16x32_bf16 v[72:75], a[76:79], a[16:19], v[72:75]
  s_waitcnt lgkmcnt(8)
  ds_read_b64_tr_b16 a[74:75], v179 offset:63488
  v_mfma_f32_16x16x32_bf16 v[80:83], a[80:83], a[16:19], v[80:83]
  ds_read_b128 a[76:79], v184 offset:3456
  v_mfma_f32_16x16x32_bf16 v[84:87], a[80:83], a[20:23], v[84:87]
  buffer_load_dwordx4 v3, s[4:7], s24 offen offset:1024 lds
  v_mfma_f32_16x16x32_bf16 v[92:95], a[84:87], a[20:23], v[92:95]
  ds_read_b64_tr_b16 a[80:81], v180 offset:0
  v_mfma_f32_16x16x32_bf16 v[88:91], a[84:87], a[16:19], v[88:91]
  s_waitcnt lgkmcnt(8)
  ds_read_b64_tr_b16 a[82:83], v180 offset:2048
  v_mfma_f32_16x16x32_bf16 v[96:99], a[88:91], a[16:19], v[96:99]
  ds_read_b64_tr_b16 a[84:85], v181 offset:0
  v_mfma_f32_16x16x32_bf16 v[100:103], a[88:91], a[20:23], v[100:103]
  s_waitcnt vmcnt(10)
  ds_read_b64_tr_b16 a[86:87], v181 offset:2048
  v_mfma_f32_16x16x32_bf16 v[68:71], a[92:95], a[28:31], v[68:71]
  ds_read_b64_tr_b16 a[88:89], v182 offset:0
  v_mfma_f32_16x16x32_bf16 v[64:67], a[92:95], a[24:27], v[64:67]
  s_waitcnt lgkmcnt(8)
  ds_read_b64_tr_b16 a[90:91], v182 offset:2048
  v_mfma_f32_16x16x32_bf16 v[72:75], a[64:67], a[24:27], v[72:75]
  ds_read_b64_tr_b16 a[92:93], v183 offset:0
  v_mfma_f32_16x16x32_bf16 v[76:79], a[64:67], a[28:31], v[76:79]
  ds_read_b64_tr_b16 a[94:95], v183 offset:2048
  v_mfma_f32_16x16x32_bf16 v[84:87], a[68:71], a[28:31], v[84:87]
  ds_read_b128 a[64:67], v184 offset:3584
  v_mfma_f32_16x16x32_bf16 v[80:83], a[68:71], a[24:27], v[80:83]
  s_waitcnt lgkmcnt(9)
  buffer_load_dwordx4 v4, s[4:7], s24 offen offset:2048 lds
  v_mfma_f32_16x16x32_bf16 v[88:91], a[72:75], a[24:27], v[88:91]
  ds_read_b64_tr_b16 a[68:69], v180 offset:4096
  v_mfma_f32_16x16x32_bf16 v[92:95], a[72:75], a[28:31], v[92:95]
  ds_read_b64_tr_b16 a[70:71], v180 offset:6144
  v_mfma_f32_16x16x32_bf16 v[100:103], a[76:79], a[28:31], v[100:103]
  ds_read_b64_tr_b16 a[72:73], v181 offset:4096
  v_mfma_f32_16x16x32_bf16 v[96:99], a[76:79], a[24:27], v[96:99]
  s_waitcnt vmcnt(9) lgkmcnt(8)
  ds_read_b64_tr_b16 a[74:75], v181 offset:6144
  v_mfma_f32_16x16x32_bf16 v[64:67], a[80:83], a[32:35], v[64:67]
  ds_read_b64_tr_b16 a[76:77], v182 offset:4096
  v_mfma_f32_16x16x32_bf16 v[68:71], a[80:83], a[36:39], v[68:71]
  ds_read_b64_tr_b16 a[78:79], v182 offset:6144
  v_mfma_f32_16x16x32_bf16 v[76:79], a[84:87], a[36:39], v[76:79]
  ds_read_b64_tr_b16 a[80:81], v183 offset:4096
  v_mfma_f32_16x16x32_bf16 v[72:75], a[84:87], a[32:35], v[72:75]
  s_waitcnt lgkmcnt(8)
  ds_read_b64_tr_b16 a[82:83], v183 offset:6144
  v_mfma_f32_16x16x32_bf16 v[80:83], a[88:91], a[32:35], v[80:83]
  ds_read_b128 a[84:87], v184 offset:3712
  v_mfma_f32_16x16x32_bf16 v[84:87], a[88:91], a[36:39], v[84:87]
  buffer_load_dwordx4 v5, s[4:7], s24 offen offset:3072 lds
  v_mfma_f32_16x16x32_bf16 v[92:95], a[92:95], a[36:39], v[92:95]
  ds_read_b64_tr_b16 a[88:89], v180 offset:8192
  v_mfma_f32_16x16x32_bf16 v[88:91], a[92:95], a[32:35], v[88:91]
  s_waitcnt lgkmcnt(8)
  ds_read_b64_tr_b16 a[90:91], v180 offset:10240
  v_mfma_f32_16x16x32_bf16 v[96:99], a[64:67], a[32:35], v[96:99]
  ds_read_b64_tr_b16 a[92:93], v181 offset:8192
  v_mfma_f32_16x16x32_bf16 v[100:103], a[64:67], a[36:39], v[100:103]
  s_waitcnt vmcnt(8)
  ds_read_b64_tr_b16 a[94:95], v181 offset:10240
  v_mfma_f32_16x16x32_bf16 v[68:71], a[68:71], a[44:47], v[68:71]
  ds_read_b64_tr_b16 a[64:65], v182 offset:8192
  v_mfma_f32_16x16x32_bf16 v[64:67], a[68:71], a[40:43], v[64:67]
  s_waitcnt lgkmcnt(8)
  ds_read_b64_tr_b16 a[66:67], v182 offset:10240
  v_mfma_f32_16x16x32_bf16 v[72:75], a[72:75], a[40:43], v[72:75]
  ds_read_b64_tr_b16 a[68:69], v183 offset:8192
  v_mfma_f32_16x16x32_bf16 v[76:79], a[72:75], a[44:47], v[76:79]
  ds_read_b64_tr_b16 a[70:71], v183 offset:10240
  v_mfma_f32_16x16x32_bf16 v[84:87], a[76:79], a[44:47], v[84:87]
  ds_read_b128 a[72:75], v184 offset:3840
  s_add_u32 m0, s26, 4096
  v_mfma_f32_16x16x32_bf16 v[80:83], a[76:79], a[40:43], v[80:83]
  s_waitcnt lgkmcnt(9)
  buffer_load_dwordx4 v6, s[4:7], s24 offen lds
  v_mfma_f32_16x16x32_bf16 v[88:91], a[80:83], a[40:43], v[88:91]
  ds_read_b64_tr_b16 a[76:77], v180 offset:12288
  v_mfma_f32_16x16x32_bf16 v[92:95], a[80:83], a[44:47], v[92:95]
  ds_read_b64_tr_b16 a[78:79], v180 offset:14336
  v_mfma_f32_16x16x32_bf16 v[100:103], a[84:87], a[44:47], v[100:103]
  ds_read_b64_tr_b16 a[80:81], v181 offset:12288
  v_mfma_f32_16x16x32_bf16 v[96:99], a[84:87], a[40:43], v[96:99]
  s_waitcnt vmcnt(7) lgkmcnt(8)
  ds_read_b64_tr_b16 a[82:83], v181 offset:14336
  v_mfma_f32_16x16x32_bf16 v[64:67], a[88:91], a[48:51], v[64:67]
  ds_read_b64_tr_b16 a[84:85], v182 offset:12288
  v_mfma_f32_16x16x32_bf16 v[68:71], a[88:91], a[52:55], v[68:71]
  ds_read_b64_tr_b16 a[86:87], v182 offset:14336
  v_mfma_f32_16x16x32_bf16 v[76:79], a[92:95], a[52:55], v[76:79]
  ds_read_b64_tr_b16 a[88:89], v183 offset:12288
  v_mfma_f32_16x16x32_bf16 v[72:75], a[92:95], a[48:51], v[72:75]
  s_waitcnt lgkmcnt(8)
  ds_read_b64_tr_b16 a[90:91], v183 offset:14336
  v_mfma_f32_16x16x32_bf16 v[80:83], a[64:67], a[48:51], v[80:83]
  ds_read_b128 a[92:95], v184 offset:3968
  v_mfma_f32_16x16x32_bf16 v[84:87], a[64:67], a[52:55], v[84:87]
  buffer_load_dwordx4 v7, s[4:7], s24 offen offset:1024 lds
  v_mfma_f32_16x16x32_bf16 v[92:95], a[68:71], a[52:55], v[92:95]
  v_mfma_f32_16x16x32_bf16 v[88:91], a[68:71], a[48:51], v[88:91]
  s_waitcnt lgkmcnt(7)
  v_mfma_f32_16x16x32_bf16 v[96:99], a[72:75], a[48:51], v[96:99]
  v_mfma_f32_16x16x32_bf16 v[100:103], a[72:75], a[52:55], v[100:103]
  s_waitcnt vmcnt(6)
  v_mfma_f32_16x16x32_bf16 v[68:71], a[76:79], a[60:63], v[68:71]
  v_mfma_f32_16x16x32_bf16 v[64:67], a[76:79], a[56:59], v[64:67]
  s_waitcnt lgkmcnt(3)
  v_mfma_f32_16x16x32_bf16 v[72:75], a[80:83], a[56:59], v[72:75]
  v_mfma_f32_16x16x32_bf16 v[76:79], a[80:83], a[60:63], v[76:79]
  v_mfma_f32_16x16x32_bf16 v[84:87], a[84:87], a[60:63], v[84:87]
  v_mfma_f32_16x16x32_bf16 v[80:83], a[84:87], a[56:59], v[80:83]
  s_waitcnt lgkmcnt(0)
  buffer_load_dwordx4 v8, s[4:7], s24 offen offset:2048 lds
  s_add_u32 s24, s24, 458752
  s_add_u32 s26, s26, 28672
  s_cmp_ge_u32 s26, s29
  s_cselect_b32 s26, s23, s26
  v_mfma_f32_16x16x32_bf16 v[88:91], a[88:91], a[56:59], v[88:91]
  v_mfma_f32_16x16x32_bf16 v[92:95], a[88:91], a[60:63], v[92:95]
  v_mfma_f32_16x16x32_bf16 v[100:103], a[92:95], a[60:63], v[100:103]
  v_mfma_f32_16x16x32_bf16 v[96:99], a[92:95], a[56:59], v[96:99]
  s_waitcnt vmcnt(18)
  v_permlane16_swap_b32 v232, v234
  v_permlane16_swap_b32 v233, v235
  v_permlane16_swap_b32 v236, v238
  v_permlane16_swap_b32 v237, v239
  v_permlane16_swap_b32 v240, v242
  v_permlane16_swap_b32 v241, v243
  v_permlane16_swap_b32 v244, v246
  v_permlane16_swap_b32 v245, v247
  v_add_f32 v96, v96, v97
  v_add_f32 v248, v248, v96
  v_mov_b32 v190, 0
  v_mov_b32 v191, 0
  v_lshlrev_b32 v192, 16, v232
  v_and_b32 v193, 0xffff0000, v232
  v_sub_f32 v192, v192, v248
  v_sub_f32 v193, v193, v248
  v_pk_add_f32 v[64:65], v[64:65], v[192:193]
  v_pk_fma_f32 v[190:191], v[64:65], v[64:65], v[190:191]
  v_cvt_pk_bf16_f32 v232, v64, v65
  v_lshlrev_b32 v192, 16, v233
  v_and_b32 v193, 0xffff0000, v233
  v_sub_f32 v192, v192, v248
  v_sub_f32 v193, v193, v248
  v_pk_add_f32 v[66:67], v[66:67], v[192:193]
  v_pk_fma_f32 v[190:191], v[66:67], v[66:67], v[190:191]
  v_cvt_pk_bf16_f32 v233, v66, v67
  v_lshlrev_b32 v192, 16, v234
  v_and_b32 v193, 0xffff0000, v234
  v_sub_f32 v192, v192, v248
  v_sub_f32 v193, v193, v248
  v_pk_add_f32 v[72:73], v[72:73], v[192:193]
  v_pk_fma_f32 v[190:191], v[72:73], v[72:73], v[190:191]
  v_cvt_pk_bf16_f32 v234, v72, v73
  v_lshlrev_b32 v192, 16, v235
  v_and_b32 v193, 0xffff0000, v235
  v_sub_f32 v192, v192, v248
  v_sub_f32 v193, v193, v248
  v_pk_add_f32 v[74:75], v[74:75], v[192:193]
  v_pk_fma_f32 v[190:191], v[74:75], v[74:75], v[190:191]
  v_cvt_pk_bf16_f32 v235, v74, v75
  buffer_store_dwordx4 v[232:235], v9, s[48:51], s38 offen offset:0 sc1
  v_lshlrev_b32 v192, 16, v236
  v_and_b32 v193, 0xffff0000, v236
  v_sub_f32 v192, v192, v248
  v_sub_f32 v193, v193, v248
  v_pk_add_f32 v[80:81], v[80:81], v[192:193]
  v_pk_fma_f32 v[190:191], v[80:81], v[80:81], v[190:191]
  v_cvt_pk_bf16_f32 v236, v80, v81
  v_lshlrev_b32 v192, 16, v237
  v_and_b32 v193, 0xffff0000, v237
  v_sub_f32 v192, v192, v248
  v_sub_f32 v193, v193, v248
  v_pk_add_f32 v[82:83], v[82:83], v[192:193]
  v_pk_fma_f32 v[190:191], v[82:83], v[82:83], v[190:191]
  v_cvt_pk_bf16_f32 v237, v82, v83
  v_lshlrev_b32 v192, 16, v238
  v_and_b32 v193, 0xffff0000, v238
  v_sub_f32 v192, v192, v248
  v_sub_f32 v193, v193, v248
  v_pk_add_f32 v[88:89], v[88:89], v[192:193]
  v_pk_fma_f32 v[190:191], v[88:89], v[88:89], v[190:191]
  v_cvt_pk_bf16_f32 v238, v88, v89
  v_lshlrev_b32 v192, 16, v239
  v_and_b32 v193, 0xffff0000, v239
  v_sub_f32 v192, v192, v248
  v_sub_f32 v193, v193, v248
  v_pk_add_f32 v[90:91], v[90:91], v[192:193]
  v_pk_fma_f32 v[190:191], v[90:91], v[90:91], v[190:191]
  v_cvt_pk_bf16_f32 v239, v90, v91
  buffer_store_dwordx4 v[236:239], v9, s[48:51], s39 offen offset:0 sc1
  v_add_f32 v194, v190, v191
  v_mov_b32 v191, v194
  s_nop 1
  v_permlane16_swap_b32 v191, v194
  v_add_f32 v194, v194, v191
  v_mov_b32 v191, v194
  s_nop 1
  v_permlane32_swap_b32 v191, v194
  v_add_f32 v194, v194, v191
  v_add_f32 v100, v100, v101
  v_add_f32 v249, v249, v100
  v_mov_b32 v190, 0
  v_mov_b32 v191, 0
  v_lshlrev_b32 v192, 16, v240
  v_and_b32 v193, 0xffff0000, v240
  v_sub_f32 v192, v192, v249
  v_sub_f32 v193, v193, v249
  v_pk_add_f32 v[68:69], v[68:69], v[192:193]
  v_pk_fma_f32 v[190:191], v[68:69], v[68:69], v[190:191]
  v_cvt_pk_bf16_f32 v240, v68, v69
  v_lshlrev_b32 v192, 16, v241
  v_and_b32 v193, 0xffff0000, v241
  v_sub_f32 v192, v192, v249
  v_sub_f32 v193, v193, v249
  v_pk_add_f32 v[70:71], v[70:71], v[192:193]
  v_pk_fma_f32 v[190:191], v[70:71], v[70:71], v[190:191]
  v_cvt_pk_bf16_f32 v241, v70, v71
  v_lshlrev_b32 v192, 16, v242
  v_and_b32 v193, 0xffff0000, v242
  v_sub_f32 v192, v192, v249
  v_sub_f32 v193, v193, v249
  v_pk_add_f32 v[76:77], v[76:77], v[192:193]
  v_pk_fma_f32 v[190:191], v[76:77], v[76:77], v[190:191]
  v_cvt_pk_bf16_f32 v242, v76, v77
  v_lshlrev_b32 v192, 16, v243
  v_and_b32 v193, 0xffff0000, v243
  v_sub_f32 v192, v192, v249
  v_sub_f32 v193, v193, v249
  v_pk_add_f32 v[78:79], v[78:79], v[192:193]
  v_pk_fma_f32 v[190:191], v[78:79], v[78:79], v[190:191]
  v_cvt_pk_bf16_f32 v243, v78, v79
  buffer_store_dwordx4 v[240:243], v9, s[48:51], s38 offen offset:1024 sc1
  v_lshlrev_b32 v192, 16, v244
  v_and_b32 v193, 0xffff0000, v244
  v_sub_f32 v192, v192, v249
  v_sub_f32 v193, v193, v249
  v_pk_add_f32 v[84:85], v[84:85], v[192:193]
  v_pk_fma_f32 v[190:191], v[84:85], v[84:85], v[190:191]
  v_cvt_pk_bf16_f32 v244, v84, v85
  v_lshlrev_b32 v192, 16, v245
  v_and_b32 v193, 0xffff0000, v245
  v_sub_f32 v192, v192, v249
  v_sub_f32 v193, v193, v249
  v_pk_add_f32 v[86:87], v[86:87], v[192:193]
  v_pk_fma_f32 v[190:191], v[86:87], v[86:87], v[190:191]
  v_cvt_pk_bf16_f32 v245, v86, v87
  v_lshlrev_b32 v192, 16, v246
  v_and_b32 v193, 0xffff0000, v246
  v_sub_f32 v192, v192, v249
  v_sub_f32 v193, v193, v249
  v_pk_add_f32 v[92:93], v[92:93], v[192:193]
  v_pk_fma_f32 v[190:191], v[92:93], v[92:93], v[190:191]
  v_cvt_pk_bf16_f32 v246, v92, v93
  v_lshlrev_b32 v192, 16, v247
  v_and_b32 v193, 0xffff0000, v247
  v_sub_f32 v192, v192, v249
  v_sub_f32 v193, v193, v249
  v_pk_add_f32 v[94:95], v[94:95], v[192:193]
  v_pk_fma_f32 v[190:191], v[94:95], v[94:95], v[190:191]
  v_cvt_pk_bf16_f32 v247, v94, v95
  buffer_store_dwordx4 v[244:247], v9, s[48:51], s39 offen offset:1024 sc1
  v_add_f32 v195, v190, v191
  v_mov_b32 v191, v195
  s_nop 1
  v_permlane16_swap_b32 v191, v195
  v_add_f32 v195, v195, v191
  v_mov_b32 v191, v195
  s_nop 1
  v_permlane32_swap_b32 v191, v195
  v_add_f32 v195, v195, v191
  s_mov_b64 exec, 0xffff
  buffer_store_dword v194, v187, s[12:15], s40 offen offset:0 sc1
  buffer_store_dword v195, v187, s[12:15], s40 offen offset:64 sc1
  s_cmp_lg_u32 s81, 0
  s_cbranch_scc1 L_p3_fin
  buffer_store_dword v248, v187, s[12:15], s41 offen offset:0 sc1
  buffer_store_dword v249, v187, s[12:15], s41 offen offset:64 sc1
L_p3_fin:
  s_mov_b64 exec, -1
  s_mov_b32 s84, s42
  s_mov_b32 m0, s26
  s_nop 0
  buffer_load_dwordx4 v2, s[4:7], s24 offen lds
  buffer_load_dwordx4 v3, s[4:7], s24 offen offset:1024 lds
  buffer_load_dwordx4 v4, s[4:7], s24 offen offset:2048 lds
  buffer_load_dwordx4 v5, s[4:7], s24 offen offset:3072 lds
  s_add_u32 m0, s26, 4096
  s_nop 0
  buffer_load_dwordx4 v6, s[4:7], s24 offen lds
  buffer_load_dwordx4 v7, s[4:7], s24 offen offset:1024 lds
  buffer_load_dwordx4 v8, s[4:7], s24 offen offset:2048 lds
  s_add_u32 s24, s24, 458752
  s_add_u32 s26, s26, 28672
  s_cmp_ge_u32 s26, s29
  s_cselect_b32 s26, s23, s26
  s_add_u32 s8, s62, 20971520
  s_addc_u32 s9, s63, 0
  s_mov_b32 s10, 4194304
  s_mov_b32 s11, 0x20000
  s_lshl_b32 s25, s21, 14
  s_lshl_b32 s30, s20, 12
  s_add_u32 s25, s25, s30
  s_mov_b32 s38, s25
  s_mov_b32 s27, 0
  s_lshl_b32 s85, s21, 1
  s_lshr_b32 s30, s22, 4
  s_add_u32 s85, s85, s30
  v_mov_b32 v32, 0
  v_mov_b32 v33, 0
  v_mov_b32 v34, 0
  v_mov_b32 v35, 0
  v_mov_b32 v36, 0
  v_mov_b32 v37, 0
  v_mov_b32 v38, 0
  v_mov_b32 v39, 0
  v_mov_b32 v40, 0
  v_mov_b32 v41, 0
  v_mov_b32 v42, 0
  v_mov_b32 v43, 0
  v_mov_b32 v44, 0
  v_mov_b32 v45, 0
  v_mov_b32 v46, 0
  v_mov_b32 v47, 0
  v_mov_b32 v48, 0
  v_mov_b32 v49, 0
  v_mov_b32 v50, 0
  v_mov_b32 v51, 0
  v_mov_b32 v52, 0
  v_mov_b32 v53, 0
  v_mov_b32 v54, 0
  v_mov_b32 v55, 0
  v_mov_b32 v56, 0
  v_mov_b32 v57, 0
  v_mov_b32 v58, 0
  v_mov_b32 v59, 0
  v_mov_b32 v60, 0
  v_mov_b32 v61, 0
  v_mov_b32 v62, 0
  v_mov_b32 v63, 0
  v_mov_b32 v64, 0
  v_mov_b32 v65, 0
  v_mov_b32 v66, 0
  v_mov_b32 v67, 0
  v_mov_b32 v68, 0
  v_mov_b32 v69, 0
  v_mov_b32 v70, 0
  v_mov_b32 v71, 0
  v_mov_b32 v72, 0
  v_mov_b32 v73, 0
  v_mov_b32 v74, 0
  v_mov_b32 v75, 0
  v_mov_b32 v76, 0
  v_mov_b32 v77, 0
  v_mov_b32 v78, 0
  v_mov_b32 v79, 0
  v_mov_b32 v80, 0
  v_mov_b32 v81, 0
  v_mov_b32 v82, 0
  v_mov_b32 v83, 0
  v_mov_b32 v84, 0
  v_mov_b32 v85, 0
  v_mov_b32 v86, 0
  v_mov_b32 v87, 0
  v_mov_b32 v88, 0
  v_mov_b32 v89, 0
  v_mov_b32 v90, 0
  v_mov_b32 v91, 0
  v_mov_b32 v92, 0
  v_mov_b32 v93, 0
  v_mov_b32 v94, 0
  v_mov_b32 v95, 0
  v_lshrrev_b32 v28, 2, v1
  v_mul_u32_u24 v28, 224, v28
  v_and_b32 v29, 3, v1
  v_lshl_add_u32 v10, v29, 3, v28
  v_mov_b32 v11, v10
  v_and_b32 v29, 1, v1
  v_lshl_add_u32 v28, v29, 4, v28
  v_bfe_u32 v29, v1, 1, 1
  v_lshl_add_u32 v13, v29, 3, v28
  v_mov_b32 v14, v13
  s_add_u32 s12, s62, 25165824
  s_addc_u32 s13, s63, 0
  s_mov_b32 s14, 14680064
  s_mov_b32 s15, 0x20000
  s_lshr_b32 s30, s22, 1
  s_mul_i32 s30, s30, 7
  s_and_b32 s31, s22, 1
  s_add_u32 s43, s30, 3
  s_lshl_b32 s43, s43, 17
  s_add_u32 s43, s43, s38
  s_lshl_b32 s33, s31, 9
  s_add_u32 s43, s43, s33
  s_lshl_b32 s31, s31, 2
  s_add_u32 s30, s30, s31
  s_lshl_b32 s30, s30, 17
  s_add_u32 s40, s30, s38
  s_add_u32 s41, s40, 131072
  s_add_u32 s42, s41, 131072
  s_add_u32 s30, s84, 24
  s_lshl_b32 s30, s30, 8
  v_mov_b32 v30, s30
  v_mov_b32 v31, 1
  s_waitcnt vmcnt(7) lgkmcnt(0)
  s_barrier
  s_cmp_lg_u32 s20, 0
  s_cbranch_scc1 L_sig_p3
  s_mov_b64 exec, 1
  global_atomic_add v30, v31, s[58:59] sc1
  s_mov_b64 exec, -1
L_sig_p3:
  s_add_u32 s30, s21, 24
  s_lshl_b32 s30, s30, 8
  v_mov_b32 v30, s30
  v_mov_b32 v29, 0
  s_cmp_lg_u32 s20, 0
  s_cbranch_scc1 L_np_p4
  s_mov_b64 exec, 1
  global_atomic_add v31, v30, v29, s[58:59] sc0 sc1
  s_mov_b64 exec, -1
L_np_p4:
  s_mov_b32 m0, s26
  s_nop 0
  buffer_load_dwordx4 v2, s[4:7], s24 offen lds
  buffer_load_dwordx4 v3, s[4:7], s24 offen offset:1024 lds
  buffer_load_dwordx4 v4, s[4:7], s24 offen offset:2048 lds
  buffer_load_dwordx4 v5, s[4:7], s24 offen offset:3072 lds
  s_add_u32 m0, s26, 4096
  s_nop 0
  buffer_load_dwordx4 v6, s[4:7], s24 offen lds
  buffer_load_dwordx4 v7, s[4:7], s24 offen offset:1024 lds
  buffer_load_dwordx4 v8, s[4:7], s24 offen offset:2048 lds
  s_add_u32 s24, s24, 458752
  s_add_u32 s26, s26, 28672
  s_cmp_ge_u32 s26, s29
  s_cselect_b32 s26, s23, s26
  v_mov_b32 v96, 0
  v_mov_b32 v97, 0
  v_mov_b32 v98, 0
  v_mov_b32 v99, 0
  v_mov_b32 v100, 0
  v_mov_b32 v101, 0
  v_mov_b32 v102, 0
  v_mov_b32 v103, 0
  v_mov_b32 v104, 0
  v_mov_b32 v105, 0
  v_mov_b32 v106, 0
  v_mov_b32 v107, 0
  v_mov_b32 v108, 0
  v_mov_b32 v109, 0
  v_mov_b32 v110, 0
  v_mov_b32 v111, 0
  v_mov_b32 v112, 0
  v_mov_b32 v113, 0
  v_mov_b32 v114, 0
  v_mov_b32 v115, 0
  v_mov_b32 v116, 0
  v_mov_b32 v117, 0
  v_mov_b32 v118, 0
  v_mov_b32 v119, 0
  v_mov_b32 v120, 0
  v_mov_b32 v121, 0
  v_mov_b32 v122, 0
  v_mov_b32 v123, 0
  v_mov_b32 v124, 0
  v_mov_b32 v125, 0
  v_mov_b32 v126, 0
  v_mov_b32 v127, 0
  v_mov_b32 v128, 0
  v_mov_b32 v129, 0
  v_mov_b32 v130, 0
  v_mov_b32 v131, 0
  v_mov_b32 v132, 0
  v_mov_b32 v133, 0
  v_mov_b32 v134, 0
  v_mov_b32 v135, 0
  v_mov_b32 v136, 0
  v_mov_b32 v137, 0
  v_mov_b32 v138, 0
  v_mov_b32 v139, 0
  v_mov_b32 v140, 0
  v_mov_b32 v141, 0
  v_mov_b32 v142, 0
  v_mov_b32 v143, 0
  v_mov_b32 v144, 0
  v_mov_b32 v145, 0
  v_mov_b32 v146, 0
  v_mov_b32 v147, 0
  v_mov_b32 v148, 0
  v_mov_b32 v149, 0
  v_mov_b32 v150, 0
  v_mov_b32 v151, 0
  v_mov_b32 v152, 0
  v_mov_b32 v153, 0
  v_mov_b32 v154, 0
  v_mov_b32 v155, 0
  v_mov_b32 v156, 0
  v_mov_b32 v157, 0
  v_mov_b32 v158, 0
  v_mov_b32 v159, 0
  v_mov_b32 v160, 0
  v_mov_b32 v161, 0
  v_mov_b32 v162, 0
  v_mov_b32 v163, 0
  v_mov_b32 v164, 0
  v_mov_b32 v165, 0
  v_mov_b32 v166, 0
  v_mov_b32 v167, 0
  v_mov_b32 v168, 0
  v_mov_b32 v169, 0
  v_mov_b32 v170, 0
  v_mov_b32 v171, 0
  v_mov_b32 v172, 0
  v_mov_b32 v173, 0
  v_mov_b32 v174, 0
  v_mov_b32 v175, 0
  v_mov_b32 v176, 0
  v_mov_b32 v177, 0
  v_mov_b32 v178, 0
  v_mov_b32 v179, 0
  v_mov_b32 v180, 0
  v_mov_b32 v181, 0
  v_mov_b32 v182, 0
  v_mov_b32 v183, 0
  v_mov_b32 v184, 0
  v_mov_b32 v185, 0
  v_mov_b32 v186, 0
  v_mov_b32 v187, 0
  v_mov_b32 v188, 0
  v_mov_b32 v189, 0
  v_mov_b32 v190, 0
  v_mov_b32 v191, 0
  v_mov_b32 v192, 0
  v_mov_b32 v193, 0
  v_mov_b32 v194, 0
  v_mov_b32 v195, 0
  v_mov_b32 v196, 0
  v_mov_b32 v197, 0
  v_mov_b32 v198, 0
  v_mov_b32 v199, 0
  v_mov_b32 v200, 0
  v_mov_b32 v201, 0
  v_mov_b32 v202, 0
  v_mov_b32 v203, 0
  v_mov_b32 v204, 0
  v_mov_b32 v205, 0
  v_mov_b32 v206, 0
  v_mov_b32 v207, 0
  v_mov_b32 v208, 0
  v_mov_b32 v209, 0
  v_mov_b32 v210, 0
  v_mov_b32 v211, 0
  v_mov_b32 v212, 0
  v_mov_b32 v213, 0
  v_mov_b32 v214, 0
  v_mov_b32 v215, 0
  v_mov_b32 v216, 0
  v_mov_b32 v217, 0
  v_mov_b32 v218, 0
  v_mov_b32 v219, 0
  v_mov_b32 v220, 0
  v_mov_b32 v221, 0
  v_mov_b32 v222, 0
  v_mov_b32 v223, 0
  v_mov_b32 v224, 0
  v_mov_b32 v225, 0
  v_mov_b32 v226, 0
  v_mov_b32 v227, 0
  v_mov_b32 v228, 0
  v_mov_b32 v229, 0
  v_mov_b32 v230, 0
  v_mov_b32 v231, 0
  v_mov_b32 v232, 0
  v_mov_b32 v233, 0
  v_mov_b32 v234, 0
  v_mov_b32 v235, 0
  v_mov_b32 v236, 0
  v_mov_b32 v237, 0
  v_mov_b32 v238, 0
  v_mov_b32 v239, 0
  v_mov_b32 v240, 0
  v_mov_b32 v241, 0
  v_mov_b32 v242, 0
  v_mov_b32 v243, 0
  v_mov_b32 v244, 0
  v_mov_b32 v245, 0
  v_mov_b32 v246, 0
  v_mov_b32 v247, 0
  v_mov_b32 v248, 0
  v_mov_b32 v249, 0
  v_mov_b32 v250, 0
  v_mov_b32 v251, 0
  v_mov_b32 v252, 0
  v_mov_b32 v253, 0
  v_mov_b32 v254, 0
  v_mov_b32 v255, 0
  s_cmp_lg_u32 s20, 0
  s_cbranch_scc1 L_go_p4
  s_mov_b32 s31, 0x40000
  s_waitcnt vmcnt(7)
L_poll_p4:
  v_readfirstlane_b32 s30, v31
  s_sub_u32 s31, s31, 1
  s_nop 0
  s_cselect_b32 s30, 32, s30
  s_cmp_ge_u32 s30, 32
  s_cbranch_scc1 L_go_p4
  s_sleep 2
  s_mov_b64 exec, 1
  global_atomic_add v31, v30, v29, s[58:59] sc0 sc1
  s_mov_b64 exec, -1
  s_waitcnt vmcnt(0)
  s_branch L_poll_p4
L_go_p4:
  s_barrier
  buffer_load_dwordx4 a[0:3], v9, s[8:11], s25 offen offset:0 sc1
  buffer_load_dwordx4 a[4:7], v9, s[8:11], s25 offen offset:1024 sc1
  buffer_load_dwordx4 a[8:11], v9, s[8:11], s25 offen offset:2048 sc1
  buffer_load_dwordx4 a[12:15], v9, s[8:11], s25 offen offset:3072 sc1
  s_add_u32 s25, s25, 131072
  buffer_load_dwordx4 a[16:19], v9, s[8:11], s25 offen offset:0 sc1
  buffer_load_dwordx4 a[20:23], v9, s[8:11], s25 offen offset:1024 sc1
  buffer_load_dwordx4 a[24:27], v9, s[8:11], s25 offen offset:2048 sc1
  buffer_load_dwordx4 a[28:31], v9, s[8:11], s25 offen offset:3072 sc1
  s_add_u32 s25, s25, 131072
  buffer_load_dwordx4 a[32:35], v9, s[8:11], s25 offen offset:0 sc1
  buffer_load_dwordx4 a[36:39], v9, s[8:11], s25 offen offset:1024 sc1
  buffer_load_dwordx4 a[40:43], v9, s[8:11], s25 offen offset:2048 sc1
  buffer_load_dwordx4 a[44:47], v9, s[8:11], s25 offen offset:3072 sc1
  s_add_u32 s25, s25, 131072
  s_sub_u32 s25, s25, 393216
  s_add_u32 s30, s25, 4063232
  buffer_load_dwordx4 a[80:83], v9, s[8:11], s30 offen offset:0 sc1
  buffer_load_dwordx4 a[84:87], v9, s[8:11], s30 offen offset:1024 sc1
  buffer_load_dwordx4 a[88:91], v9, s[8:11], s30 offen offset:2048 sc1
  buffer_load_dwordx4 a[92:95], v9, s[8:11], s30 offen offset:3072 sc1
  s_add_u32 s25, s25, 393216
  s_waitcnt vmcnt(12)
  s_barrier
  ds_read_b64_tr_b16 a[64:65], v11 offset:0
  ds_read_b64_tr_b16 a[66:67], v11 offset:3584
  ds_read_b64_tr_b16 a[68:69], v11 offset:32
  ds_read_b64_tr_b16 a[70:71], v11 offset:3616
  ds_read_b64_tr_b16 a[72:73], v11 offset:64
  ds_read_b64_tr_b16 a[74:75], v11 offset:3648
  s_mov_b32 s28, 7
  s_waitcnt lgkmcnt(4)
.p2align 5
L_k4_loop:
  v_mfma_f32_16x16x32_bf16 v[32:35], a[64:67], a[0:3], v[32:35]
  s_add_u32 s27, s27, 28672
  ds_read_b64_tr_b16 a[76:77], v11 offset:96
  v_mfma_f32_16x16x32_bf16 v[36:39], a[64:67], a[4:7], v[36:39]
  s_cmp_ge_u32 s27, 143360
  ds_read_b64_tr_b16 a[78:79], v11 offset:3680
  s_cselect_b32 s27, 0, s27
  v_mfma_f32_16x16x32_bf16 v[40:43], a[64:67], a[8:11], v[40:43]
  v_mfma_f32_16x16x32_bf16 v[44:47], a[64:67], a[12:15], v[44:47]
  s_waitcnt lgkmcnt(4)
  buffer_load_dwordx4 a[48:51], v9, s[8:11], s25 offen offset:0 sc1
  v_mfma_f32_16x16x32_bf16 v[60:63], a[68:71], a[12:15], v[60:63]
  ds_read_b64_tr_b16 a[64:65], v11 offset:128
  v_mfma_f32_16x16x32_bf16 v[56:59], a[68:71], a[8:11], v[56:59]
  ds_read_b64_tr_b16 a[66:67], v11 offset:3712
  v_mfma_f32_16x16x32_bf16 v[52:55], a[68:71], a[4:7], v[52:55]
  v_add_u32 v12, s27, v10
  v_mfma_f32_16x16x32_bf16 v[48:51], a[68:71], a[0:3], v[48:51]
  s_waitcnt lgkmcnt(4)
  v_mfma_f32_16x16x32_bf16 v[64:67], a[72:75], a[0:3], v[64:67]
  ds_read_b64_tr_b16 a[68:69], v11 offset:160
  v_mfma_f32_16x16x32_bf16 v[68:71], a[72:75], a[4:7], v[68:71]
  ds_read_b64_tr_b16 a[70:71], v11 offset:3744
  v_mfma_f32_16x16x32_bf16 v[72:75], a[72:75], a[8:11], v[72:75]
  s_mov_b32 m0, s26
  v_mfma_f32_16x16x32_bf16 v[76:79], a[72:75], a[12:15], v[76:79]
  s_waitcnt lgkmcnt(4)
  buffer_load_dwordx4 v2, s[4:7], s24 offen lds
  v_mfma_f32_16x16x32_bf16 v[92:95], a[76:79], a[12:15], v[92:95]
  ds_read_b64_tr_b16 a[72:73], v14 offset:192
  v_mfma_f32_16x16x32_bf16 v[88:91], a[76:79], a[8:11], v[88:91]
  ds_read_b64_tr_b16 a[74:75], v14 offset:3776
  v_mfma_f32_16x16x32_bf16 v[84:87], a[76:79], a[4:7], v[84:87]
  v_mfma_f32_16x16x32_bf16 v[80:83], a[76:79], a[0:3], v[80:83]
  s_waitcnt lgkmcnt(4)
  v_mfma_f32_16x16x32_bf16 v[96:99], a[64:67], a[0:3], v[96:99]
  ds_read_b64_tr_b16 a[76:77], v11 offset:14336
  v_mfma_f32_16x16x32_bf16 v[100:103], a[64:67], a[4:7], v[100:103]
  ds_read_b64_tr_b16 a[78:79], v11 offset:17920
  v_mfma_f32_16x16x32_bf16 v[104:107], a[64:67], a[8:11], v[104:107]
  buffer_load_dwordx4 a[52:55], v9, s[8:11], s25 offen offset:1024 sc1
  v_mfma_f32_16x16x32_bf16 v[108:111], a[64:67], a[12:15], v[108:111]
  s_waitcnt lgkmcnt(4)
  v_mfma_f32_16x16x32_bf16 v[124:127], a[68:71], a[12:15], v[124:127]
  ds_read_b64_tr_b16 a[64:65], v11 offset:14368
  v_mfma_f32_16x16x32_bf16 v[120:123], a[68:71], a[8:11], v[120:123]
  ds_read_b64_tr_b16 a[66:67], v11 offset:17952
  v_mfma_f32_16x16x32_bf16 v[116:119], a[68:71], a[4:7], v[116:119]
  v_mfma_f32_16x16x32_bf16 v[112:115], a[68:71], a[0:3], v[112:115]
  s_waitcnt lgkmcnt(4)
  v_mfma_f32_16x16x32_bf16 v[128:131], a[72:75], a[0:3], v[128:131]
  ds_read_b64_tr_b16 a[68:69], v11 offset:14400
  v_mfma_f32_16x16x32_bf16 v[132:135], a[72:75], a[4:7], v[132:135]
  ds_read_b64_tr_b16 a[70:71], v11 offset:17984
  v_mfma_f32_16x16x32_bf16 v[136:139], a[72:75], a[8:11], v[136:139]
  buffer_load_dwordx4 v3, s[4:7], s24 offen offset:1024 lds
  v_mfma_f32_16x16x32_bf16 v[140:143], a[72:75], a[12:15], v[140:143]
  s_waitcnt lgkmcnt(4)
  v_mfma_f32_16x16x32_bf16 v[156:159], a[76:79], a[12:15], v[156:159]
  ds_read_b64_tr_b16 a[72:73], v11 offset:14432
  v_mfma_f32_16x16x32_bf16 v[152:155], a[76:79], a[8:11], v[152:155]
  ds_read_b64_tr_b16 a[74:75], v11 offset:18016
  v_mfma_f32_16x16x32_bf16 v[148:151], a[76:79], a[4:7], v[148:151]
  v_mfma_f32_16x16x32_bf16 v[144:147], a[76:79], a[0:3], v[144:147]
  s_waitcnt lgkmcnt(4)
  buffer_load_dwordx4 a[56:59], v9, s[8:11], s25 offen offset:2048 sc1
  v_mfma_f32_16x16x32_bf16 v[160:163], a[64:67], a[0:3], v[160:163]
  ds_read_b64_tr_b16 a[76:77], v11 offset:14464
  v_mfma_f32_16x16x32_bf16 v[164:167], a[64:67], a[4:7], v[164:167]
  ds_read_b64_tr_b16 a[78:79], v11 offset:18048
  v_mfma_f32_16x16x32_bf16 v[168:171], a[64:67], a[8:11], v[168:171]
  v_mfma_f32_16x16x32_bf16 v[172:175], a[64:67], a[12:15], v[172:175]
  s_waitcnt lgkmcnt(4)
  v_mfma_f32_16x16x32_bf16 v[188:191], a[68:71], a[12:15], v[188:191]
  ds_read_b64_tr_b16 a[64:65], v11 offset:14496
  v_mfma_f32_16x16x32_bf16 v[184:187], a[68:71], a[8:11], v[184:187]
  ds_read_b64_tr_b16 a[66:67], v11 offset:18080
  v_mfma_f32_16x16x32_bf16 v[180:183], a[68:71], a[4:7], v[180:183]
  v_mfma_f32_16x16x32_bf16 v[176:179], a[68:71], a[0:3], v[176:179]
  s_waitcnt lgkmcnt(4)
  buffer_load_dwordx4 v4, s[4:7], s24 offen offset:2048 lds
  v_mfma_f32_16x16x32_bf16 v[192:195], a[72:75], a[0:3], v[192:195]
  ds_read_b64_tr_b16 a[68:69], v14 offset:14528
  v_mfma_f32_16x16x32_bf16 v[196:199], a[72:75], a[4:7], v[196:199]
  ds_read_b64_tr_b16 a[70:71], v14 offset:18112
  v_mfma_f32_16x16x32_bf16 v[200:203], a[72:75], a[8:11], v[200:203]
  v_mfma_f32_16x16x32_bf16 v[204:207], a[72:75], a[12:15], v[204:207]
  s_waitcnt lgkmcnt(4)
  v_mfma_f32_16x16x32_bf16 v[220:223], a[76:79], a[12:15], v[220:223]
  ds_read_b64_tr_b16 a[72:73], v11 offset:7168
  v_mfma_f32_16x16x32_bf16 v[216:219], a[76:79], a[8:11], v[216:219]
  ds_read_b64_tr_b16 a[74:75], v11 offset:10752
  v_mfma_f32_16x16x32_bf16 v[212:215], a[76:79], a[4:7], v[212:215]
  buffer_load_dwordx4 a[60:63], v9, s[8:11], s25 offen offset:3072 sc1
  s_add_u32 s25, s25, 131072
  v_mfma_f32_16x16x32_bf16 v[208:211], a[76:79], a[0:3], v[208:211]
  s_waitcnt lgkmcnt(4)
  v_mfma_f32_16x16x32_bf16 v[224:227], a[64:67], a[0:3], v[224:227]
  ds_read_b64_tr_b16 a[76:77], v11 offset:7200
  v_mfma_f32_16x16x32_bf16 v[228:231], a[64:67], a[4:7], v[228:231]
  ds_read_b64_tr_b16 a[78:79], v11 offset:10784
  v_mfma_f32_16x16x32_bf16 v[232:235], a[64:67], a[8:11], v[232:235]
  v_mfma_f32_16x16x32_bf16 v[236:239], a[64:67], a[12:15], v[236:239]
  s_waitcnt lgkmcnt(4)
  v_mfma_f32_16x16x32_bf16 v[252:255], a[68:71], a[12:15], v[252:255]
  ds_read_b64_tr_b16 a[64:65], v11 offset:7232
  v_mfma_f32_16x16x32_bf16 v[248:251], a[68:71], a[8:11], v[248:251]
  ds_read_b64_tr_b16 a[66:67], v11 offset:10816
  v_mfma_f32_16x16x32_bf16 v[244:247], a[68:71], a[4:7], v[244:247]
  buffer_load_dwordx4 v5, s[4:7], s24 offen offset:3072 lds
  v_mfma_f32_16x16x32_bf16 v[240:243], a[68:71], a[0:3], v[240:243]
  s_waitcnt vmcnt(16) lgkmcnt(4)
  v_add_u32 v15, s27, v13
  v_mfma_f32_16x16x32_bf16 v[32:35], a[72:75], a[16:19], v[32:35]
  ds_read_b64_tr_b16 a[68:69], v11 offset:7264
  v_mfma_f32_16x16x32_bf16 v[36:39], a[72:75], a[20:23], v[36:39]
  ds_read_b64_tr_b16 a[70:71], v11 offset:10848
  v_mfma_f32_16x16x32_bf16 v[40:43], a[72:75], a[24:27], v[40:43]
  v_mfma_f32_16x16x32_bf16 v[44:47], a[72:75], a[28:31], v[44:47]
  s_waitcnt lgkmcnt(4)
  buffer_load_dwordx4 a[0:3], v9, s[8:11], s25 offen offset:0 sc1
  v_mfma_f32_16x16x32_bf16 v[60:63], a[76:79], a[28:31], v[60:63]
  ds_read_b64_tr_b16 a[72:73], v11 offset:7296
  v_mfma_f32_16x16x32_bf16 v[56:59], a[76:79], a[24:27], v[56:59]
  ds_read_b64_tr_b16 a[74:75], v11 offset:10880
  v_mfma_f32_16x16x32_bf16 v[52:55], a[76:79], a[20:23], v[52:55]
  v_mfma_f32_16x16x32_bf16 v[48:51], a[76:79], a[16:19], v[48:51]
  s_waitcnt lgkmcnt(4)
  v_mfma_f32_16x16x32_bf16 v[64:67], a[64:67], a[16:19], v[64:67]
  ds_read_b64_tr_b16 a[76:77], v11 offset:7328
  v_mfma_f32_16x16x32_bf16 v[68:71], a[64:67], a[20:23], v[68:71]
  ds_read_b64_tr_b16 a[78:79], v11 offset:10912
  v_mfma_f32_16x16x32_bf16 v[72:75], a[64:67], a[24:27], v[72:75]
  s_add_u32 m0, s26, 4096
  v_mfma_f32_16x16x32_bf16 v[76:79], a[64:67], a[28:31], v[76:79]
  s_waitcnt lgkmcnt(4)
  buffer_load_dwordx4 v6, s[4:7], s24 offen lds
  v_mfma_f32_16x16x32_bf16 v[92:95], a[68:71], a[28:31], v[92:95]
  ds_read_b64_tr_b16 a[64:65], v14 offset:7360
  v_mfma_f32_16x16x32_bf16 v[88:91], a[68:71], a[24:27], v[88:91]
  ds_read_b64_tr_b16 a[66:67], v14 offset:10944
  v_mfma_f32_16x16x32_bf16 v[84:87], a[68:71], a[20:23], v[84:87]
  v_mfma_f32_16x16x32_bf16 v[80:83], a[68:71], a[16:19], v[80:83]
  s_waitcnt lgkmcnt(4)
  v_mfma_f32_16x16x32_bf16 v[96:99], a[72:75], a[16:19], v[96:99]
  ds_read_b64_tr_b16 a[68:69], v11 offset:21504
  v_mfma_f32_16x16x32_bf16 v[100:103], a[72:75], a[20:23], v[100:103]
  ds_read_b64_tr_b16 a[70:71], v11 offset:25088
  v_mfma_f32_16x16x32_bf16 v[104:107], a[72:75], a[24:27], v[104:107]
  buffer_load_dwordx4 a[4:7], v9, s[8:11], s25 offen offset:1024 sc1
  v_mfma_f32_16x16x32_bf16 v[108:111], a[72:75], a[28:31], v[108:111]
  s_waitcnt lgkmcnt(4)
  v_mfma_f32_16x16x32_bf16 v[124:127], a[76:79], a[28:31], v[124:127]
  ds_read_b64_tr_b16 a[72:73], v11 offset:21536
  v_mfma_f32_16x16x32_bf16 v[120:123], a[76:79], a[24:27], v[120:123]
  ds_read_b64_tr_b16 a[74:75], v11 offset:25120
  v_mfma_f32_16x16x32_bf16 v[116:119], a[76:79], a[20:23], v[116:119]
  v_mfma_f32_16x16x32_bf16 v[112:115], a[76:79], a[16:19], v[112:115]
  s_waitcnt lgkmcnt(4)
  v_mfma_f32_16x16x32_bf16 v[128:131], a[64:67], a[16:19], v[128:131]
  ds_read_b64_tr_b16 a[76:77], v11 offset:21568
  v_mfma_f32_16x16x32_bf16 v[132:135], a[64:67], a[20:23], v[132:135]
  ds_read_b64_tr_b16 a[78:79], v11 offset:25152
  v_mfma_f32_16x16x32_bf16 v[136:139], a[64:67], a[24:27], v[136:139]
  buffer_load_dwordx4 v7, s[4:7], s24 offen offset:1024 lds
  v_mfma_f32_16x16x32_bf16 v[140:143], a[64:67], a[28:31], v[140:143]
  s_waitcnt lgkmcnt(4)
  v_mfma_f32_16x16x32_bf16 v[156:159], a[68:71], a[28:31], v[156:159]
  ds_read_b64_tr_b16 a[64:65], v11 offset:21600
  v_mfma_f32_16x16x32_bf16 v[152:155], a[68:71], a[24:27], v[152:155]
  ds_read_b64_tr_b16 a[66:67], v11 offset:25184
  v_mfma_f32_16x16x32_bf16 v[148:151], a[68:71], a[20:23], v[148:151]
  v_mfma_f32_16x16x32_bf16 v[144:147], a[68:71], a[16:19], v[144:147]
  s_waitcnt lgkmcnt(4)
  v_mfma_f32_16x16x32_bf16 v[160:163], a[72:75], a[16:19], v[160:163]
  ds_read_b64_tr_b16 a[68:69], v11 offset:21632
  v_mfma_f32_16x16x32_bf16 v[164:167], a[72:75], a[20:23], v[164:167]
  ds_read_b64_tr_b16 a[70:71], v11 offset:25216
  v_mfma_f32_16x16x32_bf16 v[168:171], a[72:75], a[24:27], v[168:171]
  buffer_load_dwordx4 a[8:11], v9, s[8:11], s25 offen offset:2048 sc1
  v_mfma_f32_16x16x32_bf16 v[172:175], a[72:75], a[28:31], v[172:175]
  s_waitcnt lgkmcnt(4)
  v_mfma_f32_16x16x32_bf16 v[188:191], a[76:79], a[28:31], v[188:191]
  ds_read_b64_tr_b16 a[72:73], v11 offset:21664
  v_mfma_f32_16x16x32_bf16 v[184:187], a[76:79], a[24:27], v[184:187]
  ds_read_b64_tr_b16 a[74:75], v11 offset:25248
  v_mfma_f32_16x16x32_bf16 v[180:183], a[76:79], a[20:23], v[180:183]
  v_mfma_f32_16x16x32_bf16 v[176:179], a[76:79], a[16:19], v[176:179]
  s_waitcnt lgkmcnt(4)
  buffer_load_dwordx4 a[12:15], v9, s[8:11], s25 offen offset:3072 sc1
  s_add_u32 s25, s25, 131072
  v_mfma_f32_16x16x32_bf16 v[192:195], a[64:67], a[16:19], v[192:195]
  ds_read_b64_tr_b16 a[76:77], v14 offset:21696
  v_mfma_f32_16x16x32_bf16 v[196:199], a[64:67], a[20:23], v[196:199]
  ds_read_b64_tr_b16 a[78:79], v14 offset:25280
  v_mfma_f32_16x16x32_bf16 v[200:203], a[64:67], a[24:27], v[200:203]
  v_mfma_f32_16x16x32_bf16 v[204:207], a[64:67], a[28:31], v[204:207]
  s_waitcnt vmcnt(29) lgkmcnt(4)
  s_barrier
  v_mfma_f32_16x16x32_bf16 v[220:223], a[68:71], a[28:31], v[220:223]
  ds_read_b64_tr_b16 a[64:65], v12 offset:0
  v_mfma_f32_16x16x32_bf16 v[216:219], a[68:71], a[24:27], v[216:219]
  ds_read_b64_tr_b16 a[66:67], v12 offset:3584
  v_mfma_f32_16x16x32_bf16 v[212:215], a[68:71], a[20:23], v[212:215]
  v_mfma_f32_16x16x32_bf16 v[208:211], a[68:71], a[16:19], v[208:211]
  s_waitcnt lgkmcnt(4)
  buffer_load_dwordx4 v8, s[4:7], s24 offen offset:2048 lds
  s_add_u32 s24, s24, 458752
  v_mfma_f32_16x16x32_bf16 v[224:227], a[72:75], a[16:19], v[224:227]
  s_add_u32 s26, s26, 28672
  ds_read_b64_tr_b16 a[68:69], v12 offset:32
  v_mfma_f32_16x16x32_bf16 v[228:231], a[72:75], a[20:23], v[228:231]
  s_cmp_ge_u32 s26, s29
  ds_read_b64_tr_b16 a[70:71], v12 offset:3616
  s_cselect_b32 s26, s23, s26
  v_mfma_f32_16x16x32_bf16 v[232:235], a[72:75], a[24:27], v[232:235]
  v_mfma_f32_16x16x32_bf16 v[236:239], a[72:75], a[28:31], v[236:239]
  s_waitcnt lgkmcnt(4)
  v_mfma_f32_16x16x32_bf16 v[252:255], a[76:79], a[28:31], v[252:255]
  ds_read_b64_tr_b16 a[72:73], v12 offset:64
  v_mfma_f32_16x16x32_bf16 v[248:251], a[76:79], a[24:27], v[248:251]
  ds_read_b64_tr_b16 a[74:75], v12 offset:3648
  v_mfma_f32_16x16x32_bf16 v[244:247], a[76:79], a[20:23], v[244:247]
  v_mfma_f32_16x16x32_bf16 v[240:243], a[76:79], a[16:19], v[240:243]
  s_waitcnt vmcnt(16) lgkmcnt(4)
  v_mfma_f32_16x16x32_bf16 v[32:35], a[64:67], a[32:35], v[32:35]
  s_add_u32 s27, s27, 28672
  ds_read_b64_tr_b16 a[76:77], v12 offset:96
  s_sub_u32 s28, s28, 1
  v_mfma_f32_16x16x32_bf16 v[36:39], a[64:67], a[36:39], v[36:39]
  s_cmp_ge_u32 s27, 143360
  ds_read_b64_tr_b16 a[78:79], v12 offset:3680
  s_cselect_b32 s27, 0, s27
  v_mfma_f32_16x16x32_bf16 v[40:43], a[64:67], a[40:43], v[40:43]
  v_mfma_f32_16x16x32_bf16 v[44:47], a[64:67], a[44:47], v[44:47]
  s_waitcnt lgkmcnt(4)
  buffer_load_dwordx4 a[16:19], v9, s[8:11], s25 offen offset:0 sc1
  v_mfma_f32_16x16x32_bf16 v[60:63], a[68:71], a[44:47], v[60:63]
  ds_read_b64_tr_b16 a[64:65], v12 offset:128
  v_mfma_f32_16x16x32_bf16 v[56:59], a[68:71], a[40:43], v[56:59]
  ds_read_b64_tr_b16 a[66:67], v12 offset:3712
  v_mfma_f32_16x16x32_bf16 v[52:55], a[68:71], a[36:39], v[52:55]
  v_add_u32 v11, s27, v10
  v_mfma_f32_16x16x32_bf16 v[48:51], a[68:71], a[32:35], v[48:51]
  s_waitcnt lgkmcnt(4)
  v_mfma_f32_16x16x32_bf16 v[64:67], a[72:75], a[32:35], v[64:67]
  ds_read_b64_tr_b16 a[68:69], v12 offset:160
  v_mfma_f32_16x16x32_bf16 v[68:71], a[72:75], a[36:39], v[68:71]
  ds_read_b64_tr_b16 a[70:71], v12 offset:3744
  v_mfma_f32_16x16x32_bf16 v[72:75], a[72:75], a[40:43], v[72:75]
  s_mov_b32 m0, s26
  v_mfma_f32_16x16x32_bf16 v[76:79], a[72:75], a[44:47], v[76:79]
  s_waitcnt lgkmcnt(4)
  buffer_load_dwordx4 v2, s[4:7], s24 offen lds
  v_mfma_f32_16x16x32_bf16 v[92:95], a[76:79], a[44:47], v[92:95]
  ds_read_b64_tr_b16 a[72:73], v15 offset:192
  v_mfma_f32_16x16x32_bf16 v[88:91], a[76:79], a[40:43], v[88:91]
  ds_read_b64_tr_b16 a[74:75], v15 offset:3776
  v_mfma_f32_16x16x32_bf16 v[84:87], a[76:79], a[36:39], v[84:87]
  v_mfma_f32_16x16x32_bf16 v[80:83], a[76:79], a[32:35], v[80:83]
  s_waitcnt lgkmcnt(4)
  v_mfma_f32_16x16x32_bf16 v[96:99], a[64:67], a[32:35], v[96:99]
  ds_read_b64_tr_b16 a[76:77], v12 offset:14336
  v_mfma_f32_16x16x32_bf16 v[100:103], a[64:67], a[36:39], v[100:103]
  ds_read_b64_tr_b16 a[78:79], v12 offset:17920
  v_mfma_f32_16x16x32_bf16 v[104:107], a[64:67], a[40:43], v[104:107]
  buffer_load_dwordx4 a[20:23], v9, s[8:11], s25 offen offset:1024 sc1
  v_mfma_f32_16x16x32_bf16 v[108:111], a[64:67], a[44:47], v[108:111]
  s_waitcnt lgkmcnt(4)
  v_mfma_f32_16x16x32_bf16 v[124:127], a[68:71], a[44:47], v[124:127]
  ds_read_b64_tr_b16 a[64:65], v12 offset:14368
  v_mfma_f32_16x16x32_bf16 v[120:123], a[68:71], a[40:43], v[120:123]
  ds_read_b64_tr_b16 a[66:67], v12 offset:17952
  v_mfma_f32_16x16x32_bf16 v[116:119], a[68:71], a[36:39], v[116:119]
  v_mfma_f32_16x16x32_bf16 v[112:115], a[68:71], a[32:35], v[112:115]
  s_waitcnt lgkmcnt(4)
  v_mfma_f32_16x16x32_bf16 v[128:131], a[72:75], a[32:35], v[128:131]
  ds_read_b64_tr_b16 a[68:69], v12 offset:14400
  v_mfma_f32_16x16x32_bf16 v[132:135], a[72:75], a[36:39], v[132:135]
  ds_read_b64_tr_b16 a[70:71], v12 offset:17984
  v_mfma_f32_16x16x32_bf16 v[136:139], a[72:75], a[40:43], v[136:139]
  buffer_load_dwordx4 v3, s[4:7], s24 offen offset:1024 lds
  v_mfma_f32_16x16x32_bf16 v[140:143], a[72:75], a[44:47], v[140:143]
  s_waitcnt lgkmcnt(4)
  v_mfma_f32_16x16x32_bf16 v[156:159], a[76:79], a[44:47], v[156:159]
  ds_read_b64_tr_b16 a[72:73], v12 offset:14432
  v_mfma_f32_16x16x32_bf16 v[152:155], a[76:79], a[40:43], v[152:155]
  ds_read_b64_tr_b16 a[74:75], v12 offset:18016
  v_mfma_f32_16x16x32_bf16 v[148:151], a[76:79], a[36:39], v[148:151]
  v_mfma_f32_16x16x32_bf16 v[144:147], a[76:79], a[32:35], v[144:147]
  s_waitcnt lgkmcnt(4)
  buffer_load_dwordx4 a[24:27], v9, s[8:11], s25 offen offset:2048 sc1
  v_mfma_f32_16x16x32_bf16 v[160:163], a[64:67], a[32:35], v[160:163]
  ds_read_b64_tr_b16 a[76:77], v12 offset:14464
  v_mfma_f32_16x16x32_bf16 v[164:167], a[64:67], a[36:39], v[164:167]
  ds_read_b64_tr_b16 a[78:79], v12 offset:18048
  v_mfma_f32_16x16x32_bf16 v[168:171], a[64:67], a[40:43], v[168:171]
  v_mfma_f32_16x16x32_bf16 v[172:175], a[64:67], a[44:47], v[172:175]
  s_waitcnt lgkmcnt(4)
  v_mfma_f32_16x16x32_bf16 v[188:191], a[68:71], a[44:47], v[188:191]
  ds_read_b64_tr_b16 a[64:65], v12 offset:14496
  v_mfma_f32_16x16x32_bf16 v[184:187], a[68:71], a[40:43], v[184:187]
  ds_read_b64_tr_b16 a[66:67], v12 offset:18080
  v_mfma_f32_16x16x32_bf16 v[180:183], a[68:71], a[36:39], v[180:183]
  v_mfma_f32_16x16x32_bf16 v[176:179], a[68:71], a[32:35], v[176:179]
  s_waitcnt lgkmcnt(4)
  buffer_load_dwordx4 v4, s[4:7], s24 offen offset:2048 lds
  v_mfma_f32_16x16x32_bf16 v[192:195], a[72:75], a[32:35], v[192:195]
  ds_read_b64_tr_b16 a[68:69], v15 offset:14528
  v_mfma_f32_16x16x32_bf16 v[196:199], a[72:75], a[36:39], v[196:199]
  ds_read_b64_tr_b16 a[70:71], v15 offset:18112
  v_mfma_f32_16x16x32_bf16 v[200:203], a[72:75], a[40:43], v[200:203]
  v_mfma_f32_16x16x32_bf16 v[204:207], a[72:75], a[44:47], v[204:207]
  s_waitcnt lgkmcnt(4)
  v_mfma_f32_16x16x32_bf16 v[220:223], a[76:79], a[44:47], v[220:223]
  ds_read_b64_tr_b16 a[72:73], v12 offset:7168
  v_mfma_f32_16x16x32_bf16 v[216:219], a[76:79], a[40:43], v[216:219]
  ds_read_b64_tr_b16 a[74:75], v12 offset:10752
  v_mfma_f32_16x16x32_bf16 v[212:215], a[76:79], a[36:39], v[212:215]
  buffer_load_dwordx4 a[28:31], v9, s[8:11], s25 offen offset:3072 sc1
  s_add_u32 s25, s25, 131072
  v_mfma_f32_16x16x32_bf16 v[208:211], a[76:79], a[32:35], v[208:211]
  s_waitcnt lgkmcnt(4)
  v_mfma_f32_16x16x32_bf16 v[224:227], a[64:67], a[32:35], v[224:227]
  ds_read_b64_tr_b16 a[76:77], v12 offset:7200
  v_mfma_f32_16x16x32_bf16 v[228:231], a[64:67], a[36:39], v[228:231]
  ds_read_b64_tr_b16 a[78:79], v12 offset:10784
  v_mfma_f32_16x16x32_bf16 v[232:235], a[64:67], a[40:43], v[232:235]
  v_mfma_f32_16x16x32_bf16 v[236:239], a[64:67], a[44:47], v[236:239]
  s_waitcnt lgkmcnt(4)
  v_mfma_f32_16x16x32_bf16 v[252:255], a[68:71], a[44:47], v[252:255]
  ds_read_b64_tr_b16 a[64:65], v12 offset:7232
  v_mfma_f32_16x16x32_bf16 v[248:251], a[68:71], a[40:43], v[248:251]
  ds_read_b64_tr_b16 a[66:67], v12 offset:10816
  v_mfma_f32_16x16x32_bf16 v[244:247], a[68:71], a[36:39], v[244:247]
  buffer_load_dwordx4 v5, s[4:7], s24 offen offset:3072 lds
  v_mfma_f32_16x16x32_bf16 v[240:243], a[68:71], a[32:35], v[240:243]
  s_waitcnt vmcnt(16) lgkmcnt(4)
  v_add_u32 v14, s27, v13
  v_mfma_f32_16x16x32_bf16 v[32:35], a[72:75], a[48:51], v[32:35]
  ds_read_b64_tr_b16 a[68:69], v12 offset:7264
  v_mfma_f32_16x16x32_bf16 v[36:39], a[72:75], a[52:55], v[36:39]
  ds_read_b64_tr_b16 a[70:71], v12 offset:10848
  v_mfma_f32_16x16x32_bf16 v[40:43], a[72:75], a[56:59], v[40:43]
  v_mfma_f32_16x16x32_bf16 v[44:47], a[72:75], a[60:63], v[44:47]
  s_waitcnt lgkmcnt(4)
  buffer_load_dwordx4 a[32:35], v9, s[8:11], s25 offen offset:0 sc1
  v_mfma_f32_16x16x32_bf16 v[60:63], a[76:79], a[60:63], v[60:63]
  ds_read_b64_tr_b16 a[72:73], v12 offset:7296
  v_mfma_f32_16x16x32_bf16 v[56:59], a[76:79], a[56:59], v[56:59]
  ds_read_b64_tr_b16 a[74:75], v12 offset:10880
  v_mfma_f32_16x16x32_bf16 v[52:55], a[76:79], a[52:55], v[52:55]
  v_mfma_f32_16x16x32_bf16 v[48:51], a[76:79], a[48:51], v[48:51]
  s_waitcnt lgkmcnt(4)
  v_mfma_f32_16x16x32_bf16 v[64:67], a[64:67], a[48:51], v[64:67]
  ds_read_b64_tr_b16 a[76:77], v12 offset:7328
  v_mfma_f32_16x16x32_bf16 v[68:71], a[64:67], a[52:55], v[68:71]
  ds_read_b64_tr_b16 a[78:79], v12 offset:10912
  v_mfma_f32_16x16x32_bf16 v[72:75], a[64:67], a[56:59], v[72:75]
  s_add_u32 m0, s26, 4096
  v_mfma_f32_16x16x32_bf16 v[76:79], a[64:67], a[60:63], v[76:79]
  s_waitcnt lgkmcnt(4)
  buffer_load_dwordx4 v6, s[4:7], s24 offen lds
  v_mfma_f32_16x16x32_bf16 v[92:95], a[68:71], a[60:63], v[92:95]
  ds_read_b64_tr_b16 a[64:65], v15 offset:7360
  v_mfma_f32_16x16x32_bf16 v[88:91], a[68:71], a[56:59], v[88:91]
  ds_read_b64_tr_b16 a[66:67], v15 offset:10944
  v_mfma_f32_16x16x32_bf16 v[84:87], a[68:71], a[52:55], v[84:87]
  v_mfma_f32_16x16x32_bf16 v[80:83], a[68:71], a[48:51], v[80:83]
  s_waitcnt lgkmcnt(4)
  v_mfma_f32_16x16x32_bf16 v[96:99], a[72:75], a[48:51], v[96:99]
  ds_read_b64_tr_b16 a[68:69], v12 offset:21504
  v_mfma_f32_16x16x32_bf16 v[100:103], a[72:75], a[52:55], v[100:103]
  ds_read_b64_tr_b16 a[70:71], v12 offset:25088
  v_mfma_f32_16x16x32_bf16 v[104:107], a[72:75], a[56:59], v[104:107]
  buffer_load_dwordx4 a[36:39], v9, s[8:11], s25 offen offset:1024 sc1
  v_mfma_f32_16x16x32_bf16 v[108:111], a[72:75], a[60:63], v[108:111]
  s_waitcnt lgkmcnt(4)
  v_mfma_f32_16x16x32_bf16 v[124:127], a[76:79], a[60:63], v[124:127]
  ds_read_b64_tr_b16 a[72:73], v12 offset:21536
  v_mfma_f32_16x16x32_bf16 v[120:123], a[76:79], a[56:59], v[120:123]
  ds_read_b64_tr_b16 a[74:75], v12 offset:25120
  v_mfma_f32_16x16x32_bf16 v[116:119], a[76:79], a[52:55], v[116:119]
  v_mfma_f32_16x16x32_bf16 v[112:115], a[76:79], a[48:51], v[112:115]
  s_waitcnt lgkmcnt(4)
  v_mfma_f32_16x16x32_bf16 v[128:131], a[64:67], a[48:51], v[128:131]
  ds_read_b64_tr_b16 a[76:77], v12 offset:21568
  v_mfma_f32_16x16x32_bf16 v[132:135], a[64:67], a[52:55], v[132:135]
  ds_read_b64_tr_b16 a[78:79], v12 offset:25152
  v_mfma_f32_16x16x32_bf16 v[136:139], a[64:67], a[56:59], v[136:139]
  buffer_load_dwordx4 v7, s[4:7], s24 offen offset:1024 lds
  v_mfma_f32_16x16x32_bf16 v[140:143], a[64:67], a[60:63], v[140:143]
  s_waitcnt lgkmcnt(4)
  v_mfma_f32_16x16x32_bf16 v[156:159], a[68:71], a[60:63], v[156:159]
  ds_read_b64_tr_b16 a[64:65], v12 offset:21600
  v_mfma_f32_16x16x32_bf16 v[152:155], a[68:71], a[56:59], v[152:155]
  ds_read_b64_tr_b16 a[66:67], v12 offset:25184
  v_mfma_f32_16x16x32_bf16 v[148:151], a[68:71], a[52:55], v[148:151]
  v_mfma_f32_16x16x32_bf16 v[144:147], a[68:71], a[48:51], v[144:147]
  s_waitcnt lgkmcnt(4)
  v_mfma_f32_16x16x32_bf16 v[160:163], a[72:75], a[48:51], v[160:163]
  ds_read_b64_tr_b16 a[68:69], v12 offset:21632
  v_mfma_f32_16x16x32_bf16 v[164:167], a[72:75], a[52:55], v[164:167]
  ds_read_b64_tr_b16 a[70:71], v12 offset:25216
  v_mfma_f32_16x16x32_bf16 v[168:171], a[72:75], a[56:59], v[168:171]
  buffer_load_dwordx4 a[40:43], v9, s[8:11], s25 offen offset:2048 sc1
  v_mfma_f32_16x16x32_bf16 v[172:175], a[72:75], a[60:63], v[172:175]
  s_waitcnt lgkmcnt(4)
  v_mfma_f32_16x16x32_bf16 v[188:191], a[76:79], a[60:63], v[188:191]
  ds_read_b64_tr_b16 a[72:73], v12 offset:21664
  v_mfma_f32_16x16x32_bf16 v[184:187], a[76:79], a[56:59], v[184:187]
  ds_read_b64_tr_b16 a[74:75], v12 offset:25248
  v_mfma_f32_16x16x32_bf16 v[180:183], a[76:79], a[52:55], v[180:183]
  v_mfma_f32_16x16x32_bf16 v[176:179], a[76:79], a[48:51], v[176:179]
  s_waitcnt lgkmcnt(4)
  buffer_load_dwordx4 a[44:47], v9, s[8:11], s25 offen offset:3072 sc1
  s_add_u32 s25, s25, 131072
  v_mfma_f32_16x16x32_bf16 v[192:195], a[64:67], a[48:51], v[192:195]
  ds_read_b64_tr_b16 a[76:77], v15 offset:21696
  v_mfma_f32_16x16x32_bf16 v[196:199], a[64:67], a[52:55], v[196:199]
  ds_read_b64_tr_b16 a[78:79], v15 offset:25280
  v_mfma_f32_16x16x32_bf16 v[200:203], a[64:67], a[56:59], v[200:203]
  v_mfma_f32_16x16x32_bf16 v[204:207], a[64:67], a[60:63], v[204:207]
  s_waitcnt vmcnt(29) lgkmcnt(4)
  s_barrier
  v_mfma_f32_16x16x32_bf16 v[220:223], a[68:71], a[60:63], v[220:223]
  ds_read_b64_tr_b16 a[64:65], v11 offset:0
  v_mfma_f32_16x16x32_bf16 v[216:219], a[68:71], a[56:59], v[216:219]
  ds_read_b64_tr_b16 a[66:67], v11 offset:3584
  v_mfma_f32_16x16x32_bf16 v[212:215], a[68:71], a[52:55], v[212:215]
  v_mfma_f32_16x16x32_bf16 v[208:211], a[68:71], a[48:51], v[208:211]
  s_waitcnt lgkmcnt(4)
  buffer_load_dwordx4 v8, s[4:7], s24 offen offset:2048 lds
  s_add_u32 s24, s24, 458752
  v_mfma_f32_16x16x32_bf16 v[224:227], a[72:75], a[48:51], v[224:227]
  s_add_u32 s26, s26, 28672
  ds_read_b64_tr_b16 a[68:69], v11 offset:32
  v_mfma_f32_16x16x32_bf16 v[228:231], a[72:75], a[52:55], v[228:231]
  s_cmp_ge_u32 s26, s29
  ds_read_b64_tr_b16 a[70:71], v11 offset:3616
  s_cselect_b32 s26, s23, s26
  v_mfma_f32_16x16x32_bf16 v[232:235], a[72:75], a[56:59], v[232:235]
  v_mfma_f32_16x16x32_bf16 v[236:239], a[72:75], a[60:63], v[236:239]
  s_waitcnt lgkmcnt(4)
  v_mfma_f32_16x16x32_bf16 v[252:255], a[76:79], a[60:63], v[252:255]
  ds_read_b64_tr_b16 a[72:73], v11 offset:64
  v_mfma_f32_16x16x32_bf16 v[248:251], a[76:79], a[56:59], v[248:251]
  ds_read_b64_tr_b16 a[74:75], v11 offset:3648
  v_mfma_f32_16x16x32_bf16 v[244:247], a[76:79], a[52:55], v[244:247]
  v_mfma_f32_16x16x32_bf16 v[240:243], a[76:79], a[48:51], v[240:243]
  s_waitcnt vmcnt(16) lgkmcnt(4)
  s_cmp_lg_u32 s28, 0
  s_cbranch_scc1 L_k4_loop
L_c4:
  s_add_u32 s27, s27, 28672
  s_cmp_ge_u32 s27, 143360
  s_cselect_b32 s27, 0, s27
  v_add_u32 v12, s27, v10
  v_add_u32 v15, s27, v13
  s_waitcnt vmcnt(15)
  s_barrier
  v_mfma_f32_16x16x32_bf16 v[32:35], a[64:67], a[0:3], v[32:35]
  ds_read_b64_tr_b16 a[76:77], v11 offset:14336
  v_mfma_f32_16x16x32_bf16 v[36:39], a[64:67], a[4:7], v[36:39]
  ds_read_b64_tr_b16 a[78:79], v11 offset:17920
  v_mfma_f32_16x16x32_bf16 v[40:43], a[64:67], a[8:11], v[40:43]
  s_and_b32 s30, s2, 7
  s_lshr_b32 s31, s2, 3
  v_mfma_f32_16x16x32_bf16 v[44:47], a[64:67], a[12:15], v[44:47]
  s_waitcnt lgkmcnt(4)
  s_and_b32 s82, s30, 1
  s_lshr_b32 s30, s30, 1
  v_mfma_f32_16x16x32_bf16 v[60:63], a[68:71], a[12:15], v[60:63]
  ds_read_b64_tr_b16 a[64:65], v11 offset:14368
  s_lshl_b32 s30, s30, 2
  s_and_b32 s32, s31, 3
  v_mfma_f32_16x16x32_bf16 v[56:59], a[68:71], a[8:11], v[56:59]
  ds_read_b64_tr_b16 a[66:67], v11 offset:17952
  s_add_u32 s21, s30, s32
  s_lshr_b32 s22, s31, 2
  v_mfma_f32_16x16x32_bf16 v[52:55], a[68:71], a[4:7], v[52:55]
  v_bfe_u32 v28, v1, 4, 2
  v_bfe_u32 v29, v1, 1, 2
  v_mfma_f32_16x16x32_bf16 v[48:51], a[68:71], a[0:3], v[48:51]
  s_waitcnt lgkmcnt(4)
  v_xor_b32 v28, v28, v29
  v_and_b32 v29, 1, v1
  v_mfma_f32_16x16x32_bf16 v[64:67], a[72:75], a[0:3], v[64:67]
  ds_read_b64_tr_b16 a[68:69], v11 offset:7168
  v_lshlrev_b32 v29, 4, v29
  v_mfma_f32_16x16x32_bf16 v[68:71], a[72:75], a[4:7], v[68:71]
  ds_read_b64_tr_b16 a[70:71], v11 offset:10752
  v_lshl_add_u32 v27, v28, 5, v29
  s_lshl_b32 s83, s22, 1
  s_add_u32 s83, s83, s82
  v_mfma_f32_16x16x32_bf16 v[72:75], a[72:75], a[8:11], v[72:75]
  s_lshl_b32 s30, s20, 5
  v_mfma_f32_16x16x32_bf16 v[76:79], a[72:75], a[12:15], v[76:79]
  s_waitcnt lgkmcnt(4)
  v_lshrrev_b32 v28, 3, v1
  v_add_u32 v28, s30, v28
  s_add_u32 s34, s62, 44040192
  s_addc_u32 s35, s63, 0
  v_mfma_f32_16x16x32_bf16 v[156:159], a[76:79], a[12:15], v[156:159]
  ds_read_b64_tr_b16 a[72:73], v11 offset:21504
  s_xor_b32 s33, s83, 1
  s_lshl_b32 s31, s33, 7
  v_mfma_f32_16x16x32_bf16 v[152:155], a[76:79], a[8:11], v[152:155]
  ds_read_b64_tr_b16 a[74:75], v11 offset:25088
  s_lshr_b32 s32, s33, 3
  s_mul_i32 s32, s32, 458752
  v_mfma_f32_16x16x32_bf16 v[148:151], a[76:79], a[4:7], v[148:151]
  s_and_b32 s33, s33, 7
  s_cmp_eq_u32 s33, 99
  v_mfma_f32_16x16x32_bf16 v[144:147], a[76:79], a[0:3], v[144:147]
  s_waitcnt lgkmcnt(4)
  s_cselect_b32 s4, s34, s76
  s_cselect_b32 s5, s35, s77
  v_mfma_f32_16x16x32_bf16 v[160:163], a[64:67], a[0:3], v[160:163]
  ds_read_b64_tr_b16 a[76:77], v11 offset:7200
  s_cselect_b32 s31, s32, s31
  s_cselect_b32 s33, 7, 11
  v_mfma_f32_16x16x32_bf16 v[164:167], a[64:67], a[4:7], v[164:167]
  ds_read_b64_tr_b16 a[78:79], v11 offset:10784
  s_add_u32 s4, s4, s31
  s_addc_u32 s5, s5, 0
  v_mfma_f32_16x16x32_bf16 v[168:171], a[64:67], a[8:11], v[168:171]
  s_mov_b32 s7, 0x20000
  s_lshl_b32 s3, 128, s33
  v_mfma_f32_16x16x32_bf16 v[172:175], a[64:67], a[12:15], v[172:175]
  s_waitcnt vmcnt(8) lgkmcnt(4)
  s_lshl_b32 s31, 1792, s33
  s_mul_i32 s24, s82, s31
  v_mfma_f32_16x16x32_bf16 v[44:47], a[68:71], a[28:31], v[44:47]
  ds_read_b64_tr_b16 a[64:65], v11 offset:21536
  s_add_u32 s6, s24, s31
  s_lshl_b32 s31, 8, s33
  v_mfma_f32_16x16x32_bf16 v[40:43], a[68:71], a[24:27], v[40:43]
  ds_read_b64_tr_b16 a[66:67], v11 offset:25120
  s_sub_u32 s31, s31, 1024
  v_mfma_f32_16x16x32_bf16 v[36:39], a[68:71], a[20:23], v[36:39]
  v_lshl_add_u32 v2, v28, s33, v27
  v_add_u32 v3, s31, v2
  v_mfma_f32_16x16x32_bf16 v[32:35], a[68:71], a[16:19], v[32:35]
  s_waitcnt lgkmcnt(4)
  v_add_u32 v4, s31, v3
  v_add_u32 v5, s31, v4
  s_xor_b32 s33, s83, 0
  s_lshl_b32 s31, s33, 7
  v_mfma_f32_16x16x32_bf16 v[144:147], a[72:75], a[16:19], v[144:147]
  ds_read_b64_tr_b16 a[68:69], v12 offset:0
  s_lshr_b32 s32, s33, 3
  s_mul_i32 s32, s32, 458752
  v_mfma_f32_16x16x32_bf16 v[148:151], a[72:75], a[20:23], v[148:151]
  ds_read_b64_tr_b16 a[70:71], v12 offset:3584
  s_and_b32 s33, s33, 7
  s_cmp_eq_u32 s33, 99
  v_mfma_f32_16x16x32_bf16 v[152:155], a[72:75], a[24:27], v[152:155]
  s_cselect_b32 s44, s34, s76
  s_cselect_b32 s45, s35, s77
  v_mfma_f32_16x16x32_bf16 v[156:159], a[72:75], a[28:31], v[156:159]
  s_waitcnt lgkmcnt(4)
  s_cselect_b32 s31, s32, s31
  s_cselect_b32 s33, 7, 11
  v_mfma_f32_16x16x32_bf16 v[60:63], a[76:79], a[28:31], v[60:63]
  ds_read_b64_tr_b16 a[72:73], v12 offset:14336
  s_add_u32 s44, s44, s31
  s_addc_u32 s45, s45, 0
  v_mfma_f32_16x16x32_bf16 v[56:59], a[76:79], a[24:27], v[56:59]
  ds_read_b64_tr_b16 a[74:75], v12 offset:17920
  s_mov_b32 s47, 0x20000
  s_lshl_b32 s80, 128, s33
  v_mfma_f32_16x16x32_bf16 v[52:55], a[76:79], a[20:23], v[52:55]
  s_lshl_b32 s31, 1792, s33
  s_mul_i32 s84, s82, s31
  v_mfma_f32_16x16x32_bf16 v[48:51], a[76:79], a[16:19], v[48:51]
  s_waitcnt lgkmcnt(4)
  s_add_u32 s46, s84, s31
  s_lshl_b32 s31, 8, s33
  v_mfma_f32_16x16x32_bf16 v[160:163], a[64:67], a[16:19], v[160:163]
  ds_read_b64_tr_b16 a[76:77], v12 offset:32
  s_sub_u32 s31, s31, 1024
  v_mfma_f32_16x16x32_bf16 v[164:167], a[64:67], a[20:23], v[164:167]
  ds_read_b64_tr_b16 a[78:79], v12 offset:3616
  v_lshl_add_u32 v6, v28, s33, v27
  v_mfma_f32_16x16x32_bf16 v[168:171], a[64:67], a[24:27], v[168:171]
  v_add_u32 v7, s31, v6
  v_add_u32 v8, s31, v7
  v_mfma_f32_16x16x32_bf16 v[172:175], a[64:67], a[28:31], v[172:175]
  s_waitcnt vmcnt(1) lgkmcnt(4)
  v_add_u32 v10, s31, v8
  s_lshl_b32 s23, s20, 12
  s_add_u32 s29, s23, 163840
  v_mfma_f32_16x16x32_bf16 v[44:47], a[68:71], a[44:47], v[44:47]
  ds_read_b64_tr_b16 a[64:65], v12 offset:14368
  s_add_u32 s26, s23, 32768
  s_waitcnt vmcnt(0)
  v_mfma_f32_16x16x32_bf16 v[40:43], a[68:71], a[40:43], v[40:43]
  ds_read_b64_tr_b16 a[66:67], v12 offset:17952
  s_barrier
  s_mov_b32 m0, s26
  v_mfma_f32_16x16x32_bf16 v[36:39], a[68:71], a[36:39], v[36:39]
  buffer_load_dwordx4 v2, s[4:7], s24 offen sc1 lds
  v_mfma_f32_16x16x32_bf16 v[32:35], a[68:71], a[32:35], v[32:35]
  s_waitcnt lgkmcnt(4)
  v_mfma_f32_16x16x32_bf16 v[144:147], a[72:75], a[32:35], v[144:147]
  ds_read_b64_tr_b16 a[68:69], v12 offset:7168
  s_add_u32 m0, s26, 16384
  v_mfma_f32_16x16x32_bf16 v[148:151], a[72:75], a[36:39], v[148:151]
  ds_read_b64_tr_b16 a[70:71], v12 offset:10752
  v_mfma_f32_16x16x32_bf16 v[152:155], a[72:75], a[40:43], v[152:155]
  buffer_load_dwordx4 v6, s[44:47], s84 offen sc1 lds
  v_mfma_f32_16x16x32_bf16 v[156:159], a[72:75], a[44:47], v[156:159]
  s_waitcnt lgkmcnt(4)
  v_mfma_f32_16x16x32_bf16 v[60:63], a[76:79], a[44:47], v[60:63]
  ds_read_b64_tr_b16 a[72:73], v12 offset:21504
  s_mov_b32 m0, s26
  v_mfma_f32_16x16x32_bf16 v[56:59], a[76:79], a[40:43], v[56:59]
  ds_read_b64_tr_b16 a[74:75], v12 offset:25088
  v_mfma_f32_16x16x32_bf16 v[52:55], a[76:79], a[36:39], v[52:55]
  buffer_load_dwordx4 v3, s[4:7], s24 offen offset:1024 sc1 lds
  v_mfma_f32_16x16x32_bf16 v[48:51], a[76:79], a[32:35], v[48:51]
  s_waitcnt lgkmcnt(4)
  v_mfma_f32_16x16x32_bf16 v[160:163], a[64:67], a[32:35], v[160:163]
  ds_read_b64_tr_b16 a[76:77], v12 offset:7200
  s_add_u32 m0, s26, 16384
  v_mfma_f32_16x16x32_bf16 v[164:167], a[64:67], a[36:39], v[164:167]
  ds_read_b64_tr_b16 a[78:79], v12 offset:10784
  v_mfma_f32_16x16x32_bf16 v[168:171], a[64:67], a[40:43], v[168:171]
  buffer_load_dwordx4 v7, s[44:47], s84 offen offset:1024 sc1 lds
  v_mfma_f32_16x16x32_bf16 v[172:175], a[64:67], a[44:47], v[172:175]
  s_waitcnt lgkmcnt(4)
  v_mfma_f32_16x16x32_bf16 v[44:47], a[68:71], a[92:95], v[44:47]
  ds_read_b64_tr_b16 a[64:65], v12 offset:21536
  s_mov_b32 m0, s26
  v_mfma_f32_16x16x32_bf16 v[40:43], a[68:71], a[88:91], v[40:43]
  ds_read_b64_tr_b16 a[66:67], v12 offset:25120
  v_mfma_f32_16x16x32_bf16 v[36:39], a[68:71], a[84:87], v[36:39]
  buffer_load_dwordx4 v4, s[4:7], s24 offen offset:2048 sc1 lds
  v_mfma_f32_16x16x32_bf16 v[32:35], a[68:71], a[80:83], v[32:35]
  s_waitcnt lgkmcnt(4)
  v_mfma_f32_16x16x32_bf16 v[144:147], a[72:75], a[80:83], v[144:147]
  ds_read_b64_tr_b16 a[68:69], v11 offset:14400
  s_add_u32 m0, s26, 16384
  v_mfma_f32_16x16x32_bf16 v[148:151], a[72:75], a[84:87], v[148:151]
  ds_read_b64_tr_b16 a[70:71], v11 offset:17984
  v_mfma_f32_16x16x32_bf16 v[152:155], a[72:75], a[88:91], v[152:155]
  buffer_load_dwordx4 v8, s[44:47], s84 offen offset:2048 sc1 lds
  v_mfma_f32_16x16x32_bf16 v[156:159], a[72:75], a[92:95], v[156:159]
  s_waitcnt lgkmcnt(4)
  v_mfma_f32_16x16x32_bf16 v[60:63], a[76:79], a[92:95], v[60:63]
  ds_read_b64_tr_b16 a[72:73], v11 offset:96
  s_mov_b32 m0, s26
  v_mfma_f32_16x16x32_bf16 v[56:59], a[76:79], a[88:91], v[56:59]
  ds_read_b64_tr_b16 a[74:75], v11 offset:3680
  v_mfma_f32_16x16x32_bf16 v[52:55], a[76:79], a[84:87], v[52:55]
  buffer_load_dwordx4 v5, s[4:7], s24 offen offset:3072 sc1 lds
  v_mfma_f32_16x16x32_bf16 v[48:51], a[76:79], a[80:83], v[48:51]
  s_waitcnt lgkmcnt(4)
  v_mfma_f32_16x16x32_bf16 v[160:163], a[64:67], a[80:83], v[160:163]
  ds_read_b64_tr_b16 a[76:77], v11 offset:14432
  s_add_u32 m0, s26, 16384
  v_mfma_f32_16x16x32_bf16 v[164:167], a[64:67], a[84:87], v[164:167]
  ds_read_b64_tr_b16 a[78:79], v11 offset:18016
  v_mfma_f32_16x16x32_bf16 v[168:171], a[64:67], a[88:91], v[168:171]
  buffer_load_dwordx4 v10, s[44:47], s84 offen offset:3072 sc1 lds
  v_mfma_f32_16x16x32_bf16 v[172:175], a[64:67], a[92:95], v[172:175]
  s_waitcnt lgkmcnt(4)
  v_mfma_f32_16x16x32_bf16 v[188:191], a[68:71], a[12:15], v[188:191]
  ds_read_b64_tr_b16 a[64:65], v11 offset:7232
  s_add_u32 s24, s24, s3
  s_add_u32 s84, s84, s80
  v_mfma_f32_16x16x32_bf16 v[184:187], a[68:71], a[8:11], v[184:187]
  ds_read_b64_tr_b16 a[66:67], v11 offset:10816
  s_add_u32 s26, s26, 32768
  s_cmp_ge_u32 s26, s29
  v_mfma_f32_16x16x32_bf16 v[180:183], a[68:71], a[4:7], v[180:183]
  s_cselect_b32 s26, s23, s26
  s_mov_b32 m0, s26
  v_mfma_f32_16x16x32_bf16 v[176:179], a[68:71], a[0:3], v[176:179]
  s_waitcnt lgkmcnt(4)
  buffer_load_dwordx4 v2, s[4:7], s24 offen sc1 lds
  v_mul_f32 v32, v32, v144
  v_mfma_f32_16x16x32_bf16 v[80:83], a[72:75], a[0:3], v[80:83]
  ds_read_b64_tr_b16 a[68:69], v11 offset:21568
  v_mul_f32 v33, v33, v145
  v_mfma_f32_16x16x32_bf16 v[84:87], a[72:75], a[4:7], v[84:87]
  ds_read_b64_tr_b16 a[70:71], v11 offset:25152
  s_add_u32 m0, s26, 16384
  v_mfma_f32_16x16x32_bf16 v[88:91], a[72:75], a[8:11], v[88:91]
  buffer_load_dwordx4 v6, s[44:47], s84 offen sc1 lds
  v_mul_f32 v34, v34, v146
  v_mfma_f32_16x16x32_bf16 v[92:95], a[72:75], a[12:15], v[92:95]
  s_waitcnt lgkmcnt(4)
  v_mul_f32 v35, v35, v147
  v_mul_f32 v48, v48, v160
  v_mfma_f32_16x16x32_bf16 v[204:207], a[76:79], a[12:15], v[204:207]
  ds_read_b64_tr_b16 a[72:73], v11 offset:7264
  s_mov_b32 m0, s26
  v_mfma_f32_16x16x32_bf16 v[200:203], a[76:79], a[8:11], v[200:203]
  ds_read_b64_tr_b16 a[74:75], v11 offset:10848
  v_mul_f32 v49, v49, v161
  v_mfma_f32_16x16x32_bf16 v[196:199], a[76:79], a[4:7], v[196:199]
  buffer_load_dwordx4 v3, s[4:7], s24 offen offset:1024 sc1 lds
  v_mul_f32 v50, v50, v162
  v_mfma_f32_16x16x32_bf16 v[192:195], a[76:79], a[0:3], v[192:195]
  s_waitcnt lgkmcnt(4)
  v_mul_f32 v51, v51, v163
  v_cvt_pk_bf16_f32 v16, v32, v33
  v_mfma_f32_16x16x32_bf16 v[64:67], a[64:67], a[16:19], v[64:67]
  ds_read_b64_tr_b16 a[76:77], v11 offset:21600
  s_add_u32 m0, s26, 16384
  v_mfma_f32_16x16x32_bf16 v[68:71], a[64:67], a[20:23], v[68:71]
  ds_read_b64_tr_b16 a[78:79], v11 offset:25184
  v_cvt_pk_bf16_f32 v17, v34, v35
  v_mfma_f32_16x16x32_bf16 v[72:75], a[64:67], a[24:27], v[72:75]
  buffer_load_dwordx4 v7, s[44:47], s84 offen offset:1024 sc1 lds
  v_cvt_pk_bf16_f32 v18, v48, v49
  v_mfma_f32_16x16x32_bf16 v[76:79], a[64:67], a[28:31], v[76:79]
  s_waitcnt lgkmcnt(4)
  v_cvt_pk_bf16_f32 v19, v50, v51
  v_mfma_f32_16x16x32_bf16 v[188:191], a[68:71], a[28:31], v[188:191]
  ds_read_b64_tr_b16 a[64:65], v12 offset:64
  s_mov_b32 m0, s26
  v_mfma_f32_16x16x32_bf16 v[184:187], a[68:71], a[24:27], v[184:187]
  ds_read_b64_tr_b16 a[66:67], v12 offset:3648
  v_mfma_f32_16x16x32_bf16 v[180:183], a[68:71], a[20:23], v[180:183]
  buffer_load_dwordx4 v4, s[4:7], s24 offen offset:2048 sc1 lds
  v_mfma_f32_16x16x32_bf16 v[176:179], a[68:71], a[16:19], v[176:179]
  s_waitcnt lgkmcnt(4)
  buffer_store_dwordx4 v[16:19], v9, s[12:15], s40 offen offset:0 sc1
  v_mfma_f32_16x16x32_bf16 v[80:83], a[72:75], a[16:19], v[80:83]
  ds_read_b64_tr_b16 a[68:69], v12 offset:14400
  s_add_u32 m0, s26, 16384
  v_mfma_f32_16x16x32_bf16 v[84:87], a[72:75], a[20:23], v[84:87]
  ds_read_b64_tr_b16 a[70:71], v12 offset:17984
  v_mul_f32 v36, v36, v148
  v_mfma_f32_16x16x32_bf16 v[88:91], a[72:75], a[24:27], v[88:91]
  buffer_load_dwordx4 v8, s[44:47], s84 offen offset:2048 sc1 lds
  v_mul_f32 v37, v37, v149
  v_mfma_f32_16x16x32_bf16 v[92:95], a[72:75], a[28:31], v[92:95]
  s_waitcnt lgkmcnt(4)
  v_mul_f32 v38, v38, v150
  v_mul_f32 v39, v39, v151
  v_mfma_f32_16x16x32_bf16 v[204:207], a[76:79], a[28:31], v[204:207]
  ds_read_b64_tr_b16 a[72:73], v12 offset:96
  s_mov_b32 m0, s26
  v_mfma_f32_16x16x32_bf16 v[200:203], a[76:79], a[24:27], v[200:203]
  ds_read_b64_tr_b16 a[74:75], v12 offset:3680
  v_mul_f32 v52, v52, v164
  v_mfma_f32_16x16x32_bf16 v[196:199], a[76:79], a[20:23], v[196:199]
  buffer_load_dwordx4 v5, s[4:7], s24 offen offset:3072 sc1 lds
  v_mul_f32 v53, v53, v165
  v_mfma_f32_16x16x32_bf16 v[192:195], a[76:79], a[16:19], v[192:195]
  s_waitcnt lgkmcnt(4)
  v_mul_f32 v54, v54, v166
  v_mul_f32 v55, v55, v167
  v_mfma_f32_16x16x32_bf16 v[64:67], a[64:67], a[32:35], v[64:67]
  ds_read_b64_tr_b16 a[76:77], v12 offset:14432
  s_add_u32 m0, s26, 16384
  v_mfma_f32_16x16x32_bf16 v[68:71], a[64:67], a[36:39], v[68:71]
  ds_read_b64_tr_b16 a[78:79], v12 offset:18016
  v_cvt_pk_bf16_f32 v20, v36, v37
  v_mfma_f32_16x16x32_bf16 v[72:75], a[64:67], a[40:43], v[72:75]
  buffer_load_dwordx4 v10, s[44:47], s84 offen offset:3072 sc1 lds
  v_cvt_pk_bf16_f32 v21, v38, v39
  v_mfma_f32_16x16x32_bf16 v[76:79], a[64:67], a[44:47], v[76:79]
  s_waitcnt lgkmcnt(4)
  v_cvt_pk_bf16_f32 v22, v52, v53
  v_cvt_pk_bf16_f32 v23, v54, v55
  v_mfma_f32_16x16x32_bf16 v[188:191], a[68:71], a[44:47], v[188:191]
  ds_read_b64_tr_b16 a[64:65], v12 offset:7232
  s_add_u32 s24, s24, s3
  s_add_u32 s84, s84, s80
  v_mfma_f32_16x16x32_bf16 v[184:187], a[68:71], a[40:43], v[184:187]
  ds_read_b64_tr_b16 a[66:67], v12 offset:10816
  s_add_u32 s26, s26, 32768
  s_cmp_ge_u32 s26, s29
  v_mfma_f32_16x16x32_bf16 v[180:183], a[68:71], a[36:39], v[180:183]
  s_cselect_b32 s26, s23, s26
  v_mfma_f32_16x16x32_bf16 v[176:179], a[68:71], a[32:35], v[176:179]
  s_waitcnt lgkmcnt(4)
  buffer_store_dwordx4 v[20:23], v9, s[12:15], s40 offen offset:1024 sc1
  v_mfma_f32_16x16x32_bf16 v[80:83], a[72:75], a[32:35], v[80:83]
  ds_read_b64_tr_b16 a[68:69], v12 offset:21568
  v_mul_f32 v40, v40, v152
  v_mfma_f32_16x16x32_bf16 v[84:87], a[72:75], a[36:39], v[84:87]
  ds_read_b64_tr_b16 a[70:71], v12 offset:25152
  v_mul_f32 v41, v41, v153
  v_mfma_f32_16x16x32_bf16 v[88:91], a[72:75], a[40:43], v[88:91]
  v_mul_f32 v42, v42, v154
  v_mul_f32 v43, v43, v155
  v_mfma_f32_16x16x32_bf16 v[92:95], a[72:75], a[44:47], v[92:95]
  s_waitcnt lgkmcnt(4)
  v_mul_f32 v56, v56, v168
  v_mul_f32 v57, v57, v169
  v_mfma_f32_16x16x32_bf16 v[204:207], a[76:79], a[44:47], v[204:207]
  ds_read_b64_tr_b16 a[72:73], v12 offset:7264
  v_mul_f32 v58, v58, v170
  v_mfma_f32_16x16x32_bf16 v[200:203], a[76:79], a[40:43], v[200:203]
  ds_read_b64_tr_b16 a[74:75], v12 offset:10848
  v_mul_f32 v59, v59, v171
  v_mfma_f32_16x16x32_bf16 v[196:199], a[76:79], a[36:39], v[196:199]
  v_cvt_pk_bf16_f32 v24, v40, v41
  v_cvt_pk_bf16_f32 v25, v42, v43
  v_mfma_f32_16x16x32_bf16 v[192:195], a[76:79], a[32:35], v[192:195]
  s_waitcnt lgkmcnt(4)
  v_cvt_pk_bf16_f32 v26, v56, v57
  v_cvt_pk_bf16_f32 v27, v58, v59
  v_mfma_f32_16x16x32_bf16 v[64:67], a[64:67], a[80:83], v[64:67]
  ds_read_b64_tr_b16 a[76:77], v12 offset:21600
  v_mfma_f32_16x16x32_bf16 v[68:71], a[64:67], a[84:87], v[68:71]
  ds_read_b64_tr_b16 a[78:79], v12 offset:25184
  v_mfma_f32_16x16x32_bf16 v[72:75], a[64:67], a[88:91], v[72:75]
  buffer_store_dwordx4 v[24:27], v9, s[12:15], s40 offen offset:2048 sc1
  v_mfma_f32_16x16x32_bf16 v[76:79], a[64:67], a[92:95], v[76:79]
  s_waitcnt lgkmcnt(4)
  v_mul_f32 v44, v44, v156
  v_mul_f32 v45, v45, v157
  v_mfma_f32_16x16x32_bf16 v[188:191], a[68:71], a[92:95], v[188:191]
  ds_read_b64_tr_b16 a[64:65], v11 offset:128
  v_mul_f32 v46, v46, v158
  v_mfma_f32_16x16x32_bf16 v[184:187], a[68:71], a[88:91], v[184:187]
  ds_read_b64_tr_b16 a[66:67], v11 offset:3712
  v_mul_f32 v47, v47, v159
  v_mfma_f32_16x16x32_bf16 v[180:183], a[68:71], a[84:87], v[180:183]
  v_mul_f32 v60, v60, v172
  v_mul_f32 v61, v61, v173
  v_mfma_f32_16x16x32_bf16 v[176:179], a[68:71], a[80:83], v[176:179]
  s_waitcnt lgkmcnt(4)
  v_mul_f32 v62, v62, v174
  v_mul_f32 v63, v63, v175
  v_mfma_f32_16x16x32_bf16 v[80:83], a[72:75], a[80:83], v[80:83]
  ds_read_b64_tr_b16 a[68:69], v11 offset:14464
  v_cvt_pk_bf16_f32 v28, v44, v45
  v_mfma_f32_16x16x32_bf16 v[84:87], a[72:75], a[84:87], v[84:87]
  ds_read_b64_tr_b16 a[70:71], v11 offset:18048
  v_cvt_pk_bf16_f32 v29, v46, v47
  v_mfma_f32_16x16x32_bf16 v[88:91], a[72:75], a[88:91], v[88:91]
  v_cvt_pk_bf16_f32 v30, v60, v61
  v_cvt_pk_bf16_f32 v31, v62, v63
  v_mfma_f32_16x16x32_bf16 v[92:95], a[72:75], a[92:95], v[92:95]
  s_waitcnt lgkmcnt(4)
  buffer_store_dwordx4 v[28:31], v9, s[12:15], s40 offen offset:3072 sc1
  v_mfma_f32_16x16x32_bf16 v[204:207], a[76:79], a[92:95], v[204:207]
  ds_read_b64_tr_b16 a[72:73], v11 offset:160
  v_mfma_f32_16x16x32_bf16 v[200:203], a[76:79], a[88:91], v[200:203]
  ds_read_b64_tr_b16 a[74:75], v11 offset:3744
  v_mfma_f32_16x16x32_bf16 v[196:199], a[76:79], a[84:87], v[196:199]
  v_mfma_f32_16x16x32_bf16 v[192:195], a[76:79], a[80:83], v[192:195]
  s_waitcnt lgkmcnt(4)
  v_mfma_f32_16x16x32_bf16 v[96:99], a[64:67], a[0:3], v[96:99]
  ds_read_b64_tr_b16 a[76:77], v11 offset:14496
  v_mfma_f32_16x16x32_bf16 v[100:103], a[64:67], a[4:7], v[100:103]
  ds_read_b64_tr_b16 a[78:79], v11 offset:18080
  v_mfma_f32_16x16x32_bf16 v[104:107], a[64:67], a[8:11], v[104:107]
  v_mul_f32 v64, v64, v176
  v_mul_f32 v65, v65, v177
  v_mfma_f32_16x16x32_bf16 v[108:111], a[64:67], a[12:15], v[108:111]
  s_waitcnt lgkmcnt(4)
  v_mul_f32 v66, v66, v178
  v_mul_f32 v67, v67, v179
  v_mfma_f32_16x16x32_bf16 v[220:223], a[68:71], a[12:15], v[220:223]
  ds_read_b64_tr_b16 a[64:65], v11 offset:7296
  v_mul_f32 v80, v80, v192
  v_mfma_f32_16x16x32_bf16 v[216:219], a[68:71], a[8:11], v[216:219]
  ds_read_b64_tr_b16 a[66:67], v11 offset:10880
  v_mul_f32 v81, v81, v193
  v_mfma_f32_16x16x32_bf16 v[212:215], a[68:71], a[4:7], v[212:215]
  v_mul_f32 v82, v82, v194
  v_mul_f32 v83, v83, v195
  v_mfma_f32_16x16x32_bf16 v[208:211], a[68:71], a[0:3], v[208:211]
  s_waitcnt lgkmcnt(4)
  v_cvt_pk_bf16_f32 v16, v64, v65
  v_cvt_pk_bf16_f32 v17, v66, v67
  v_mfma_f32_16x16x32_bf16 v[112:115], a[72:75], a[0:3], v[112:115]
  ds_read_b64_tr_b16 a[68:69], v11 offset:21632
  v_cvt_pk_bf16_f32 v18, v80, v81
  v_mfma_f32_16x16x32_bf16 v[116:119], a[72:75], a[4:7], v[116:119]
  ds_read_b64_tr_b16 a[70:71], v11 offset:25216
  v_cvt_pk_bf16_f32 v19, v82, v83
  v_mfma_f32_16x16x32_bf16 v[120:123], a[72:75], a[8:11], v[120:123]
  buffer_store_dwordx4 v[16:19], v9, s[12:15], s41 offen offset:0 sc1
  v_mfma_f32_16x16x32_bf16 v[124:127], a[72:75], a[12:15], v[124:127]
  s_waitcnt lgkmcnt(4)
  v_mul_f32 v68, v68, v180
  v_mul_f32 v69, v69, v181
  v_mfma_f32_16x16x32_bf16 v[236:239], a[76:79], a[12:15], v[236:239]
  ds_read_b64_tr_b16 a[72:73], v11 offset:7328
  v_mul_f32 v70, v70, v182
  v_mfma_f32_16x16x32_bf16 v[232:235], a[76:79], a[8:11], v[232:235]
  ds_read_b64_tr_b16 a[74:75], v11 offset:10912
  v_mul_f32 v71, v71, v183
  v_mfma_f32_16x16x32_bf16 v[228:231], a[76:79], a[4:7], v[228:231]
  v_mul_f32 v84, v84, v196
  v_mul_f32 v85, v85, v197
  v_mfma_f32_16x16x32_bf16 v[224:227], a[76:79], a[0:3], v[224:227]
  s_waitcnt lgkmcnt(4)
  v_mul_f32 v86, v86, v198
  v_mul_f32 v87, v87, v199
  v_mfma_f32_16x16x32_bf16 v[96:99], a[64:67], a[16:19], v[96:99]
  ds_read_b64_tr_b16 a[76:77], v11 offset:21664
  v_cvt_pk_bf16_f32 v20, v68, v69
  v_mfma_f32_16x16x32_bf16 v[100:103], a[64:67], a[20:23], v[100:103]
  ds_read_b64_tr_b16 a[78:79], v11 offset:25248
  v_cvt_pk_bf16_f32 v21, v70, v71
  v_mfma_f32_16x16x32_bf16 v[104:107], a[64:67], a[24:27], v[104:107]
  v_cvt_pk_bf16_f32 v22, v84, v85
  v_cvt_pk_bf16_f32 v23, v86, v87
  v_mfma_f32_16x16x32_bf16 v[108:111], a[64:67], a[28:31], v[108:111]
  s_waitcnt lgkmcnt(4)
  buffer_store_dwordx4 v[20:23], v9, s[12:15], s41 offen offset:1024 sc1
  v_mfma_f32_16x16x32_bf16 v[220:223], a[68:71], a[28:31], v[220:223]
  ds_read_b64_tr_b16 a[64:65], v12 offset:128
  v_mul_f32 v72, v72, v184
  v_mfma_f32_16x16x32_bf16 v[216:219], a[68:71], a[24:27], v[216:219]
  ds_read_b64_tr_b16 a[66:67], v12 offset:3712
  v_mul_f32 v73, v73, v185
  v_mfma_f32_16x16x32_bf16 v[212:215], a[68:71], a[20:23], v[212:215]
  v_mul_f32 v74, v74, v186
  v_mul_f32 v75, v75, v187
  v_mfma_f32_16x16x32_bf16 v[208:211], a[68:71], a[16:19], v[208:211]
  s_waitcnt lgkmcnt(4)
  v_mul_f32 v88, v88, v200
  v_mul_f32 v89, v89, v201
  v_mfma_f32_16x16x32_bf16 v[112:115], a[72:75], a[16:19], v[112:115]
  ds_read_b64_tr_b16 a[68:69], v12 offset:14464
  v_mul_f32 v90, v90, v202
  v_mfma_f32_16x16x32_bf16 v[116:119], a[72:75], a[20:23], v[116:119]
  ds_read_b64_tr_b16 a[70:71], v12 offset:18048
  v_mul_f32 v91, v91, v203
  v_mfma_f32_16x16x32_bf16 v[120:123], a[72:75], a[24:27], v[120:123]
  v_cvt_pk_bf16_f32 v24, v72, v73
  v_cvt_pk_bf16_f32 v25, v74, v75
  v_mfma_f32_16x16x32_bf16 v[124:127], a[72:75], a[28:31], v[124:127]
  s_waitcnt lgkmcnt(4)
  v_cvt_pk_bf16_f32 v26, v88, v89
  v_cvt_pk_bf16_f32 v27, v90, v91
  v_mfma_f32_16x16x32_bf16 v[236:239], a[76:79], a[28:31], v[236:239]
  ds_read_b64_tr_b16 a[72:73], v12 offset:160
  v_mfma_f32_16x16x32_bf16 v[232:235], a[76:79], a[24:27], v[232:235]
  ds_read_b64_tr_b16 a[74:75], v12 offset:3744
  v_mfma_f32_16x16x32_bf16 v[228:231], a[76:79], a[20:23], v[228:231]
  buffer_store_dwordx4 v[24:27], v9, s[12:15], s41 offen offset:2048 sc1
  v_mfma_f32_16x16x32_bf16 v[224:227], a[76:79], a[16:19], v[224:227]
  s_waitcnt lgkmcnt(4)
  v_mul_f32 v76, v76, v188
  v_mul_f32 v77, v77, v189
  v_mfma_f32_16x16x32_bf16 v[96:99], a[64:67], a[32:35], v[96:99]
  ds_read_b64_tr_b16 a[76:77], v12 offset:14496
  v_mul_f32 v78, v78, v190
  v_mfma_f32_16x16x32_bf16 v[100:103], a[64:67], a[36:39], v[100:103]
  ds_read_b64_tr_b16 a[78:79], v12 offset:18080
  v_mul_f32 v79, v79, v191
  v_mfma_f32_16x16x32_bf16 v[104:107], a[64:67], a[40:43], v[104:107]
  v_mul_f32 v92, v92, v204
  v_mul_f32 v93, v93, v205
  v_mfma_f32_16x16x32_bf16 v[108:111], a[64:67], a[44:47], v[108:111]
  s_waitcnt lgkmcnt(4)
  v_mul_f32 v94, v94, v206
  v_mul_f32 v95, v95, v207
  v_mfma_f32_16x16x32_bf16 v[220:223], a[68:71], a[44:47], v[220:223]
  ds_read_b64_tr_b16 a[64:65], v12 offset:7296
  v_cvt_pk_bf16_f32 v28, v76, v77
  v_mfma_f32_16x16x32_bf16 v[216:219], a[68:71], a[40:43], v[216:219]
  ds_read_b64_tr_b16 a[66:67], v12 offset:10880
  v_cvt_pk_bf16_f32 v29, v78, v79
  v_mfma_f32_16x16x32_bf16 v[212:215], a[68:71], a[36:39], v[212:215]
  v_cvt_pk_bf16_f32 v30, v92, v93
  v_cvt_pk_bf16_f32 v31, v94, v95
  v_mfma_f32_16x16x32_bf16 v[208:211], a[68:71], a[32:35], v[208:211]
  s_waitcnt lgkmcnt(4)
  buffer_store_dwordx4 v[28:31], v9, s[12:15], s41 offen offset:3072 sc1
  v_mfma_f32_16x16x32_bf16 v[112:115], a[72:75], a[32:35], v[112:115]
  ds_read_b64_tr_b16 a[68:69], v12 offset:21632
  v_mfma_f32_16x16x32_bf16 v[116:119], a[72:75], a[36:39], v[116:119]
  ds_read_b64_tr_b16 a[70:71], v12 offset:25216
  v_mfma_f32_16x16x32_bf16 v[120:123], a[72:75], a[40:43], v[120:123]
  v_mfma_f32_16x16x32_bf16 v[124:127], a[72:75], a[44:47], v[124:127]
  s_waitcnt lgkmcnt(4)
  v_mfma_f32_16x16x32_bf16 v[236:239], a[76:79], a[44:47], v[236:239]
  ds_read_b64_tr_b16 a[72:73], v12 offset:7328
  v_mfma_f32_16x16x32_bf16 v[232:235], a[76:79], a[40:43], v[232:235]
  ds_read_b64_tr_b16 a[74:75], v12 offset:10912
  v_mfma_f32_16x16x32_bf16 v[228:231], a[76:79], a[36:39], v[228:231]
  v_mfma_f32_16x16x32_bf16 v[224:227], a[76:79], a[32:35], v[224:227]
  s_waitcnt lgkmcnt(4)
  v_mfma_f32_16x16x32_bf16 v[96:99], a[64:67], a[80:83], v[96:99]
  ds_read_b64_tr_b16 a[76:77], v12 offset:21664
  v_mfma_f32_16x16x32_bf16 v[100:103], a[64:67], a[84:87], v[100:103]
  ds_read_b64_tr_b16 a[78:79], v12 offset:25248
  v_mfma_f32_16x16x32_bf16 v[104:107], a[64:67], a[88:91], v[104:107]
  v_mfma_f32_16x16x32_bf16 v[108:111], a[64:67], a[92:95], v[108:111]
  s_waitcnt lgkmcnt(4)
  v_mfma_f32_16x16x32_bf16 v[220:223], a[68:71], a[92:95], v[220:223]
  ds_read_b64_tr_b16 a[64:65], v14 offset:192
  v_mfma_f32_16x16x32_bf16 v[216:219], a[68:71], a[88:91], v[216:219]
  ds_read_b64_tr_b16 a[66:67], v14 offset:3776
  v_mfma_f32_16x16x32_bf16 v[212:215], a[68:71], a[84:87], v[212:215]
  v_mfma_f32_16x16x32_bf16 v[208:211], a[68:71], a[80:83], v[208:211]
  s_waitcnt lgkmcnt(4)
  v_mfma_f32_16x16x32_bf16 v[112:115], a[72:75], a[80:83], v[112:115]
  ds_read_b64_tr_b16 a[68:69], v14 offset:14528
  v_mfma_f32_16x16x32_bf16 v[116:119], a[72:75], a[84:87], v[116:119]
  ds_read_b64_tr_b16 a[70:71], v14 offset:18112
  v_mfma_f32_16x16x32_bf16 v[120:123], a[72:75], a[88:91], v[120:123]
  v_mfma_f32_16x16x32_bf16 v[124:127], a[72:75], a[92:95], v[124:127]
  s_waitcnt lgkmcnt(4)
  v_mfma_f32_16x16x32_bf16 v[236:239], a[76:79], a[92:95], v[236:239]
  ds_read_b64_tr_b16 a[72:73], v14 offset:7360
  v_mfma_f32_16x16x32_bf16 v[232:235], a[76:79], a[88:91], v[232:235]
  ds_read_b64_tr_b16 a[74:75], v14 offset:10944
  v_mfma_f32_16x16x32_bf16 v[228:231], a[76:79], a[84:87], v[228:231]
  v_mfma_f32_16x16x32_bf16 v[224:227], a[76:79], a[80:83], v[224:227]
  s_waitcnt lgkmcnt(4)
  v_mfma_f32_16x16x32_bf16 v[128:131], a[64:67], a[0:3], v[128:131]
  ds_read_b64_tr_b16 a[76:77], v14 offset:21696
  v_mfma_f32_16x16x32_bf16 v[132:135], a[64:67], a[4:7], v[132:135]
  ds_read_b64_tr_b16 a[78:79], v14 offset:25280
  v_mfma_f32_16x16x32_bf16 v[136:139], a[64:67], a[8:11], v[136:139]
  v_mul_f32 v96, v96, v208
  v_mul_f32 v97, v97, v209
  v_mfma_f32_16x16x32_bf16 v[140:143], a[64:67], a[12:15], v[140:143]
  s_waitcnt lgkmcnt(4)
  v_mul_f32 v98, v98, v210
  v_mul_f32 v99, v99, v211
  v_mfma_f32_16x16x32_bf16 v[252:255], a[68:71], a[12:15], v[252:255]
  ds_read_b64_tr_b16 a[64:65], v15 offset:192
  v_mul_f32 v112, v112, v224
  v_mfma_f32_16x16x32_bf16 v[248:251], a[68:71], a[8:11], v[248:251]
  ds_read_b64_tr_b16 a[66:67], v15 offset:3776
  v_mul_f32 v113, v113, v225
  v_mfma_f32_16x16x32_bf16 v[244:247], a[68:71], a[4:7], v[244:247]
  v_mul_f32 v114, v114, v226
  v_mul_f32 v115, v115, v227
  v_mfma_f32_16x16x32_bf16 v[240:243], a[68:71], a[0:3], v[240:243]
  s_waitcnt lgkmcnt(4)
  v_cvt_pk_bf16_f32 v16, v96, v97
  v_cvt_pk_bf16_f32 v17, v98, v99
  v_mfma_f32_16x16x32_bf16 v[128:131], a[72:75], a[16:19], v[128:131]
  ds_read_b64_tr_b16 a[68:69], v15 offset:14528
  v_cvt_pk_bf16_f32 v18, v112, v113
  v_mfma_f32_16x16x32_bf16 v[132:135], a[72:75], a[20:23], v[132:135]
  ds_read_b64_tr_b16 a[70:71], v15 offset:18112
  v_cvt_pk_bf16_f32 v19, v114, v115
  v_mfma_f32_16x16x32_bf16 v[136:139], a[72:75], a[24:27], v[136:139]
  buffer_store_dwordx4 v[16:19], v9, s[12:15], s42 offen offset:0 sc1
  v_mfma_f32_16x16x32_bf16 v[140:143], a[72:75], a[28:31], v[140:143]
  s_waitcnt lgkmcnt(4)
  v_mul_f32 v100, v100, v212
  v_mul_f32 v101, v101, v213
  v_mfma_f32_16x16x32_bf16 v[252:255], a[76:79], a[28:31], v[252:255]
  ds_read_b64_tr_b16 a[72:73], v15 offset:7360
  v_mul_f32 v102, v102, v214
  v_mfma_f32_16x16x32_bf16 v[248:251], a[76:79], a[24:27], v[248:251]
  ds_read_b64_tr_b16 a[74:75], v15 offset:10944
  v_mul_f32 v103, v103, v215
  v_mfma_f32_16x16x32_bf16 v[244:247], a[76:79], a[20:23], v[244:247]
  v_mul_f32 v116, v116, v228
  v_mul_f32 v117, v117, v229
  v_mfma_f32_16x16x32_bf16 v[240:243], a[76:79], a[16:19], v[240:243]
  s_waitcnt lgkmcnt(4)
  v_mul_f32 v118, v118, v230
  v_mul_f32 v119, v119, v231
  v_mfma_f32_16x16x32_bf16 v[128:131], a[64:67], a[32:35], v[128:131]
  ds_read_b64_tr_b16 a[76:77], v15 offset:21696
  v_cvt_pk_bf16_f32 v20, v100, v101
  v_mfma_f32_16x16x32_bf16 v[132:135], a[64:67], a[36:39], v[132:135]
  ds_read_b64_tr_b16 a[78:79], v15 offset:25280
  v_cvt_pk_bf16_f32 v21, v102, v103
  v_mfma_f32_16x16x32_bf16 v[136:139], a[64:67], a[40:43], v[136:139]
  v_cvt_pk_bf16_f32 v22, v116, v117
  v_cvt_pk_bf16_f32 v23, v118, v119
  v_mfma_f32_16x16x32_bf16 v[140:143], a[64:67], a[44:47], v[140:143]
  s_waitcnt lgkmcnt(4)
  buffer_store_dwordx4 v[20:23], v9, s[12:15], s42 offen offset:1024 sc1
  v_mfma_f32_16x16x32_bf16 v[252:255], a[68:71], a[44:47], v[252:255]
  v_mul_f32 v104, v104, v216
  v_mul_f32 v105, v105, v217
  v_mfma_f32_16x16x32_bf16 v[248:251], a[68:71], a[40:43], v[248:251]
  v_mul_f32 v106, v106, v218
  v_mul_f32 v107, v107, v219
  v_mfma_f32_16x16x32_bf16 v[244:247], a[68:71], a[36:39], v[244:247]
  v_mul_f32 v120, v120, v232
  v_mul_f32 v121, v121, v233
  v_mfma_f32_16x16x32_bf16 v[240:243], a[68:71], a[32:35], v[240:243]
  s_waitcnt lgkmcnt(2)
  v_mul_f32 v122, v122, v234
  v_mul_f32 v123, v123, v235
  v_mfma_f32_16x16x32_bf16 v[128:131], a[72:75], a[80:83], v[128:131]
  v_cvt_pk_bf16_f32 v24, v104, v105
  v_cvt_pk_bf16_f32 v25, v106, v107
  v_mfma_f32_16x16x32_bf16 v[132:135], a[72:75], a[84:87], v[132:135]
  v_cvt_pk_bf16_f32 v26, v120, v121
  v_cvt_pk_bf16_f32 v27, v122, v123
  v_mfma_f32_16x16x32_bf16 v[136:139], a[72:75], a[88:91], v[136:139]
  buffer_store_dwordx4 v[24:27], v9, s[12:15], s42 offen offset:2048 sc1
  v_mfma_f32_16x16x32_bf16 v[140:143], a[72:75], a[92:95], v[140:143]
  s_waitcnt lgkmcnt(0)
  v_mul_f32 v108, v108, v220
  v_mul_f32 v109, v109, v221
  v_mfma_f32_16x16x32_bf16 v[252:255], a[76:79], a[92:95], v[252:255]
  v_mul_f32 v110, v110, v222
  v_mul_f32 v111, v111, v223
  v_mfma_f32_16x16x32_bf16 v[248:251], a[76:79], a[88:91], v[248:251]
  v_mul_f32 v124, v124, v236
  v_mul_f32 v125, v125, v237
  v_mfma_f32_16x16x32_bf16 v[244:247], a[76:79], a[84:87], v[244:247]
  v_mul_f32 v126, v126, v238
  v_mul_f32 v127, v127, v239
  v_mfma_f32_16x16x32_bf16 v[240:243], a[76:79], a[80:83], v[240:243]
  v_cvt_pk_bf16_f32 v28, v108, v109
  v_cvt_pk_bf16_f32 v29, v110, v111
  v_cvt_pk_bf16_f32 v30, v124, v125
  v_cvt_pk_bf16_f32 v31, v126, v127
  buffer_store_dwordx4 v[28:31], v9, s[12:15], s42 offen offset:3072 sc1
  v_and_b32 v13, 15, v1
  v_lshlrev_b32 v13, 4, v13
  v_bfe_u32 v32, v1, 4, 1
  v_lshl_add_u32 v13, v32, 10, v13
  v_lshrrev_b32 v32, 5, v1
  v_lshl_add_u32 v13, v32, 8, v13
  v_mul_f32 v128, v128, v240
  v_mul_f32 v129, v129, v241
  v_mul_f32 v130, v130, v242
  v_mul_f32 v131, v131, v243
  v_mul_f32 v132, v132, v244
  v_mul_f32 v133, v133, v245
  v_mul_f32 v134, v134, v246
  v_mul_f32 v135, v135, v247
  v_cvt_pk_bf16_f32 v16, v128, v129
  v_cvt_pk_bf16_f32 v17, v130, v131
  v_cvt_pk_bf16_f32 v18, v132, v133
  v_cvt_pk_bf16_f32 v19, v134, v135
  s_nop 0
  v_permlane16_swap_b32 v16, v18
  v_permlane16_swap_b32 v17, v19
  buffer_store_dwordx4 v[16:19], v13, s[12:15], s43 offen offset:0 sc1
  v_mul_f32 v136, v136, v248
  v_mul_f32 v137, v137, v249
  v_mul_f32 v138, v138, v250
  v_mul_f32 v139, v139, v251
  v_mul_f32 v140, v140, v252
  v_mul_f32 v141, v141, v253
  v_mul_f32 v142, v142, v254
  v_mul_f32 v143, v143, v255
  v_cvt_pk_bf16_f32 v20, v136, v137
  v_cvt_pk_bf16_f32 v21, v138, v139
  v_cvt_pk_bf16_f32 v22, v140, v141
  v_cvt_pk_bf16_f32 v23, v142, v143
  s_nop 0
  v_permlane16_swap_b32 v20, v22
  v_permlane16_swap_b32 v21, v23
  buffer_store_dwordx4 v[20:23], v13, s[12:15], s43 offen offset:2048 sc1
  s_add_u32 s8, s62, 25165824
  s_addc_u32 s9, s63, 0
  s_mov_b32 s10, 14680064
  s_mov_b32 s11, 0x20000
  s_lshl_b32 s38, s21, 13
  s_lshl_b32 s30, s20, 11
  s_add_u32 s38, s38, s30
  s_mul_i32 s25, s82, 7340032
  s_add_u32 s25, s25, s38
  s_mov_b32 s27, 32768
  v_lshrrev_b32 v28, 2, v1
  v_lshlrev_b32 v29, 7, v28
  v_and_b32 v30, 3, v1
  v_lshl_add_u32 v29, v30, 3, v29
  v_bfe_u32 v28, v28, 1, 2
  v_xor_b32 v30, 0, v28
  v_lshl_add_u32 v12, v30, 5, v29
  v_mov_b32 v16, v12
  v_xor_b32 v30, 1, v28
  v_lshl_add_u32 v13, v30, 5, v29
  v_mov_b32 v17, v13
  v_xor_b32 v30, 2, v28
  v_lshl_add_u32 v14, v30, 5, v29
  v_mov_b32 v18, v14
  v_xor_b32 v30, 3, v28
  v_lshl_add_u32 v15, v30, 5, v29
  v_mov_b32 v19, v15
  v_add_u32 v16, 32768, v12
  v_add_u32 v17, 32768, v13
  v_add_u32 v18, 32768, v14
  v_add_u32 v19, 32768, v15
  s_add_u32 s12, s62, 41943040
  s_addc_u32 s13, s63, 0
  s_mov_b32 s14, 360448
  s_mov_b32 s15, 0x20000
  s_mov_b32 s16, s78
  s_mov_b32 s17, s79
  s_mov_b32 s18, 4194304
  s_mov_b32 s19, 0x20000
  s_add_u32 s48, s62, 20971520
  s_addc_u32 s49, s63, 0
  s_mov_b32 s50, 4194304
  s_mov_b32 s51, 0x20000
  s_add_u32 s52, s62, 46137344
  s_addc_u32 s53, s63, 0
  s_mov_b32 s54, 4194304
  s_mov_b32 s55, 0x20000
  s_lshl_b32 s39, s21, 7
  s_lshl_b32 s30, s20, 5
  s_add_u32 s39, s39, s30
  v_and_b32 v24, 15, v1
  v_lshrrev_b32 v25, 4, v1
  v_lshlrev_b32 v26, 2, v24
  s_lshl_b32 s35, s39, 2
  s_lshl_b32 s36, s83, 18
  s_add_u32 s36, s36, s38
  s_add_u32 s37, s36, 131072
  s_add_u32 s34, s35, 8192
  v_lshl_add_u32 v27, v25, 15, v26
  s_lshl_b32 s40, s21, 4
  s_add_u32 s40, s40, s83
  s_xor_b32 s41, s40, 1
  s_lshl_b32 s40, s40, 14
  s_lshl_b32 s41, s41, 14
  s_lshl_b32 s30, s20, 12
  s_add_u32 s40, s40, s30
  s_add_u32 s41, s41, s30
  s_and_b32 s42, s21, 14
  s_add_u32 s42, s42, s82
  s_add_u32 s30, s85, 32
  s_lshl_b32 s30, s30, 8
  v_mov_b32 v30, s30
  v_mov_b32 v31, 1
  s_waitcnt vmcnt(0) lgkmcnt(0)
  s_barrier
  s_cmp_lg_u32 s20, 0
  s_cbranch_scc1 L_sig_p4
  s_mov_b64 exec, 1
  global_atomic_add v30, v31, s[58:59] sc1
  s_mov_b64 exec, -1
L_sig_p4:
  s_add_u32 s30, s42, 32
  s_lshl_b32 s30, s30, 8
  v_mov_b32 v30, s30
  v_mov_b32 v29, 0
  s_cmp_lg_u32 s20, 0
  s_cbranch_scc1 L_np_p5
  s_mov_b64 exec, 1
  global_atomic_add v31, v30, v29, s[58:59] sc0 sc1
  s_mov_b64 exec, -1
L_np_p5:
  s_mov_b32 m0, s26
  s_nop 0
  buffer_load_dwordx4 v2, s[4:7], s24 offen sc1 lds
  s_add_u32 m0, s26, 16384
  s_nop 0
  buffer_load_dwordx4 v6, s[44:47], s84 offen sc1 lds
  s_mov_b32 m0, s26
  s_nop 0
  buffer_load_dwordx4 v3, s[4:7], s24 offen offset:1024 sc1 lds
  s_add_u32 m0, s26, 16384
  s_nop 0
  buffer_load_dwordx4 v7, s[44:47], s84 offen offset:1024 sc1 lds
  s_mov_b32 m0, s26
  s_nop 0
  buffer_load_dwordx4 v4, s[4:7], s24 offen offset:2048 sc1 lds
  s_add_u32 m0, s26, 16384
  s_nop 0
  buffer_load_dwordx4 v8, s[44:47], s84 offen offset:2048 sc1 lds
  s_mov_b32 m0, s26
  s_nop 0
  buffer_load_dwordx4 v5, s[4:7], s24 offen offset:3072 sc1 lds
  s_add_u32 m0, s26, 16384
  s_nop 0
  buffer_load_dwordx4 v10, s[44:47], s84 offen offset:3072 sc1 lds
  s_add_u32 s24, s24, s3
  s_add_u32 s84, s84, s80
  s_add_u32 s26, s26, 32768
  s_cmp_ge_u32 s26, s29
  s_cselect_b32 s26, s23, s26
  v_mov_b32 v64, 0
  v_mov_b32 v65, 0
  v_mov_b32 v66, 0
  v_mov_b32 v67, 0
  v_mov_b32 v68, 0
  v_mov_b32 v69, 0
  v_mov_b32 v70, 0
  v_mov_b32 v71, 0
  v_mov_b32 v72, 0
  v_mov_b32 v73, 0
  v_mov_b32 v74, 0
  v_mov_b32 v75, 0
  v_mov_b32 v76, 0
  v_mov_b32 v77, 0
  v_mov_b32 v78, 0
  v_mov_b32 v79, 0
  v_mov_b32 v80, 0
  v_mov_b32 v81, 0
  v_mov_b32 v82, 0
  v_mov_b32 v83, 0
  v_mov_b32 v84, 0
  v_mov_b32 v85, 0
  v_mov_b32 v86, 0
  v_mov_b32 v87, 0
  v_mov_b32 v88, 0
  v_mov_b32 v89, 0
  v_mov_b32 v90, 0
  v_mov_b32 v91, 0
  v_mov_b32 v92, 0
  v_mov_b32 v93, 0
  v_mov_b32 v94, 0
  v_mov_b32 v95, 0
  v_mov_b32 v96, 0
  v_mov_b32 v97, 0
  v_mov_b32 v98, 0
  v_mov_b32 v99, 0
  v_mov_b32 v100, 0
  v_mov_b32 v101, 0
  v_mov_b32 v102, 0
  v_mov_b32 v103, 0
  v_mov_b32 v104, 0
  v_mov_b32 v105, 0
  v_mov_b32 v106, 0
  v_mov_b32 v107, 0
  v_mov_b32 v108, 0
  v_mov_b32 v109, 0
  v_mov_b32 v110, 0
  v_mov_b32 v111, 0
  v_mov_b32 v112, 0
  v_mov_b32 v113, 0
  v_mov_b32 v114, 0
  v_mov_b32 v115, 0
  v_mov_b32 v116, 0
  v_mov_b32 v117, 0
  v_mov_b32 v118, 0
  v_mov_b32 v119, 0
  v_mov_b32 v120, 0
  v_mov_b32 v121, 0
  v_mov_b32 v122, 0
  v_mov_b32 v123, 0
  v_mov_b32 v124, 0
  v_mov_b32 v125, 0
  v_mov_b32 v126, 0
  v_mov_b32 v127, 0
  s_cmp_lg_u32 s20, 0
  s_cbranch_scc1 L_go_p5
  s_mov_b32 s31, 0x40000
  s_waitcnt vmcnt(8)
L_poll_p5:
  v_readfirstlane_b32 s30, v31
  s_sub_u32 s31, s31, 1
  s_nop 0
  s_cselect_b32 s30, 16, s30
  s_cmp_ge_u32 s30, 16
  s_cbranch_scc1 L_go_p5
  s_sleep 2
  s_mov_b64 exec, 1
  global_atomic_add v31, v30, v29, s[58:59] sc0 sc1
  s_mov_b64 exec, -1
  s_waitcnt vmcnt(0)
  s_branch L_poll_p5
L_go_p5:
  s_barrier
  buffer_load_dwordx4 a[0:3], v9, s[8:11], s25 offen offset:0 sc1
  buffer_load_dwordx4 a[4:7], v9, s[8:11], s25 offen offset:1024 sc1
  s_add_u32 s25, s25, 131072
  buffer_load_dwordx4 a[8:11], v9, s[8:11], s25 offen offset:0 sc1
  buffer_load_dwordx4 a[12:15], v9, s[8:11], s25 offen offset:1024 sc1
  s_add_u32 s25, s25, 131072
  buffer_load_dwordx4 a[16:19], v9, s[8:11], s25 offen offset:0 sc1
  buffer_load_dwordx4 a[20:23], v9, s[8:11], s25 offen offset:1024 sc1
  s_add_u32 s25, s25, 131072
  buffer_load_dwordx4 a[24:27], v9, s[8:11], s25 offen offset:0 sc1
  buffer_load_dwordx4 a[28:31], v9, s[8:11], s25 offen offset:1024 sc1
  s_add_u32 s25, s25, 131072
  buffer_load_dwordx4 a[32:35], v9, s[8:11], s25 offen offset:0 sc1
  buffer_load_dwordx4 a[36:39], v9, s[8:11], s25 offen offset:1024 sc1
  s_add_u32 s25, s25, 131072
  buffer_load_dwordx4 a[40:43], v9, s[8:11], s25 offen offset:0 sc1
  buffer_load_dwordx4 a[44:47], v9, s[8:11], s25 offen offset:1024 sc1
  s_add_u32 s25, s25, 131072
  buffer_load_dwordx4 a[48:51], v9, s[8:11], s25 offen offset:0 sc1
  buffer_load_dwordx4 a[52:55], v9, s[8:11], s25 offen offset:1024 sc1
  s_add_u32 s25, s25, 131072
  s_sub_u32 s25, s25, 917504
  s_add_u32 s30, s25, 7208960
  buffer_load_dwordx4 a[96:99], v9, s[8:11], s30 offen offset:0 sc1
  buffer_load_dwordx4 a[100:103], v9, s[8:11], s30 offen offset:1024 sc1
  s_add_u32 s25, s25, 917504
  v_lshlrev_b32 v11, 11, v24
  v_and_b32 v28, 1, v25
  v_lshl_add_u32 v11, v28, 5, v11
  v_lshrrev_b32 v28, 1, v25
  v_lshl_add_u32 v11, v28, 4, v11
  s_lshl_b32 s32, s39, 11
  s_lshl_b32 s30, s83, 7
  s_add_u32 s32, s32, s30
  s_add_u32 s33, s32, 32768
  s_waitcnt vmcnt(14)
  s_barrier
  ds_read_b64_tr_b16 a[64:65], v16 offset:0
  ds_read_b64_tr_b16 a[66:67], v16 offset:2048
  ds_read_b64_tr_b16 a[68:69], v17 offset:0
  ds_read_b64_tr_b16 a[70:71], v17 offset:2048
  ds_read_b64_tr_b16 a[72:73], v18 offset:0
  ds_read_b64_tr_b16 a[74:75], v18 offset:2048
  ds_read_b64_tr_b16 a[76:77], v19 offset:0
  ds_read_b64_tr_b16 a[78:79], v19 offset:2048
  ds_read_b64_tr_b16 a[80:81], v16 offset:16384
  ds_read_b64_tr_b16 a[82:83], v16 offset:18432
  ds_read_b64_tr_b16 a[84:85], v17 offset:16384
  ds_read_b64_tr_b16 a[86:87], v17 offset:18432
  ds_read_b64_tr_b16 a[88:89], v18 offset:16384
  ds_read_b64_tr_b16 a[90:91], v18 offset:18432
  s_mov_b32 s28, 6
  s_waitcnt lgkmcnt(10)
.p2align 5
L_k5_loop:
  v_mfma_f32_16x16x32_bf16 v[64:67], a[64:67], a[0:3], v[64:67]
  s_add_u32 s27, s27, 32768
  ds_read_b64_tr_b16 a[92:93], v19 offset:16384
  v_mfma_f32_16x16x32_bf16 v[68:71], a[64:67], a[4:7], v[68:71]
  s_cmp_ge_u32 s27, 163840
  ds_read_b64_tr_b16 a[94:95], v19 offset:18432
  s_cselect_b32 s27, 0, s27
  v_mfma_f32_16x16x32_bf16 v[76:79], a[68:71], a[4:7], v[76:79]
  ds_read_b64_tr_b16 a[64:65], v16 offset:4096
  v_mfma_f32_16x16x32_bf16 v[72:75], a[68:71], a[0:3], v[72:75]
  s_waitcnt lgkmcnt(9)
  ds_read_b64_tr_b16 a[66:67], v16 offset:6144
  buffer_load_dwordx4 a[56:59], v9, s[8:11], s25 offen offset:0 sc1
  v_mfma_f32_16x16x32_bf16 v[80:83], a[72:75], a[0:3], v[80:83]
  ds_read_b64_tr_b16 a[68:69], v17 offset:4096
  v_mfma_f32_16x16x32_bf16 v[84:87], a[72:75], a[4:7], v[84:87]
  ds_read_b64_tr_b16 a[70:71], v17 offset:6144
  v_mfma_f32_16x16x32_bf16 v[92:95], a[76:79], a[4:7], v[92:95]
  s_mov_b32 m0, s26
  ds_read_b64_tr_b16 a[72:73], v18 offset:4096
  v_add_u32 v20, s27, v12
  v_mfma_f32_16x16x32_bf16 v[88:91], a[76:79], a[0:3], v[88:91]
  s_waitcnt lgkmcnt(9)
  ds_read_b64_tr_b16 a[74:75], v18 offset:6144
  buffer_load_dwordx4 v2, s[4:7], s24 offen sc1 lds
  v_mfma_f32_16x16x32_bf16 v[96:99], a[80:83], a[0:3], v[96:99]
  ds_read_b64_tr_b16 a[76:77], v19 offset:4096
  v_mfma_f32_16x16x32_bf16 v[100:103], a[80:83], a[4:7], v[100:103]
  ds_read_b64_tr_b16 a[78:79], v19 offset:6144
  v_mfma_f32_16x16x32_bf16 v[108:111], a[84:87], a[4:7], v[108:111]
  ds_read_b64_tr_b16 a[80:81], v16 offset:20480
  buffer_load_dwordx4 a[60:63], v9, s[8:11], s25 offen offset:1024 sc1
  s_add_u32 s25, s25, 131072
  v_mfma_f32_16x16x32_bf16 v[104:107], a[84:87], a[0:3], v[104:107]
  s_waitcnt lgkmcnt(9)
  ds_read_b64_tr_b16 a[82:83], v16 offset:22528
  v_mfma_f32_16x16x32_bf16 v[112:115], a[88:91], a[0:3], v[112:115]
  ds_read_b64_tr_b16 a[84:85], v17 offset:20480
  v_mfma_f32_16x16x32_bf16 v[116:119], a[88:91], a[4:7], v[116:119]
  s_add_u32 m0, s26, 16384
  ds_read_b64_tr_b16 a[86:87], v17 offset:22528
  v_mfma_f32_16x16x32_bf16 v[124:127], a[92:95], a[4:7], v[124:127]
  ds_read_b64_tr_b16 a[88:89], v18 offset:20480
  buffer_load_dwordx4 v6, s[44:47], s84 offen sc1 lds
  v_mfma_f32_16x16x32_bf16 v[120:123], a[92:95], a[0:3], v[120:123]
  s_waitcnt vmcnt(16) lgkmcnt(9)
  ds_read_b64_tr_b16 a[90:91], v18 offset:22528
  v_mfma_f32_16x16x32_bf16 v[64:67], a[64:67], a[8:11], v[64:67]
  ds_read_b64_tr_b16 a[92:93], v19 offset:20480
  v_add_u32 v21, s27, v13
  v_mfma_f32_16x16x32_bf16 v[68:71], a[64:67], a[12:15], v[68:71]
  ds_read_b64_tr_b16 a[94:95], v19 offset:22528
  v_mfma_f32_16x16x32_bf16 v[76:79], a[68:71], a[12:15], v[76:79]
  ds_read_b64_tr_b16 a[64:65], v16 offset:8192
  buffer_load_dwordx4 a[0:3], v9, s[8:11], s25 offen offset:0 sc1
  v_mfma_f32_16x16x32_bf16 v[72:75], a[68:71], a[8:11], v[72:75]
  s_waitcnt lgkmcnt(9)
  ds_read_b64_tr_b16 a[66:67], v16 offset:10240
  v_mfma_f32_16x16x32_bf16 v[80:83], a[72:75], a[8:11], v[80:83]
  ds_read_b64_tr_b16 a[68:69], v17 offset:8192
  v_mfma_f32_16x16x32_bf16 v[84:87], a[72:75], a[12:15], v[84:87]
  s_mov_b32 m0, s26
  ds_read_b64_tr_b16 a[70:71], v17 offset:10240
  v_mfma_f32_16x16x32_bf16 v[92:95], a[76:79], a[12:15], v[92:95]
  ds_read_b64_tr_b16 a[72:73], v18 offset:8192
  buffer_load_dwordx4 v3, s[4:7], s24 offen offset:1024 sc1 lds
  v_mfma_f32_16x16x32_bf16 v[88:91], a[76:79], a[8:11], v[88:91]
  s_waitcnt lgkmcnt(9)
  ds_read_b64_tr_b16 a[74:75], v18 offset:10240
  v_mfma_f32_16x16x32_bf16 v[96:99], a[80:83], a[8:11], v[96:99]
  ds_read_b64_tr_b16 a[76:77], v19 offset:8192
  v_mfma_f32_16x16x32_bf16 v[100:103], a[80:83], a[12:15], v[100:103]
  ds_read_b64_tr_b16 a[78:79], v19 offset:10240
  v_mfma_f32_16x16x32_bf16 v[108:111], a[84:87], a[12:15], v[108:111]
  ds_read_b64_tr_b16 a[80:81], v16 offset:24576
  buffer_load_dwordx4 a[4:7], v9, s[8:11], s25 offen offset:1024 sc1
  s_add_u32 s25, s25, 131072
  v_mfma_f32_16x16x32_bf16 v[104:107], a[84:87], a[8:11], v[104:107]
  s_waitcnt lgkmcnt(9)
  ds_read_b64_tr_b16 a[82:83], v16 offset:26624
  v_add_u32 v22, s27, v14
  v_mfma_f32_16x16x32_bf16 v[112:115], a[88:91], a[8:11], v[112:115]
  ds_read_b64_tr_b16 a[84:85], v17 offset:24576
  v_mfma_f32_16x16x32_bf16 v[116:119], a[88:91], a[12:15], v[116:119]
  s_add_u32 m0, s26, 16384
  ds_read_b64_tr_b16 a[86:87], v17 offset:26624
  v_mfma_f32_16x16x32_bf16 v[124:127], a[92:95], a[12:15], v[124:127]
  ds_read_b64_tr_b16 a[88:89], v18 offset:24576
  buffer_load_dwordx4 v7, s[44:47], s84 offen offset:1024 sc1 lds
  v_mfma_f32_16x16x32_bf16 v[120:123], a[92:95], a[8:11], v[120:123]
  s_waitcnt vmcnt(18) lgkmcnt(9)
  ds_read_b64_tr_b16 a[90:91], v18 offset:26624
  v_mfma_f32_16x16x32_bf16 v[64:67], a[64:67], a[16:19], v[64:67]
  ds_read_b64_tr_b16 a[92:93], v19 offset:24576
  v_mfma_f32_16x16x32_bf16 v[68:71], a[64:67], a[20:23], v[68:71]
  ds_read_b64_tr_b16 a[94:95], v19 offset:26624
  v_mfma_f32_16x16x32_bf16 v[76:79], a[68:71], a[20:23], v[76:79]
  ds_read_b64_tr_b16 a[64:65], v16 offset:12288
  buffer_load_dwordx4 a[8:11], v9, s[8:11], s25 offen offset:0 sc1
  v_mfma_f32_16x16x32_bf16 v[72:75], a[68:71], a[16:19], v[72:75]
  s_waitcnt lgkmcnt(9)
  ds_read_b64_tr_b16 a[66:67], v16 offset:14336
  v_mfma_f32_16x16x32_bf16 v[80:83], a[72:75], a[16:19], v[80:83]
  ds_read_b64_tr_b16 a[68:69], v17 offset:12288
  v_mfma_f32_16x16x32_bf16 v[84:87], a[72:75], a[20:23], v[84:87]
  s_mov_b32 m0, s26
  ds_read_b64_tr_b16 a[70:71], v17 offset:14336
  v_add_u32 v23, s27, v15
  v_mfma_f32_16x16x32_bf16 v[92:95], a[76:79], a[20:23], v[92:95]
  ds_read_b64_tr_b16 a[72:73], v18 offset:12288
  buffer_load_dwordx4 v4, s[4:7], s24 offen offset:2048 sc1 lds
  v_mfma_f32_16x16x32_bf16 v[88:91], a[76:79], a[16:19], v[88:91]
  s_waitcnt lgkmcnt(9)
  ds_read_b64_tr_b16 a[74:75], v18 offset:14336
  v_mfma_f32_16x16x32_bf16 v[96:99], a[80:83], a[16:19], v[96:99]
  ds_read_b64_tr_b16 a[76:77], v19 offset:12288
  v_mfma_f32_16x16x32_bf16 v[100:103], a[80:83], a[20:23], v[100:103]
  ds_read_b64_tr_b16 a[78:79], v19 offset:14336
  v_mfma_f32_16x16x32_bf16 v[108:111], a[84:87], a[20:23], v[108:111]
  ds_read_b64_tr_b16 a[80:81], v16 offset:28672
  buffer_load_dwordx4 a[12:15], v9, s[8:11], s25 offen offset:1024 sc1
  s_add_u32 s25, s25, 131072
  v_mfma_f32_16x16x32_bf16 v[104:107], a[84:87], a[16:19], v[104:107]
  s_waitcnt lgkmcnt(9)
  ds_read_b64_tr_b16 a[82:83], v16 offset:30720
  v_mfma_f32_16x16x32_bf16 v[112:115], a[88:91], a[16:19], v[112:115]
  ds_read_b64_tr_b16 a[84:85], v17 offset:28672
  v_mfma_f32_16x16x32_bf16 v[116:119], a[88:91], a[20:23], v[116:119]
  s_add_u32 m0, s26, 16384
  ds_read_b64_tr_b16 a[86:87], v17 offset:30720
  v_mfma_f32_16x16x32_bf16 v[124:127], a[92:95], a[20:23], v[124:127]
  ds_read_b64_tr_b16 a[88:89], v18 offset:28672
  buffer_load_dwordx4 v8, s[44:47], s84 offen offset:2048 sc1 lds
  v_mfma_f32_16x16x32_bf16 v[120:123], a[92:95], a[16:19], v[120:123]
  s_waitcnt vmcnt(20) lgkmcnt(9)
  ds_read_b64_tr_b16 a[90:91], v18 offset:30720
  v_mfma_f32_16x16x32_bf16 v[64:67], a[64:67], a[24:27], v[64:67]
  ds_read_b64_tr_b16 a[92:93], v19 offset:28672
  v_mfma_f32_16x16x32_bf16 v[68:71], a[64:67], a[28:31], v[68:71]
  s_waitcnt vmcnt(28)
  ds_read_b64_tr_b16 a[94:95], v19 offset:30720
  s_barrier
  v_mfma_f32_16x16x32_bf16 v[76:79], a[68:71], a[28:31], v[76:79]
  ds_read_b64_tr_b16 a[64:65], v20 offset:0
  buffer_load_dwordx4 a[16:19], v9, s[8:11], s25 offen offset:0 sc1
  v_mfma_f32_16x16x32_bf16 v[72:75], a[68:71], a[24:27], v[72:75]
  s_waitcnt lgkmcnt(9)
  ds_read_b64_tr_b16 a[66:67], v20 offset:2048
  s_mov_b32 m0, s26
  v_mfma_f32_16x16x32_bf16 v[80:83], a[72:75], a[24:27], v[80:83]
  ds_read_b64_tr_b16 a[68:69], v21 offset:0
  buffer_load_dwordx4 v5, s[4:7], s24 offen offset:3072 sc1 lds
  v_mfma_f32_16x16x32_bf16 v[84:87], a[72:75], a[28:31], v[84:87]
  ds_read_b64_tr_b16 a[70:71], v21 offset:2048
  v_mfma_f32_16x16x32_bf16 v[92:95], a[76:79], a[28:31], v[92:95]
  ds_read_b64_tr_b16 a[72:73], v22 offset:0
  v_mfma_f32_16x16x32_bf16 v[88:91], a[76:79], a[24:27], v[88:91]
  s_waitcnt lgkmcnt(9)
  ds_read_b64_tr_b16 a[74:75], v22 offset:2048
  buffer_load_dwordx4 a[20:23], v9, s[8:11], s25 offen offset:1024 sc1
  v_mfma_f32_16x16x32_bf16 v[96:99], a[80:83], a[24:27], v[96:99]
  s_add_u32 s25, s25, 131072
  ds_read_b64_tr_b16 a[76:77], v23 offset:0
  v_mfma_f32_16x16x32_bf16 v[100:103], a[80:83], a[28:31], v[100:103]
  s_add_u32 m0, s26, 16384
  ds_read_b64_tr_b16 a[78:79], v23 offset:2048
  v_mfma_f32_16x16x32_bf16 v[108:111], a[84:87], a[28:31], v[108:111]
  ds_read_b64_tr_b16 a[80:81], v20 offset:16384
  buffer_load_dwordx4 v10, s[44:47], s84 offen offset:3072 sc1 lds
  s_add_u32 s24, s24, s3
  v_mfma_f32_16x16x32_bf16 v[104:107], a[84:87], a[24:27], v[104:107]
  s_waitcnt lgkmcnt(9)
  ds_read_b64_tr_b16 a[82:83], v20 offset:18432
  s_add_u32 s84, s84, s80
  v_mfma_f32_16x16x32_bf16 v[112:115], a[88:91], a[24:27], v[112:115]
  s_add_u32 s26, s26, 32768
  ds_read_b64_tr_b16 a[84:85], v21 offset:16384
  v_mfma_f32_16x16x32_bf16 v[116:119], a[88:91], a[28:31], v[116:119]
  s_cmp_ge_u32 s26, s29
  ds_read_b64_tr_b16 a[86:87], v21 offset:18432
  s_cselect_b32 s26, s23, s26
  v_mfma_f32_16x16x32_bf16 v[124:127], a[92:95], a[28:31], v[124:127]
  ds_read_b64_tr_b16 a[88:89], v22 offset:16384
  v_mfma_f32_16x16x32_bf16 v[120:123], a[92:95], a[24:27], v[120:123]
  s_waitcnt vmcnt(22) lgkmcnt(9)
  ds_read_b64_tr_b16 a[90:91], v22 offset:18432
  v_mfma_f32_16x16x32_bf16 v[64:67], a[64:67], a[32:35], v[64:67]
  s_add_u32 s27, s27, 32768
  ds_read_b64_tr_b16 a[92:93], v23 offset:16384
  s_sub_u32 s28, s28, 1
  v_mfma_f32_16x16x32_bf16 v[68:71], a[64:67], a[36:39], v[68:71]
  s_cmp_ge_u32 s27, 163840
  ds_read_b64_tr_b16 a[94:95], v23 offset:18432
  s_cselect_b32 s27, 0, s27
  v_mfma_f32_16x16x32_bf16 v[76:79], a[68:71], a[36:39], v[76:79]
  ds_read_b64_tr_b16 a[64:65], v20 offset:4096
  v_mfma_f32_16x16x32_bf16 v[72:75], a[68:71], a[32:35], v[72:75]
  s_waitcnt lgkmcnt(9)
  ds_read_b64_tr_b16 a[66:67], v20 offset:6144
  buffer_load_dwordx4 a[24:27], v9, s[8:11], s25 offen offset:0 sc1
  v_mfma_f32_16x16x32_bf16 v[80:83], a[72:75], a[32:35], v[80:83]
  ds_read_b64_tr_b16 a[68:69], v21 offset:4096
  v_mfma_f32_16x16x32_bf16 v[84:87], a[72:75], a[36:39], v[84:87]
  ds_read_b64_tr_b16 a[70:71], v21 offset:6144
  v_mfma_f32_16x16x32_bf16 v[92:95], a[76:79], a[36:39], v[92:95]
  s_mov_b32 m0, s26
  ds_read_b64_tr_b16 a[72:73], v22 offset:4096
  v_add_u32 v16, s27, v12
  v_mfma_f32_16x16x32_bf16 v[88:91], a[76:79], a[32:35], v[88:91]
  s_waitcnt lgkmcnt(9)
  ds_read_b64_tr_b16 a[74:75], v22 offset:6144
  buffer_load_dwordx4 v2, s[4:7], s24 offen sc1 lds
  v_mfma_f32_16x16x32_bf16 v[96:99], a[80:83], a[32:35], v[96:99]
  ds_read_b64_tr_b16 a[76:77], v23 offset:4096
  v_mfma_f32_16x16x32_bf16 v[100:103], a[80:83], a[36:39], v[100:103]
  ds_read_b64_tr_b16 a[78:79], v23 offset:6144
  v_mfma_f32_16x16x32_bf16 v[108:111], a[84:87], a[36:39], v[108:111]
  ds_read_b64_tr_b16 a[80:81], v20 offset:20480
  buffer_load_dwordx4 a[28:31], v9, s[8:11], s25 offen offset:1024 sc1
  s_add_u32 s25, s25, 131072
  v_mfma_f32_16x16x32_bf16 v[104:107], a[84:87], a[32:35], v[104:107]
  s_waitcnt lgkmcnt(9)
  ds_read_b64_tr_b16 a[82:83], v20 offset:22528
  v_mfma_f32_16x16x32_bf16 v[112:115], a[88:91], a[32:35], v[112:115]
  ds_read_b64_tr_b16 a[84:85], v21 offset:20480
  v_mfma_f32_16x16x32_bf16 v[116:119], a[88:91], a[36:39], v[116:119]
  s_add_u32 m0, s26, 16384
  ds_read_b64_tr_b16 a[86:87], v21 offset:22528
  v_mfma_f32_16x16x32_bf16 v[124:127], a[92:95], a[36:39], v[124:127]
  ds_read_b64_tr_b16 a[88:89], v22 offset:20480
  buffer_load_dwordx4 v6, s[44:47], s84 offen sc1 lds
  v_mfma_f32_16x16x32_bf16 v[120:123], a[92:95], a[32:35], v[120:123]
  s_waitcnt vmcnt(24) lgkmcnt(9)
  ds_read_b64_tr_b16 a[90:91], v22 offset:22528
  v_mfma_f32_16x16x32_bf16 v[64:67], a[64:67], a[40:43], v[64:67]
  ds_read_b64_tr_b16 a[92:93], v23 offset:20480
  v_add_u32 v17, s27, v13
  v_mfma_f32_16x16x32_bf16 v[68:71], a[64:67], a[44:47], v[68:71]
  ds_read_b64_tr_b16 a[94:95], v23 offset:22528
  v_mfma_f32_16x16x32_bf16 v[76:79], a[68:71], a[44:47], v[76:79]
  ds_read_b64_tr_b16 a[64:65], v20 offset:8192
  buffer_load_dwordx4 a[32:35], v9, s[8:11], s25 offen offset:0 sc1
  v_mfma_f32_16x16x32_bf16 v[72:75], a[68:71], a[40:43], v[72:75]
  s_waitcnt lgkmcnt(9)
  ds_read_b64_tr_b16 a[66:67], v20 offset:10240
  v_mfma_f32_16x16x32_bf16 v[80:83], a[72:75], a[40:43], v[80:83]
  ds_read_b64_tr_b16 a[68:69], v21 offset:8192
  v_mfma_f32_16x16x32_bf16 v[84:87], a[72:75], a[44:47], v[84:87]
  s_mov_b32 m0, s26
  ds_read_b64_tr_b16 a[70:71], v21 offset:10240
  v_mfma_f32_16x16x32_bf16 v[92:95], a[76:79], a[44:47], v[92:95]
  ds_read_b64_tr_b16 a[72:73], v22 offset:8192
  buffer_load_dwordx4 v3, s[4:7], s24 offen offset:1024 sc1 lds
  v_mfma_f32_16x16x32_bf16 v[88:91], a[76:79], a[40:43], v[88:91]
  s_waitcnt lgkmcnt(9)
  ds_read_b64_tr_b16 a[74:75], v22 offset:10240
  v_mfma_f32_16x16x32_bf16 v[96:99], a[80:83], a[40:43], v[96:99]
  ds_read_b64_tr_b16 a[76:77], v23 offset:8192
  v_mfma_f32_16x16x32_bf16 v[100:103], a[80:83], a[44:47], v[100:103]
  ds_read_b64_tr_b16 a[78:79], v23 offset:10240
  v_mfma_f32_16x16x32_bf16 v[108:111], a[84:87], a[44:47], v[108:111]
  ds_read_b64_tr_b16 a[80:81], v20 offset:24576
  buffer_load_dwordx4 a[36:39], v9, s[8:11], s25 offen offset:1024 sc1
  s_add_u32 s25, s25, 131072
  v_mfma_f32_16x16x32_bf16 v[104:107], a[84:87], a[40:43], v[104:107]
  s_waitcnt lgkmcnt(9)
  ds_read_b64_tr_b16 a[82:83], v20 offset:26624
  v_add_u32 v18, s27, v14
  v_mfma_f32_16x16x32_bf16 v[112:115], a[88:91], a[40:43], v[112:115]
  ds_read_b64_tr_b16 a[84:85], v21 offset:24576
  v_mfma_f32_16x16x32_bf16 v[116:119], a[88:91], a[44:47], v[116:119]
  s_add_u32 m0, s26, 16384
  ds_read_b64_tr_b16 a[86:87], v21 offset:26624
  v_mfma_f32_16x16x32_bf16 v[124:127], a[92:95], a[44:47], v[124:127]
  ds_read_b64_tr_b16 a[88:89], v22 offset:24576
  buffer_load_dwordx4 v7, s[44:47], s84 offen offset:1024 sc1 lds
  v_mfma_f32_16x16x32_bf16 v[120:123], a[92:95], a[40:43], v[120:123]
  s_waitcnt vmcnt(25) lgkmcnt(9)
  ds_read_b64_tr_b16 a[90:91], v22 offset:26624
  v_mfma_f32_16x16x32_bf16 v[64:67], a[64:67], a[48:51], v[64:67]
  ds_read_b64_tr_b16 a[92:93], v23 offset:24576
  v_mfma_f32_16x16x32_bf16 v[68:71], a[64:67], a[52:55], v[68:71]
  ds_read_b64_tr_b16 a[94:95], v23 offset:26624
  v_mfma_f32_16x16x32_bf16 v[76:79], a[68:71], a[52:55], v[76:79]
  ds_read_b64_tr_b16 a[64:65], v20 offset:12288
  buffer_load_dwordx4 a[40:43], v9, s[8:11], s25 offen offset:0 sc1
  v_mfma_f32_16x16x32_bf16 v[72:75], a[68:71], a[48:51], v[72:75]
  s_waitcnt lgkmcnt(9)
  ds_read_b64_tr_b16 a[66:67], v20 offset:14336
  v_mfma_f32_16x16x32_bf16 v[80:83], a[72:75], a[48:51], v[80:83]
  ds_read_b64_tr_b16 a[68:69], v21 offset:12288
  v_mfma_f32_16x16x32_bf16 v[84:87], a[72:75], a[52:55], v[84:87]
  s_mov_b32 m0, s26
  ds_read_b64_tr_b16 a[70:71], v21 offset:14336
  v_add_u32 v19, s27, v15
  v_mfma_f32_16x16x32_bf16 v[92:95], a[76:79], a[52:55], v[92:95]
  ds_read_b64_tr_b16 a[72:73], v22 offset:12288
  buffer_load_dwordx4 v4, s[4:7], s24 offen offset:2048 sc1 lds
  v_mfma_f32_16x16x32_bf16 v[88:91], a[76:79], a[48:51], v[88:91]
  s_waitcnt lgkmcnt(9)
  ds_read_b64_tr_b16 a[74:75], v22 offset:14336
  v_mfma_f32_16x16x32_bf16 v[96:99], a[80:83], a[48:51], v[96:99]
  ds_read_b64_tr_b16 a[76:77], v23 offset:12288
  v_mfma_f32_16x16x32_bf16 v[100:103], a[80:83], a[52:55], v[100:103]
  ds_read_b64_tr_b16 a[78:79], v23 offset:14336
  v_mfma_f32_16x16x32_bf16 v[108:111], a[84:87], a[52:55], v[108:111]
  ds_read_b64_tr_b16 a[80:81], v20 offset:28672
  buffer_load_dwordx4 a[44:47], v9, s[8:11], s25 offen offset:1024 sc1
  s_add_u32 s25, s25, 131072
  v_mfma_f32_16x16x32_bf16 v[104:107], a[84:87], a[48:51], v[104:107]
  s_waitcnt lgkmcnt(9)
  ds_read_b64_tr_b16 a[82:83], v20 offset:30720
  v_mfma_f32_16x16x32_bf16 v[112:115], a[88:91], a[48:51], v[112:115]
  ds_read_b64_tr_b16 a[84:85], v21 offset:28672
  v_mfma_f32_16x16x32_bf16 v[116:119], a[88:91], a[52:55], v[116:119]
  s_add_u32 m0, s26, 16384
  ds_read_b64_tr_b16 a[86:87], v21 offset:30720
  v_mfma_f32_16x16x32_bf16 v[124:127], a[92:95], a[52:55], v[124:127]
  ds_read_b64_tr_b16 a[88:89], v22 offset:28672
  buffer_load_dwordx4 v8, s[44:47], s84 offen offset:2048 sc1 lds
  v_mfma_f32_16x16x32_bf16 v[120:123], a[92:95], a[48:51], v[120:123]
  s_waitcnt vmcnt(25) lgkmcnt(9)
  ds_read_b64_tr_b16 a[90:91], v22 offset:30720
  v_mfma_f32_16x16x32_bf16 v[64:67], a[64:67], a[56:59], v[64:67]
  ds_read_b64_tr_b16 a[92:93], v23 offset:28672
  v_mfma_f32_16x16x32_bf16 v[68:71], a[64:67], a[60:63], v[68:71]
  s_waitcnt vmcnt(28)
  ds_read_b64_tr_b16 a[94:95], v23 offset:30720
  s_barrier
  v_mfma_f32_16x16x32_bf16 v[76:79], a[68:71], a[60:63], v[76:79]
  ds_read_b64_tr_b16 a[64:65], v16 offset:0
  buffer_load_dwordx4 a[48:51], v9, s[8:11], s25 offen offset:0 sc1
  v_mfma_f32_16x16x32_bf16 v[72:75], a[68:71], a[56:59], v[72:75]
  s_waitcnt lgkmcnt(9)
  ds_read_b64_tr_b16 a[66:67], v16 offset:2048
  s_mov_b32 m0, s26
  v_mfma_f32_16x16x32_bf16 v[80:83], a[72:75], a[56:59], v[80:83]
  ds_read_b64_tr_b16 a[68:69], v17 offset:0
  buffer_load_dwordx4 v5, s[4:7], s24 offen offset:3072 sc1 lds
  v_mfma_f32_16x16x32_bf16 v[84:87], a[72:75], a[60:63], v[84:87]
  ds_read_b64_tr_b16 a[70:71], v17 offset:2048
  v_mfma_f32_16x16x32_bf16 v[92:95], a[76:79], a[60:63], v[92:95]
  ds_read_b64_tr_b16 a[72:73], v18 offset:0
  v_mfma_f32_16x16x32_bf16 v[88:91], a[76:79], a[56:59], v[88:91]
  s_waitcnt lgkmcnt(9)
  ds_read_b64_tr_b16 a[74:75], v18 offset:2048
  buffer_load_dwordx4 a[52:55], v9, s[8:11], s25 offen offset:1024 sc1
  v_mfma_f32_16x16x32_bf16 v[96:99], a[80:83], a[56:59], v[96:99]
  s_add_u32 s25, s25, 131072
  ds_read_b64_tr_b16 a[76:77], v19 offset:0
  v_mfma_f32_16x16x32_bf16 v[100:103], a[80:83], a[60:63], v[100:103]
  s_add_u32 m0, s26, 16384
  ds_read_b64_tr_b16 a[78:79], v19 offset:2048
  v_mfma_f32_16x16x32_bf16 v[108:111], a[84:87], a[60:63], v[108:111]
  ds_read_b64_tr_b16 a[80:81], v16 offset:16384
  buffer_load_dwordx4 v10, s[44:47], s84 offen offset:3072 sc1 lds
  s_add_u32 s24, s24, s3
  v_mfma_f32_16x16x32_bf16 v[104:107], a[84:87], a[56:59], v[104:107]
  s_waitcnt lgkmcnt(9)
  ds_read_b64_tr_b16 a[82:83], v16 offset:18432
  s_add_u32 s84, s84, s80
  v_mfma_f32_16x16x32_bf16 v[112:115], a[88:91], a[56:59], v[112:115]
  s_add_u32 s26, s26, 32768
  ds_read_b64_tr_b16 a[84:85], v17 offset:16384
  v_mfma_f32_16x16x32_bf16 v[116:119], a[88:91], a[60:63], v[116:119]
  s_cmp_ge_u32 s26, s29
  ds_read_b64_tr_b16 a[86:87], v17 offset:18432
  s_cselect_b32 s26, s23, s26
  v_mfma_f32_16x16x32_bf16 v[124:127], a[92:95], a[60:63], v[124:127]
  ds_read_b64_tr_b16 a[88:89], v18 offset:16384
  v_mfma_f32_16x16x32_bf16 v[120:123], a[92:95], a[56:59], v[120:123]
  s_waitcnt vmcnt(25) lgkmcnt(9)
  ds_read_b64_tr_b16 a[90:91], v18 offset:18432
  s_bitcmp1_b32 3, s28
  s_cbranch_scc0 L_k5_loop
  s_cmp_lg_u32 s28, 1
  s_cbranch_scc1 L_k5_loop_n1
  buffer_load_dwordx4 v[32:35], v9, s[48:51], s36 offen offset:0 sc1
  buffer_load_dwordx4 v[36:39], v9, s[48:51], s37 offen offset:0 sc1
  buffer_load_dwordx4 v[40:43], v9, s[48:51], s36 offen offset:1024 sc1
  buffer_load_dwordx4 v[44:47], v9, s[48:51], s37 offen offset:1024 sc1
  buffer_load_dword v48, v26, s[12:15], s34 offen offset:0 sc1
  buffer_load_dword v49, v26, s[12:15], s34 offen offset:64 sc1
  s_add_u32 s34, s35, 32768
  buffer_load_dword v50, v27, s[12:15], s34 offen offset:0 sc1
  buffer_load_dword v54, v27, s[12:15], s34 offen offset:64 sc1
  s_add_u32 s34, s35, 40960
  buffer_load_dword v51, v27, s[12:15], s34 offen offset:0 sc1
  buffer_load_dword v55, v27, s[12:15], s34 offen offset:64 sc1
  s_add_u32 s34, s35, 49152
  buffer_load_dword v52, v27, s[12:15], s34 offen offset:0 sc1
  buffer_load_dword v56, v27, s[12:15], s34 offen offset:64 sc1
  s_add_u32 s34, s35, 57344
  buffer_load_dword v53, v27, s[12:15], s34 offen offset:0 sc1
  buffer_load_dword v57, v27, s[12:15], s34 offen offset:64 sc1
  s_branch L_k5_loop
L_k5_loop_n1:
L_c5:
  s_add_u32 s27, s27, 32768
  s_cmp_ge_u32 s27, 163840
  s_cselect_b32 s27, 0, s27
  v_add_u32 v20, s27, v12
  v_add_u32 v21, s27, v13
  v_add_u32 v22, s27, v14
  v_add_u32 v23, s27, v15
  s_waitcnt vmcnt(16)
  s_barrier
  v_mfma_f32_16x16x32_bf16 v[64:67], a[64:67], a[0:3], v[64:67]
  ds_read_b64_tr_b16 a[92:93], v16 offset:4096
  v_mfma_f32_16x16x32_bf16 v[68:71], a[64:67], a[4:7], v[68:71]
  ds_read_b64_tr_b16 a[94:95], v16 offset:6144
  v_mfma_f32_16x16x32_bf16 v[76:79], a[68:71], a[4:7], v[76:79]
  ds_read_b64_tr_b16 a[64:65], v17 offset:4096
  v_add_f32 v50, v50, v51
  v_mfma_f32_16x16x32_bf16 v[72:75], a[68:71], a[0:3], v[72:75]
  s_waitcnt lgkmcnt(9)
  ds_read_b64_tr_b16 a[66:67], v17 offset:6144
  v_add_f32 v52, v52, v53
  v_mfma_f32_16x16x32_bf16 v[80:83], a[72:75], a[0:3], v[80:83]
  ds_read_b64_tr_b16 a[68:69], v18 offset:4096
  v_add_f32 v58, v50, v52
  v_mfma_f32_16x16x32_bf16 v[84:87], a[72:75], a[4:7], v[84:87]
  ds_read_b64_tr_b16 a[70:71], v18 offset:6144
  v_mov_b32 v59, v58
  v_mfma_f32_16x16x32_bf16 v[92:95], a[76:79], a[4:7], v[92:95]
  ds_read_b64_tr_b16 a[72:73], v19 offset:4096
  v_permlane16_swap_b32 v59, v58
  v_mfma_f32_16x16x32_bf16 v[88:91], a[76:79], a[0:3], v[88:91]
  s_waitcnt lgkmcnt(9)
  ds_read_b64_tr_b16 a[74:75], v19 offset:6144
  v_add_f32 v58, v58, v59
  v_mfma_f32_16x16x32_bf16 v[96:99], a[80:83], a[0:3], v[96:99]
  ds_read_b64_tr_b16 a[76:77], v16 offset:8192
  v_mov_b32 v59, v58
  v_mfma_f32_16x16x32_bf16 v[100:103], a[80:83], a[4:7], v[100:103]
  ds_read_b64_tr_b16 a[78:79], v16 offset:10240
  v_permlane32_swap_b32 v59, v58
  v_mfma_f32_16x16x32_bf16 v[108:111], a[84:87], a[4:7], v[108:111]
  ds_read_b64_tr_b16 a[80:81], v17 offset:8192
  v_add_f32 v58, v58, v59
  v_mfma_f32_16x16x32_bf16 v[104:107], a[84:87], a[0:3], v[104:107]
  s_waitcnt lgkmcnt(9)
  ds_read_b64_tr_b16 a[82:83], v17 offset:10240
  v_mov_b32 v59, 0x3727c5ac
  v_mfma_f32_16x16x32_bf16 v[112:115], a[88:91], a[0:3], v[112:115]
  ds_read_b64_tr_b16 a[84:85], v18 offset:8192
  v_fmac_f32 v59, 0x3a800000, v58
  v_mfma_f32_16x16x32_bf16 v[116:119], a[88:91], a[4:7], v[116:119]
  s_waitcnt vmcnt(21)
  ds_read_b64_tr_b16 a[86:87], v18 offset:10240
  v_rcp_f32 v58, v59
  v_mfma_f32_16x16x32_bf16 v[68:71], a[92:95], a[12:15], v[68:71]
  ds_read_b64_tr_b16 a[88:89], v19 offset:8192
  v_add_f32 v54, v54, v55
  v_mfma_f32_16x16x32_bf16 v[64:67], a[92:95], a[8:11], v[64:67]
  s_waitcnt lgkmcnt(9)
  ds_read_b64_tr_b16 a[90:91], v19 offset:10240
  v_add_f32 v56, v56, v57
  v_mfma_f32_16x16x32_bf16 v[72:75], a[64:67], a[8:11], v[72:75]
  ds_read_b64_tr_b16 a[92:93], v16 offset:12288
  v_add_f32 v60, v54, v56
  v_mfma_f32_16x16x32_bf16 v[76:79], a[64:67], a[12:15], v[76:79]
  ds_read_b64_tr_b16 a[94:95], v16 offset:14336
  v_mov_b32 v61, v60
  v_mfma_f32_16x16x32_bf16 v[84:87], a[68:71], a[12:15], v[84:87]
  ds_read_b64_tr_b16 a[64:65], v17 offset:12288
  v_permlane16_swap_b32 v61, v60
  v_mfma_f32_16x16x32_bf16 v[80:83], a[68:71], a[8:11], v[80:83]
  s_waitcnt lgkmcnt(9)
  ds_read_b64_tr_b16 a[66:67], v17 offset:14336
  v_add_f32 v60, v60, v61
  v_mfma_f32_16x16x32_bf16 v[88:91], a[72:75], a[8:11], v[88:91]
  ds_read_b64_tr_b16 a[68:69], v18 offset:12288
  v_mov_b32 v61, v60
  v_mfma_f32_16x16x32_bf16 v[92:95], a[72:75], a[12:15], v[92:95]
  s_waitcnt vmcnt(17)
  ds_read_b64_tr_b16 a[70:71], v18 offset:14336
  v_permlane32_swap_b32 v61, v60
  v_mfma_f32_16x16x32_bf16 v[68:71], a[76:79], a[20:23], v[68:71]
  ds_read_b64_tr_b16 a[72:73], v19 offset:12288
  v_add_f32 v60, v60, v61
  v_mfma_f32_16x16x32_bf16 v[64:67], a[76:79], a[16:19], v[64:67]
  s_waitcnt lgkmcnt(9)
  ds_read_b64_tr_b16 a[74:75], v19 offset:14336
  v_mov_b32 v61, 0x3727c5ac
  v_mfma_f32_16x16x32_bf16 v[72:75], a[80:83], a[16:19], v[72:75]
  ds_read_b64_tr_b16 a[76:77], v20 offset:0
  v_fmac_f32 v61, 0x3a800000, v60
  v_mfma_f32_16x16x32_bf16 v[76:79], a[80:83], a[20:23], v[76:79]
  ds_read_b64_tr_b16 a[78:79], v20 offset:2048
  v_rcp_f32 v60, v61
  v_mfma_f32_16x16x32_bf16 v[84:87], a[84:87], a[20:23], v[84:87]
  ds_read_b64_tr_b16 a[80:81], v21 offset:0
  v_mov_b32 v59, v58
  v_mfma_f32_16x16x32_bf16 v[80:83], a[84:87], a[16:19], v[80:83]
  s_waitcnt lgkmcnt(9)
  ds_read_b64_tr_b16 a[82:83], v21 offset:2048
  v_lshlrev_b32 v144, 16, v32
  v_mfma_f32_16x16x32_bf16 v[88:91], a[88:91], a[16:19], v[88:91]
  ds_read_b64_tr_b16 a[84:85], v22 offset:0
  v_and_b32 v145, 0xffff0000, v32
  v_mfma_f32_16x16x32_bf16 v[92:95], a[88:91], a[20:23], v[92:95]
  s_waitcnt vmcnt(13)
  ds_read_b64_tr_b16 a[86:87], v22 offset:2048
  v_lshlrev_b32 v146, 16, v33
  v_mfma_f32_16x16x32_bf16 v[68:71], a[92:95], a[28:31], v[68:71]
  ds_read_b64_tr_b16 a[88:89], v23 offset:0
  v_and_b32 v147, 0xffff0000, v33
  v_mfma_f32_16x16x32_bf16 v[64:67], a[92:95], a[24:27], v[64:67]
  s_waitcnt lgkmcnt(9)
  ds_read_b64_tr_b16 a[90:91], v23 offset:2048
  v_lshlrev_b32 v148, 16, v34
  v_mfma_f32_16x16x32_bf16 v[72:75], a[64:67], a[24:27], v[72:75]
  ds_read_b64_tr_b16 a[92:93], v20 offset:4096
  v_and_b32 v149, 0xffff0000, v34
  v_mfma_f32_16x16x32_bf16 v[76:79], a[64:67], a[28:31], v[76:79]
  ds_read_b64_tr_b16 a[94:95], v20 offset:6144
  v_lshlrev_b32 v150, 16, v35
  v_mfma_f32_16x16x32_bf16 v[84:87], a[68:71], a[28:31], v[84:87]
  ds_read_b64_tr_b16 a[64:65], v21 offset:4096
  v_and_b32 v151, 0xffff0000, v35
  v_mfma_f32_16x16x32_bf16 v[80:83], a[68:71], a[24:27], v[80:83]
  s_waitcnt lgkmcnt(9)
  ds_read_b64_tr_b16 a[66:67], v21 offset:6144
  v_lshlrev_b32 v152, 16, v36
  v_mfma_f32_16x16x32_bf16 v[88:91], a[72:75], a[24:27], v[88:91]
  ds_read_b64_tr_b16 a[68:69], v22 offset:4096
  v_and_b32 v153, 0xffff0000, v36
  v_mfma_f32_16x16x32_bf16 v[92:95], a[72:75], a[28:31], v[92:95]
  s_waitcnt vmcnt(9)
  ds_read_b64_tr_b16 a[70:71], v22 offset:6144
  v_lshlrev_b32 v154, 16, v37
  v_mfma_f32_16x16x32_bf16 v[68:71], a[76:79], a[36:39], v[68:71]
  ds_read_b64_tr_b16 a[72:73], v23 offset:4096
  v_and_b32 v155, 0xffff0000, v37
  v_mfma_f32_16x16x32_bf16 v[64:67], a[76:79], a[32:35], v[64:67]
  s_waitcnt lgkmcnt(9)
  ds_read_b64_tr_b16 a[74:75], v23 offset:6144
  v_lshlrev_b32 v156, 16, v38
  v_mfma_f32_16x16x32_bf16 v[72:75], a[80:83], a[32:35], v[72:75]
  ds_read_b64_tr_b16 a[76:77], v20 offset:8192
  v_and_b32 v157, 0xffff0000, v38
  v_mfma_f32_16x16x32_bf16 v[76:79], a[80:83], a[36:39], v[76:79]
  ds_read_b64_tr_b16 a[78:79], v20 offset:10240
  v_lshlrev_b32 v158, 16, v39
  v_mfma_f32_16x16x32_bf16 v[84:87], a[84:87], a[36:39], v[84:87]
  ds_read_b64_tr_b16 a[80:81], v21 offset:8192
  v_and_b32 v159, 0xffff0000, v39
  v_mfma_f32_16x16x32_bf16 v[80:83], a[84:87], a[32:35], v[80:83]
  s_waitcnt lgkmcnt(9)
  ds_read_b64_tr_b16 a[82:83], v21 offset:10240
  v_mov_b32 v61, v60
  v_mfma_f32_16x16x32_bf16 v[88:91], a[88:91], a[32:35], v[88:91]
  ds_read_b64_tr_b16 a[84:85], v22 offset:8192
  v_lshlrev_b32 v160, 16, v40
  v_mfma_f32_16x16x32_bf16 v[92:95], a[88:91], a[36:39], v[92:95]
  s_waitcnt vmcnt(5)
  ds_read_b64_tr_b16 a[86:87], v22 offset:10240
  v_and_b32 v161, 0xffff0000, v40
  v_mfma_f32_16x16x32_bf16 v[68:71], a[92:95], a[44:47], v[68:71]
  ds_read_b64_tr_b16 a[88:89], v23 offset:8192
  v_lshlrev_b32 v162, 16, v41
  v_mfma_f32_16x16x32_bf16 v[64:67], a[92:95], a[40:43], v[64:67]
  s_waitcnt lgkmcnt(9)
  ds_read_b64_tr_b16 a[90:91], v23 offset:10240
  v_and_b32 v163, 0xffff0000, v41
  v_mfma_f32_16x16x32_bf16 v[72:75], a[64:67], a[40:43], v[72:75]
  ds_read_b64_tr_b16 a[92:93], v20 offset:12288
  v_lshlrev_b32 v164, 16, v42
  v_mfma_f32_16x16x32_bf16 v[76:79], a[64:67], a[44:47], v[76:79]
  ds_read_b64_tr_b16 a[94:95], v20 offset:14336
  v_and_b32 v165, 0xffff0000, v42
  v_mfma_f32_16x16x32_bf16 v[84:87], a[68:71], a[44:47], v[84:87]
  ds_read_b64_tr_b16 a[64:65], v21 offset:12288
  v_lshlrev_b32 v166, 16, v43
  v_mfma_f32_16x16x32_bf16 v[80:83], a[68:71], a[40:43], v[80:83]
  s_waitcnt lgkmcnt(9)
  ds_read_b64_tr_b16 a[66:67], v21 offset:14336
  v_and_b32 v167, 0xffff0000, v43
  v_mfma_f32_16x16x32_bf16 v[88:91], a[72:75], a[40:43], v[88:91]
  ds_read_b64_tr_b16 a[68:69], v22 offset:12288
  v_lshlrev_b32 v168, 16, v44
  v_mfma_f32_16x16x32_bf16 v[92:95], a[72:75], a[44:47], v[92:95]
  s_waitcnt vmcnt(1)
  ds_read_b64_tr_b16 a[70:71], v22 offset:14336
  v_and_b32 v169, 0xffff0000, v44
  v_mfma_f32_16x16x32_bf16 v[68:71], a[76:79], a[52:55], v[68:71]
  ds_read_b64_tr_b16 a[72:73], v23 offset:12288
  v_lshlrev_b32 v170, 16, v45
  v_mfma_f32_16x16x32_bf16 v[64:67], a[76:79], a[48:51], v[64:67]
  s_waitcnt lgkmcnt(9)
  ds_read_b64_tr_b16 a[74:75], v23 offset:14336
  v_and_b32 v171, 0xffff0000, v45
  v_mfma_f32_16x16x32_bf16 v[72:75], a[80:83], a[48:51], v[72:75]
  ds_read_b64_tr_b16 a[76:77], v19 offset:16384
  v_lshlrev_b32 v172, 16, v46
  v_mfma_f32_16x16x32_bf16 v[76:79], a[80:83], a[52:55], v[76:79]
  ds_read_b64_tr_b16 a[78:79], v19 offset:18432
  v_and_b32 v173, 0xffff0000, v46
  v_mfma_f32_16x16x32_bf16 v[84:87], a[84:87], a[52:55], v[84:87]
  ds_read_b64_tr_b16 a[80:81], v16 offset:20480
  v_lshlrev_b32 v174, 16, v47
  v_mfma_f32_16x16x32_bf16 v[80:83], a[84:87], a[48:51], v[80:83]
  s_waitcnt lgkmcnt(9)
  ds_read_b64_tr_b16 a[82:83], v16 offset:22528
  v_and_b32 v175, 0xffff0000, v47
  v_mfma_f32_16x16x32_bf16 v[88:91], a[88:91], a[48:51], v[88:91]
  ds_read_b64_tr_b16 a[84:85], v17 offset:20480
  v_mfma_f32_16x16x32_bf16 v[92:95], a[88:91], a[52:55], v[92:95]
  ds_read_b64_tr_b16 a[86:87], v17 offset:22528
  v_mfma_f32_16x16x32_bf16 v[68:71], a[92:95], a[100:103], v[68:71]
  ds_read_b64_tr_b16 a[88:89], v18 offset:20480
  v_mfma_f32_16x16x32_bf16 v[64:67], a[92:95], a[96:99], v[64:67]
  s_waitcnt lgkmcnt(9)
  ds_read_b64_tr_b16 a[90:91], v18 offset:22528
  v_mfma_f32_16x16x32_bf16 v[72:75], a[64:67], a[96:99], v[72:75]
  ds_read_b64_tr_b16 a[92:93], v19 offset:20480
  v_mfma_f32_16x16x32_bf16 v[76:79], a[64:67], a[100:103], v[76:79]
  ds_read_b64_tr_b16 a[94:95], v19 offset:22528
  v_mfma_f32_16x16x32_bf16 v[84:87], a[68:71], a[100:103], v[84:87]
  ds_read_b64_tr_b16 a[64:65], v16 offset:24576
  v_mfma_f32_16x16x32_bf16 v[80:83], a[68:71], a[96:99], v[80:83]
  s_waitcnt lgkmcnt(9)
  ds_read_b64_tr_b16 a[66:67], v16 offset:26624
  v_mfma_f32_16x16x32_bf16 v[88:91], a[72:75], a[96:99], v[88:91]
  ds_read_b64_tr_b16 a[68:69], v17 offset:24576
  v_mfma_f32_16x16x32_bf16 v[92:95], a[72:75], a[100:103], v[92:95]
  ds_read_b64_tr_b16 a[70:71], v17 offset:26624
  v_mfma_f32_16x16x32_bf16 v[124:127], a[76:79], a[4:7], v[124:127]
  ds_read_b64_tr_b16 a[72:73], v18 offset:24576
  v_mfma_f32_16x16x32_bf16 v[120:123], a[76:79], a[0:3], v[120:123]
  s_waitcnt lgkmcnt(9)
  ds_read_b64_tr_b16 a[74:75], v18 offset:26624
  v_mfma_f32_16x16x32_bf16 v[96:99], a[80:83], a[8:11], v[96:99]
  ds_read_b64_tr_b16 a[76:77], v19 offset:24576
  v_cvt_pk_bf16_f32 v128, v64, v65
  v_mfma_f32_16x16x32_bf16 v[100:103], a[80:83], a[12:15], v[100:103]
  ds_read_b64_tr_b16 a[78:79], v19 offset:26624
  v_cvt_pk_bf16_f32 v129, v66, v67
  v_mfma_f32_16x16x32_bf16 v[108:111], a[84:87], a[12:15], v[108:111]
  ds_read_b64_tr_b16 a[80:81], v16 offset:28672
  v_cvt_pk_bf16_f32 v130, v72, v73
  v_mfma_f32_16x16x32_bf16 v[104:107], a[84:87], a[8:11], v[104:107]
  s_waitcnt lgkmcnt(9)
  ds_read_b64_tr_b16 a[82:83], v16 offset:30720
  v_cvt_pk_bf16_f32 v131, v74, v75
  v_mfma_f32_16x16x32_bf16 v[112:115], a[88:91], a[8:11], v[112:115]
  ds_read_b64_tr_b16 a[84:85], v17 offset:28672
  buffer_store_dwordx4 v[128:131], v9, s[52:55], s41 offen offset:0 sc1
  v_mfma_f32_16x16x32_bf16 v[116:119], a[88:91], a[12:15], v[116:119]
  ds_read_b64_tr_b16 a[86:87], v17 offset:30720
  v_cvt_pk_bf16_f32 v132, v80, v81
  v_mfma_f32_16x16x32_bf16 v[124:127], a[92:95], a[12:15], v[124:127]
  ds_read_b64_tr_b16 a[88:89], v18 offset:28672
  v_cvt_pk_bf16_f32 v133, v82, v83
  v_mfma_f32_16x16x32_bf16 v[120:123], a[92:95], a[8:11], v[120:123]
  s_waitcnt lgkmcnt(9)
  ds_read_b64_tr_b16 a[90:91], v18 offset:30720
  v_cvt_pk_bf16_f32 v134, v88, v89
  v_mfma_f32_16x16x32_bf16 v[96:99], a[64:67], a[16:19], v[96:99]
  ds_read_b64_tr_b16 a[92:93], v19 offset:28672
  v_cvt_pk_bf16_f32 v135, v90, v91
  v_mfma_f32_16x16x32_bf16 v[100:103], a[64:67], a[20:23], v[100:103]
  ds_read_b64_tr_b16 a[94:95], v19 offset:30720
  buffer_store_dwordx4 v[132:135], v9, s[52:55], s41 offen offset:1024 sc1
  v_mfma_f32_16x16x32_bf16 v[108:111], a[68:71], a[20:23], v[108:111]
  ds_read_b64_tr_b16 a[64:65], v20 offset:16384
  v_cvt_pk_bf16_f32 v136, v68, v69
  v_mfma_f32_16x16x32_bf16 v[104:107], a[68:71], a[16:19], v[104:107]
  s_waitcnt lgkmcnt(9)
  ds_read_b64_tr_b16 a[66:67], v20 offset:18432
  v_cvt_pk_bf16_f32 v137, v70, v71
  v_mfma_f32_16x16x32_bf16 v[112:115], a[72:75], a[16:19], v[112:115]
  ds_read_b64_tr_b16 a[68:69], v21 offset:16384
  v_cvt_pk_bf16_f32 v138, v76, v77
  v_mfma_f32_16x16x32_bf16 v[116:119], a[72:75], a[20:23], v[116:119]
  ds_read_b64_tr_b16 a[70:71], v21 offset:18432
  v_cvt_pk_bf16_f32 v139, v78, v79
  v_mfma_f32_16x16x32_bf16 v[124:127], a[76:79], a[20:23], v[124:127]
  ds_read_b64_tr_b16 a[72:73], v22 offset:16384
  buffer_store_dwordx4 v[136:139], v9, s[52:55], s41 offen offset:2048 sc1
  v_mfma_f32_16x16x32_bf16 v[120:123], a[76:79], a[16:19], v[120:123]
  s_waitcnt lgkmcnt(9)
  ds_read_b64_tr_b16 a[74:75], v22 offset:18432
  v_cvt_pk_bf16_f32 v140, v84, v85
  v_mfma_f32_16x16x32_bf16 v[96:99], a[80:83], a[24:27], v[96:99]
  ds_read_b64_tr_b16 a[76:77], v23 offset:16384
  v_cvt_pk_bf16_f32 v141, v86, v87
  v_mfma_f32_16x16x32_bf16 v[100:103], a[80:83], a[28:31], v[100:103]
  ds_read_b64_tr_b16 a[78:79], v23 offset:18432
  v_cvt_pk_bf16_f32 v142, v92, v93
  v_mfma_f32_16x16x32_bf16 v[108:111], a[84:87], a[28:31], v[108:111]
  ds_read_b64_tr_b16 a[80:81], v20 offset:20480
  v_cvt_pk_bf16_f32 v143, v94, v95
  v_mfma_f32_16x16x32_bf16 v[104:107], a[84:87], a[24:27], v[104:107]
  s_waitcnt lgkmcnt(9)
  ds_read_b64_tr_b16 a[82:83], v20 offset:22528
  buffer_store_dwordx4 v[140:143], v9, s[52:55], s41 offen offset:3072 sc1
  v_mfma_f32_16x16x32_bf16 v[112:115], a[88:91], a[24:27], v[112:115]
  ds_read_b64_tr_b16 a[84:85], v21 offset:20480
  v_add_f32 v144, v144, v48
  v_mfma_f32_16x16x32_bf16 v[116:119], a[88:91], a[28:31], v[116:119]
  ds_read_b64_tr_b16 a[86:87], v21 offset:22528
  v_add_f32 v145, v145, v48
  v_mfma_f32_16x16x32_bf16 v[124:127], a[92:95], a[28:31], v[124:127]
  ds_read_b64_tr_b16 a[88:89], v22 offset:20480
  v_add_f32 v146, v146, v48
  v_mfma_f32_16x16x32_bf16 v[120:123], a[92:95], a[24:27], v[120:123]
  s_waitcnt lgkmcnt(9)
  ds_read_b64_tr_b16 a[90:91], v22 offset:22528
  v_add_f32 v147, v147, v48
  v_mfma_f32_16x16x32_bf16 v[96:99], a[64:67], a[32:35], v[96:99]
  ds_read_b64_tr_b16 a[92:93], v23 offset:20480
  v_add_f32 v148, v148, v48
  v_mfma_f32_16x16x32_bf16 v[100:103], a[64:67], a[36:39], v[100:103]
  ds_read_b64_tr_b16 a[94:95], v23 offset:22528
  v_add_f32 v149, v149, v48
  v_mfma_f32_16x16x32_bf16 v[108:111], a[68:71], a[36:39], v[108:111]
  ds_read_b64_tr_b16 a[64:65], v20 offset:24576
  v_add_f32 v150, v150, v48
  v_mfma_f32_16x16x32_bf16 v[104:107], a[68:71], a[32:35], v[104:107]
  s_waitcnt lgkmcnt(9)
  ds_read_b64_tr_b16 a[66:67], v20 offset:26624
  v_add_f32 v151, v151, v48
  v_mfma_f32_16x16x32_bf16 v[112:115], a[72:75], a[32:35], v[112:115]
  ds_read_b64_tr_b16 a[68:69], v21 offset:24576
  v_add_f32 v152, v152, v48
  v_mfma_f32_16x16x32_bf16 v[116:119], a[72:75], a[36:39], v[116:119]
  ds_read_b64_tr_b16 a[70:71], v21 offset:26624
  v_add_f32 v153, v153, v48
  v_mfma_f32_16x16x32_bf16 v[124:127], a[76:79], a[36:39], v[124:127]
  ds_read_b64_tr_b16 a[72:73], v22 offset:24576
  v_add_f32 v154, v154, v48
  v_mfma_f32_16x16x32_bf16 v[120:123], a[76:79], a[32:35], v[120:123]
  s_waitcnt lgkmcnt(9)
  ds_read_b64_tr_b16 a[74:75], v22 offset:26624
  v_add_f32 v155, v155, v48
  v_mfma_f32_16x16x32_bf16 v[96:99], a[80:83], a[40:43], v[96:99]
  ds_read_b64_tr_b16 a[76:77], v23 offset:24576
  v_add_f32 v156, v156, v48
  v_mfma_f32_16x16x32_bf16 v[100:103], a[80:83], a[44:47], v[100:103]
  ds_read_b64_tr_b16 a[78:79], v23 offset:26624
  v_add_f32 v157, v157, v48
  v_mfma_f32_16x16x32_bf16 v[108:111], a[84:87], a[44:47], v[108:111]
  ds_read_b64_tr_b16 a[80:81], v20 offset:28672
  v_add_f32 v158, v158, v48
  v_mfma_f32_16x16x32_bf16 v[104:107], a[84:87], a[40:43], v[104:107]
  s_waitcnt lgkmcnt(9)
  ds_read_b64_tr_b16 a[82:83], v20 offset:30720
  v_add_f32 v159, v159, v48
  v_mfma_f32_16x16x32_bf16 v[112:115], a[88:91], a[40:43], v[112:115]
  ds_read_b64_tr_b16 a[84:85], v21 offset:28672
  v_add_f32 v160, v160, v49
  v_mfma_f32_16x16x32_bf16 v[116:119], a[88:91], a[44:47], v[116:119]
  ds_read_b64_tr_b16 a[86:87], v21 offset:30720
  v_add_f32 v161, v161, v49
  v_mfma_f32_16x16x32_bf16 v[124:127], a[92:95], a[44:47], v[124:127]
  ds_read_b64_tr_b16 a[88:89], v22 offset:28672
  v_add_f32 v162, v162, v49
  v_mfma_f32_16x16x32_bf16 v[120:123], a[92:95], a[40:43], v[120:123]
  s_waitcnt lgkmcnt(9)
  ds_read_b64_tr_b16 a[90:91], v22 offset:30720
  v_add_f32 v163, v163, v49
  v_mfma_f32_16x16x32_bf16 v[96:99], a[64:67], a[48:51], v[96:99]
  ds_read_b64_tr_b16 a[92:93], v23 offset:28672
  v_add_f32 v164, v164, v49
  v_mfma_f32_16x16x32_bf16 v[100:103], a[64:67], a[52:55], v[100:103]
  ds_read_b64_tr_b16 a[94:95], v23 offset:30720
  v_add_f32 v165, v165, v49
  v_mfma_f32_16x16x32_bf16 v[108:111], a[68:71], a[52:55], v[108:111]
  v_add_f32 v166, v166, v49
  v_add_f32 v167, v167, v49
  v_mfma_f32_16x16x32_bf16 v[104:107], a[68:71], a[48:51], v[104:107]
  s_waitcnt lgkmcnt(8)
  v_add_f32 v168, v168, v49
  v_add_f32 v169, v169, v49
  v_mfma_f32_16x16x32_bf16 v[112:115], a[72:75], a[48:51], v[112:115]
  v_add_f32 v170, v170, v49
  v_add_f32 v171, v171, v49
  v_mfma_f32_16x16x32_bf16 v[116:119], a[72:75], a[52:55], v[116:119]
  v_add_f32 v172, v172, v49
  v_add_f32 v173, v173, v49
  v_mfma_f32_16x16x32_bf16 v[124:127], a[76:79], a[52:55], v[124:127]
  v_add_f32 v174, v174, v49
  v_add_f32 v175, v175, v49
  v_mfma_f32_16x16x32_bf16 v[120:123], a[76:79], a[48:51], v[120:123]
  s_waitcnt lgkmcnt(4)
  v_mfma_f32_16x16x32_bf16 v[96:99], a[80:83], a[96:99], v[96:99]
  v_mfma_f32_16x16x32_bf16 v[100:103], a[80:83], a[100:103], v[100:103]
  v_mfma_f32_16x16x32_bf16 v[108:111], a[84:87], a[100:103], v[108:111]
  v_mfma_f32_16x16x32_bf16 v[104:107], a[84:87], a[96:99], v[104:107]
  s_waitcnt lgkmcnt(0)
  v_mfma_f32_16x16x32_bf16 v[112:115], a[88:91], a[96:99], v[112:115]
  v_mfma_f32_16x16x32_bf16 v[116:119], a[88:91], a[100:103], v[116:119]
  v_mfma_f32_16x16x32_bf16 v[124:127], a[92:95], a[100:103], v[124:127]
  v_mfma_f32_16x16x32_bf16 v[120:123], a[92:95], a[96:99], v[120:123]
  buffer_load_dwordx4 v[176:179], v9, s[52:55], s40 offen offset:0 sc1
  buffer_load_dwordx4 v[180:183], v9, s[52:55], s40 offen offset:1024 sc1
  buffer_load_dwordx4 v[184:187], v9, s[52:55], s40 offen offset:2048 sc1
  buffer_load_dwordx4 v[188:191], v9, s[52:55], s40 offen offset:3072 sc1
  v_pk_fma_f32 v[144:145], v[96:97], v[58:59], v[144:145]
  v_pk_fma_f32 v[146:147], v[98:99], v[58:59], v[146:147]
  v_pk_fma_f32 v[148:149], v[104:105], v[58:59], v[148:149]
  v_pk_fma_f32 v[150:151], v[106:107], v[58:59], v[150:151]
  v_pk_fma_f32 v[152:153], v[112:113], v[58:59], v[152:153]
  v_pk_fma_f32 v[154:155], v[114:115], v[58:59], v[154:155]
  v_pk_fma_f32 v[156:157], v[120:121], v[58:59], v[156:157]
  v_pk_fma_f32 v[158:159], v[122:123], v[58:59], v[158:159]
  v_pk_fma_f32 v[160:161], v[100:101], v[60:61], v[160:161]
  v_pk_fma_f32 v[162:163], v[102:103], v[60:61], v[162:163]
  v_pk_fma_f32 v[164:165], v[108:109], v[60:61], v[164:165]
  v_pk_fma_f32 v[166:167], v[110:111], v[60:61], v[166:167]
  v_pk_fma_f32 v[168:169], v[116:117], v[60:61], v[168:169]
  v_pk_fma_f32 v[170:171], v[118:119], v[60:61], v[170:171]
  v_pk_fma_f32 v[172:173], v[124:125], v[60:61], v[172:173]
  v_pk_fma_f32 v[174:175], v[126:127], v[60:61], v[174:175]
  s_mov_b32 s31, 0x40000
L_p5_poll:
  s_waitcnt vmcnt(0)
  v_max3_u32 v2, v176, v177, v178
  v_max3_u32 v2, v2, v179, v180
  v_max3_u32 v2, v2, v181, v182
  v_max3_u32 v2, v2, v183, v184
  v_max3_u32 v2, v2, v185, v186
  v_max3_u32 v2, v2, v187, v188
  v_max3_u32 v2, v2, v189, v190
  v_max_u32 v2, v2, v191
  v_cmp_eq_u32 vcc, -1, v2
  s_sub_u32 s31, s31, 1
  s_cbranch_scc1 L_p5_got
  s_cbranch_vccz L_p5_got
  buffer_load_dwordx4 v[176:179], v9, s[52:55], s40 offen offset:0 sc1
  buffer_load_dwordx4 v[180:183], v9, s[52:55], s40 offen offset:1024 sc1
  buffer_load_dwordx4 v[184:187], v9, s[52:55], s40 offen offset:2048 sc1
  buffer_load_dwordx4 v[188:191], v9, s[52:55], s40 offen offset:3072 sc1
  s_branch L_p5_poll
L_p5_got:
  v_lshlrev_b32 v4, 16, v176
  v_and_b32 v5, 0xffff0000, v176
  v_pk_fma_f32 v[4:5], v[4:5], v[58:59], v[144:145]
  v_cvt_pk_bf16_f32 v176, v4, v5
  v_lshlrev_b32 v4, 16, v177
  v_and_b32 v5, 0xffff0000, v177
  v_pk_fma_f32 v[4:5], v[4:5], v[58:59], v[146:147]
  v_cvt_pk_bf16_f32 v177, v4, v5
  v_lshlrev_b32 v4, 16, v178
  v_and_b32 v5, 0xffff0000, v178
  v_pk_fma_f32 v[4:5], v[4:5], v[58:59], v[148:149]
  v_cvt_pk_bf16_f32 v178, v4, v5
  v_lshlrev_b32 v4, 16, v179
  v_and_b32 v5, 0xffff0000, v179
  v_pk_fma_f32 v[4:5], v[4:5], v[58:59], v[150:151]
  v_cvt_pk_bf16_f32 v179, v4, v5
  v_permlane16_swap_b32 v176, v178
  s_nop 0
  v_permlane16_swap_b32 v177, v179
  buffer_store_dwordx4 v[176:179], v11, s[16:19], s32 offen offset:0 sc1
  v_lshlrev_b32 v4, 16, v180
  v_and_b32 v5, 0xffff0000, v180
  v_pk_fma_f32 v[4:5], v[4:5], v[58:59], v[152:153]
  v_cvt_pk_bf16_f32 v180, v4, v5
  v_lshlrev_b32 v4, 16, v181
  v_and_b32 v5, 0xffff0000, v181
  v_pk_fma_f32 v[4:5], v[4:5], v[58:59], v[154:155]
  v_cvt_pk_bf16_f32 v181, v4, v5
  v_lshlrev_b32 v4, 16, v182
  v_and_b32 v5, 0xffff0000, v182
  v_pk_fma_f32 v[4:5], v[4:5], v[58:59], v[156:157]
  v_cvt_pk_bf16_f32 v182, v4, v5
  v_lshlrev_b32 v4, 16, v183
  v_and_b32 v5, 0xffff0000, v183
  v_pk_fma_f32 v[4:5], v[4:5], v[58:59], v[158:159]
  v_cvt_pk_bf16_f32 v183, v4, v5
  v_permlane16_swap_b32 v180, v182
  s_nop 0
  v_permlane16_swap_b32 v181, v183
  buffer_store_dwordx4 v[180:183], v11, s[16:19], s32 offen offset:64 sc1
  v_lshlrev_b32 v4, 16, v184
  v_and_b32 v5, 0xffff0000, v184
  v_pk_fma_f32 v[4:5], v[4:5], v[60:61], v[160:161]
  v_cvt_pk_bf16_f32 v184, v4, v5
  v_lshlrev_b32 v4, 16, v185
  v_and_b32 v5, 0xffff0000, v185
  v_pk_fma_f32 v[4:5], v[4:5], v[60:61], v[162:163]
  v_cvt_pk_bf16_f32 v185, v4, v5
  v_lshlrev_b32 v4, 16, v186
  v_and_b32 v5, 0xffff0000, v186
  v_pk_fma_f32 v[4:5], v[4:5], v[60:61], v[164:165]
  v_cvt_pk_bf16_f32 v186, v4, v5
  v_lshlrev_b32 v4, 16, v187
  v_and_b32 v5, 0xffff0000, v187
  v_pk_fma_f32 v[4:5], v[4:5], v[60:61], v[166:167]
  v_cvt_pk_bf16_f32 v187, v4, v5
  v_permlane16_swap_b32 v184, v186
  s_nop 0
  v_permlane16_swap_b32 v185, v187
  buffer_store_dwordx4 v[184:187], v11, s[16:19], s33 offen offset:0 sc1
  v_lshlrev_b32 v4, 16, v188
  v_and_b32 v5, 0xffff0000, v188
  v_pk_fma_f32 v[4:5], v[4:5], v[60:61], v[168:169]
  v_cvt_pk_bf16_f32 v188, v4, v5
  v_lshlrev_b32 v4, 16, v189
  v_and_b32 v5, 0xffff0000, v189
  v_pk_fma_f32 v[4:5], v[4:5], v[60:61], v[170:171]
  v_cvt_pk_bf16_f32 v189, v4, v5
  v_lshlrev_b32 v4, 16, v190
  v_and_b32 v5, 0xffff0000, v190
  v_pk_fma_f32 v[4:5], v[4:5], v[60:61], v[172:173]
  v_cvt_pk_bf16_f32 v190, v4, v5
  v_lshlrev_b32 v4, 16, v191
  v_and_b32 v5, 0xffff0000, v191
  v_pk_fma_f32 v[4:5], v[4:5], v[60:61], v[174:175]
  v_cvt_pk_bf16_f32 v191, v4, v5
  v_permlane16_swap_b32 v188, v190
  s_nop 0
  v_permlane16_swap_b32 v189, v191
  buffer_store_dwordx4 v[188:191], v11, s[16:19], s33 offen offset:64 sc1
L_sequential_preLN__softmax_full_mha__glu_gated_bilinear__prompt_kernel_end:
  s_endpgm
L_attn_redo:
  s_waitcnt vmcnt(0)
  s_barrier
  s_mov_b32 s33, 1
  s_mov_b32 s6, 8388608
  s_mov_b32 s30, s34
  s_mov_b32 s31, 64
  v_mov_b32 v5, 0xff800000
  v_mov_b32 v6, 0xff800000
L_attn_maxloop:
  buffer_load_dwordx4 v[144:147], v9, s[4:7], s30 offen sc1
  buffer_load_dwordx4 v[148:151], v9, s[4:7], s30 offen offset:1024 sc1
  s_add_u32 s30, s30, 2048
  s_waitcnt vmcnt(0)
  v_mfma_f32_32x32x16_bf16 v[16:31], v[144:147], v[128:131], 0
  v_mfma_f32_32x32x16_bf16 v[16:31], v[148:151], v[132:135], v[16:31]
  v_mfma_f32_32x32x16_bf16 v[32:47], v[144:147], v[136:139], 0
  v_mfma_f32_32x32x16_bf16 v[32:47], v[148:151], v[140:143], v[32:47]
  s_nop 9
  v_max3_f32 v5, v5, v16, v17
  v_max3_f32 v5, v5, v18, v19
  v_max3_f32 v5, v5, v20, v21
  v_max3_f32 v5, v5, v22, v23
  v_max3_f32 v5, v5, v24, v25
  v_max3_f32 v5, v5, v26, v27
  v_max3_f32 v5, v5, v28, v29
  v_max3_f32 v5, v5, v30, v31
  v_max3_f32 v6, v6, v32, v33
  v_max3_f32 v6, v6, v34, v35
  v_max3_f32 v6, v6, v36, v37
  v_max3_f32 v6, v6, v38, v39
  v_max3_f32 v6, v6, v40, v41
  v_max3_f32 v6, v6, v42, v43
  v_max3_f32 v6, v6, v44, v45
  v_max3_f32 v6, v6, v46, v47
  s_sub_u32 s31, s31, 1
  s_cmp_lg_u32 s31, 0
  s_cbranch_scc1 L_attn_maxloop
  v_mov_b32 v7, v5
  s_nop 1
  v_permlane32_swap_b32 v5, v7
  v_max_f32 v5, v5, v7
  v_sub_f32 v96, 0, v5
  v_sub_f32 v97, 0, v5
  v_sub_f32 v98, 0, v5
  v_sub_f32 v99, 0, v5
  v_sub_f32 v100, 0, v5
  v_sub_f32 v101, 0, v5
  v_sub_f32 v102, 0, v5
  v_sub_f32 v103, 0, v5
  v_sub_f32 v104, 0, v5
  v_sub_f32 v105, 0, v5
  v_sub_f32 v106, 0, v5
  v_sub_f32 v107, 0, v5
  v_sub_f32 v108, 0, v5
  v_sub_f32 v109, 0, v5
  v_sub_f32 v110, 0, v5
  v_sub_f32 v111, 0, v5
  v_mov_b32 v7, v6
  s_nop 1
  v_permlane32_swap_b32 v6, v7
  v_max_f32 v6, v6, v7
  v_sub_f32 v112, 0, v6
  v_sub_f32 v113, 0, v6
  v_sub_f32 v114, 0, v6
  v_sub_f32 v115, 0, v6
  v_sub_f32 v116, 0, v6
  v_sub_f32 v117, 0, v6
  v_sub_f32 v118, 0, v6
  v_sub_f32 v119, 0, v6
  v_sub_f32 v120, 0, v6
  v_sub_f32 v121, 0, v6
  v_sub_f32 v122, 0, v6
  v_sub_f32 v123, 0, v6
  v_sub_f32 v124, 0, v6
  v_sub_f32 v125, 0, v6
  v_sub_f32 v126, 0, v6
  v_sub_f32 v127, 0, v6
  s_lshr_b32 s30, s20, 1
  s_lshl_b32 s30, s30, 22
  s_and_b32 s31, s20, 1
  s_mul_i32 s31, s31, 4096
  s_add_u32 s24, s34, s30
  s_add_u32 s24, s24, s31
  s_add_u32 s35, s24, 131072
  s_mov_b32 s26, 0
  s_mov_b32 s27, 0
  s_mov_b32 s6, 8388608
  v_mov_b32 v3, v2
  v_mov_b32 v56, 0
  v_mov_b32 v57, 0
  v_mov_b32 v58, 0
  v_mov_b32 v59, 0
  v_mov_b32 v60, 0
  v_mov_b32 v61, 0
  v_mov_b32 v62, 0
  v_mov_b32 v63, 0
  v_mov_b32 v64, 0
  v_mov_b32 v65, 0
  v_mov_b32 v66, 0
  v_mov_b32 v67, 0
  v_mov_b32 v68, 0
  v_mov_b32 v69, 0
  v_mov_b32 v70, 0
  v_mov_b32 v71, 0
  v_mov_b32 v72, 0
  v_mov_b32 v73, 0
  v_mov_b32 v74, 0
  v_mov_b32 v75, 0
  v_mov_b32 v76, 0
  v_mov_b32 v77, 0
  v_mov_b32 v78, 0
  v_mov_b32 v79, 0
  v_mov_b32 v80, 0
  v_mov_b32 v81, 0
  v_mov_b32 v82, 0
  v_mov_b32 v83, 0
  v_mov_b32 v84, 0
  v_mov_b32 v85, 0
  v_mov_b32 v86, 0
  v_mov_b32 v87, 0
  v_mov_b32 v88, 0
  v_mov_b32 v89, 0
  v_mov_b32 v90, 0
  v_mov_b32 v91, 0
  v_mov_b32 v92, 0
  v_mov_b32 v93, 0
  v_mov_b32 v94, 0
  v_mov_b32 v95, 0
  v_mov_b32 v48, 0
  v_mov_b32 v49, 0
  v_mov_b32 v50, 0
  v_mov_b32 v51, 0
  v_mov_b32 v52, 0
  v_mov_b32 v53, 0
  v_mov_b32 v54, 0
  v_mov_b32 v55, 0
  s_branch L_attn_start
L_text_end:
.section .rodata,"a"
.p2align 6
.amdhsa_kernel sequential_preLN__softmax_full_mha__glu_gated_bilinear__prompt_kernel
  .amdhsa_next_free_vgpr 384
  .amdhsa_next_free_sgpr 102
  .amdhsa_accum_offset 256
  .amdhsa_group_segment_fixed_size 0
  .amdhsa_kernarg_size 80
  .amdhsa_user_sgpr_count 2
  .amdhsa_user_sgpr_kernarg_segment_ptr 1
  .amdhsa_system_sgpr_workgroup_id_x 1
  .amdhsa_float_denorm_mode_32 3
.end_amdhsa_kernel
```
